```python
import torch

def _softmax(x, axis=-1):
    return torch.softmax(x, dim=axis)

def _gelu(x):
    return torch.nn.functional.gelu(x, approximate='tanh')

def _silu(x):
    return torch.nn.functional.silu(x)

def _sigmoid(x):
    return torch.sigmoid(x)

def _layernorm(x, axis=-1, eps=1e-05):
    m = x.mean(dim=axis, keepdim=True)
    v = x.var(dim=axis, keepdim=True, unbiased=False)
    return (x - m) / torch.sqrt(v + eps)

def _scatter_add(tgt, idx, src, axis=0):
    return tgt.clone().index_add_(axis, idx, src)

def _segment_sum(src, seg, n):
    out = torch.zeros((n,) + src.shape[1:], dtype=src.dtype)
    return out.index_add_(0, seg, src)

def _pad(x, pw):
    flat = tuple((v for pair in reversed(pw) for v in pair))
    return torch.nn.functional.pad(x, flat)
kernel_name = 'parallel_sum__softmax_full_mha__mixer_gmlp__prompt'

def setup_inputs():

    _w = lambda a: (lambda t: t.to(torch.bfloat16) if t.is_floating_point() else t)(torch.as_tensor(a))

    def _A_setup():
        B, S, D = (1, 2048, 640)
        return {'x': _w((lambda *s: torch.randn(*s, dtype=torch.bfloat16) * 0.05)(B, S, D)), 'wqkv': _w((lambda *s: torch.randn(*s, dtype=torch.bfloat16) * 0.2)(D, 3 * D)), 'wo': _w((lambda *s: torch.randn(*s, dtype=torch.bfloat16) * 0.1)(D, D))}
    _A_in = _A_setup()

    def _B_setup():
        B, S, D, F = (1, 2048, 640, 1728)
        Fh = F // 2
        return {'x': _w((lambda *s: torch.randn(*s, dtype=torch.bfloat16) * 0.05)(B, S, D)), 'w_in': _w((lambda *s: torch.randn(*s, dtype=torch.bfloat16) * 0.8)(D, 2 * Fh)), 'w_sp': _w(0.01 * (lambda *s: torch.randn(*s, dtype=torch.bfloat16) * 0.8)(S, S)), 'b_sp': _w(1.0 + 0.01 * (lambda *s: torch.randn(*s, dtype=torch.bfloat16) * 0.2)(S)), 'w_out': _w((lambda *s: torch.randn(*s, dtype=torch.bfloat16) * 0.2)(Fh, D))}
    _B_in = _B_setup()
    return {'A_x': _A_in['x'], 'A_wqkv': _A_in['wqkv'], 'A_wo': _A_in['wo'], 'B_x': _B_in['x'], 'B_w_in': _B_in['w_in'], 'B_w_sp': _B_in['w_sp'], 'B_b_sp': _B_in['b_sp'], 'B_w_out': _B_in['w_out']}

def reference(A_x, A_wqkv, A_wo, B_x, B_w_in, B_w_sp, B_b_sp, B_w_out):

    def _A_ref(x, wqkv, wo):
        B, S, D = x.shape
        H = 32
        Dh = D // H
        qkv = (lambda x, *d: x.permute(*d))((x @ wqkv).reshape(B, S, 3, H, Dh), 2, 0, 3, 1, 4)
        q, k, v = (qkv[0], qkv[1], qkv[2])
        scale = Dh ** (-0.5)
        scores = torch.einsum('bhqd,bhkd->bhqk', q, k) * scale
        p = _softmax(scores, axis=-1)
        o = torch.einsum('bhqk,bhkd->bhqd', p, v)
        return (lambda x, *d: x.permute(*d))(o, 0, 2, 1, 3).reshape(B, S, D) @ wo

    def _B_ref(x, w_in, w_sp, b_sp, w_out):
        B, S, D = x.shape
        F = w_in.shape[-1]
        Fh = F // 2
        z = _gelu(torch.einsum('bsd,df->bsf', x, w_in))
        z1 = z[..., :Fh].clone()
        z2 = _layernorm(z[..., Fh:], axis=-1)
        g = torch.einsum('ts,bsf->btf', w_sp, z2) + b_sp[None, :, None]
        return torch.einsum('bsf,fd->bsd', z1 * g, w_out)
    x = A_x
    xn = _layernorm(x, axis=-1)
    return x + _A_ref(xn, A_wqkv, A_wo) + _B_ref(xn, B_w_in, B_w_sp, B_b_sp, B_w_out)
```

```asm
; @launch kernel=parallel_sum__softmax_full_mha__mixer_gmlp__prompt_kernel grid=(256,1,1) block=(256,1,1) lds=163840
; @launch kernel=k23_kernel grid=(256,1,1) block=(256,1,1) lds=161792
.amdgcn_target "amdgcn-amd-amdhsa--gfx950"
.text
.globl parallel_sum__softmax_full_mha__mixer_gmlp__prompt_kernel
.p2align 8
.type parallel_sum__softmax_full_mha__mixer_gmlp__prompt_kernel,@function
parallel_sum__softmax_full_mha__mixer_gmlp__prompt_kernel:
  s_cmp_ge_u32 s2, 256
  s_cbranch_scc1 K1_END
  s_load_dwordx2 s[4:5], s[0:1], 0
  s_load_dwordx2 s[8:9], s[0:1], 8
  s_load_dwordx2 s[16:17], s[0:1], 32
  s_load_dwordx2 s[20:21], s[0:1], 16
  s_load_dwordx2 s[22:23], s[0:1], 56
  s_load_dwordx2 s[24:25], s[0:1], 72
  s_load_dwordx2 s[12:13], s[0:1], 80
  s_load_dwordx2 s[100:101], s[0:1], 40
  s_getpc_b64 s[32:33]
K1_PC:
  s_bfe_u32 s34, s2, 0x20003
  s_lshl_b32 s34, s34, 15
  v_lshl_add_u32 v224, v0, 7, s34
  v_min_u32 v224, CODE_END-K1_PC-4, v224
  v_mov_b32 v225, s33
  v_add_co_u32 v224, vcc, s32, v224
  v_addc_co_u32 v225, vcc, 0, v225, vcc
  global_load_dword v226, v[224:225], off
  v_lshrrev_b32 v1, 6, v0
  v_and_b32 v0, 63, v0
  v_readfirstlane_b32 s28, v1
  s_bfe_u32 s32, s2, 0x20001
  s_bfe_u32 s33, s2, 0x20003
  s_lshl_b32 s32, s32, 4
  s_lshl_b32 s33, s33, 2
  s_add_u32 s29, s32, s33
  s_add_u32 s29, s29, s28
  s_mul_i32 s36, s28, 40960
  s_bfe_u32 s32, s2, 0x20003
  s_lshr_b32 s33, s2, 5
  s_add_u32 s32, s32, s33
  s_mul_i32 s33, s32, 52
  s_lshr_b32 s33, s33, 8
  s_mul_i32 s33, s33, 5
  s_sub_u32 s32, s32, s33
  s_mul_i32 s84, s32, 128
  s_mul_i32 s32, s29, 40960
  s_lshr_b32 s33, s28, 1
  s_lshl_b32 s33, s33, 7
  s_add_u32 s89, s32, s33
  s_lshl1_add_u32 s46, s84, s89
  s_xor_b32 s47, s46, 128
  s_and_b32 s33, s28, 1
  s_lshl_b32 s33, s33, 2
  v_lshrrev_b32 v84, 3, v0
  v_and_b32 v85, 7, v0
  v_lshrrev_b32 v86, 4, v0
  v_xor_b32 v86, v85, v86
  v_xor_b32 v86, s33, v86
  v_mul_u32_u24 v2, 1280, v84
  v_lshl_add_u32 v2, v86, 4, v2
  v_xor_b32 v3, 64, v2
  v_add_u32 v3, 9216, v3
  v_add_u32 v4, 18432, v2
  v_add_u32 v5, 18432, v3
  s_add_u32 s42, s36, 24576
  s_add_u32 s43, s36, 28672
  s_mov_b32 s6, 2621440
  s_mov_b32 s7, 0x20000
  s_and_b32 s32, s2, 1
  s_lshl_b32 s32, s32, 3
  s_lshr_b32 s33, s2, 5
  s_add_u32 s32, s32, s33
  s_sub_u32 s30, s32, 8
  s_min_u32 s31, s32, 8
  s_add_u32 s32, s31, 4
  s_add_u32 s33, s31, 18
  s_cmp_lt_u32 s31, 2
  s_cselect_b32 s32, s33, s32
  s_cmp_eq_u32 s31, 2
  s_cselect_b32 s32, 29, s32
  s_lshl_b32 s33, s30, 1
  s_add_u32 s33, s33, 13
  s_cmp_lt_u32 s30, 7
  s_cselect_b32 s76, s33, s32
  s_lshl_b32 s92, s76, 7
  s_movk_i32 s34, 3456
  s_cmp_lt_u32 s31, 3
  s_cmovk_i32 s34, 3840
  s_mul_i32 s56, s84, s34
  s_add_u32 s56, s56, s92
  v_lshl_add_u32 v84, s28, 5, v84
  v_lshrrev_b32 v86, 2, v0
  v_and_b32 v86, 4, v86
  v_xor_b32 v85, v85, v86
  v_lshlrev_b32 v85, 4, v85
  v_mad_u32_u24 v10, v84, s34, v85
  s_lshl_b32 s35, s34, 3
  s_sub_u32 s35, s35, 1024
  v_add_u32 v11, s35, v10
  v_add_u32 v12, s35, v11
  v_add_u32 v13, s35, v12
  s_mul_i32 s10, s34, 640
  s_mov_b32 s11, 0x20000
  s_mov_b32 m0, s42
  s_waitcnt lgkmcnt(0)
  s_bfe_u32 s32, s2, 0x20001
  s_lshl_b32 s32, s32, 21
  s_lshr_b32 s33, s2, 3
  s_lshl_b32 s33, s33, 16
  s_add_u32 s32, s32, s33
  s_and_b32 s33, s2, 1
  s_lshl2_add_u32 s33, s33, s28
  s_lshl_b32 s33, s33, 13
  s_add_u32 s32, s32, s33
  s_add_u32 s100, s32, s100
  s_addc_u32 s101, s101, 0
  buffer_load_dwordx4 v2, s[4:7], s46 offen offset:0 lds
  s_mov_b32 s32, s8
  s_mov_b32 s33, s9
  buffer_load_dwordx4 v3, s[4:7], s46 offen offset:1024 lds
  s_cmp_lt_u32 s31, 3
  s_cselect_b32 s8, s8, s16
  buffer_load_dwordx4 v4, s[4:7], s46 offen offset:2048 lds
  s_cselect_b32 s9, s9, s17
  s_cmp_lt_u32 s30, 7
  buffer_load_dwordx4 v5, s[4:7], s46 offen offset:3072 lds
  s_cselect_b32 s16, s16, s32
  s_cselect_b32 s17, s17, s33
  s_mov_b32 m0, s43
  s_nop 0
  buffer_load_dwordx4 v2, s[4:7], s47 offen offset:0 lds
  s_add_u32 s44, s36, 32768
  s_add_u32 s45, s36, 36864
  s_add_u32 s85, s84, 128
  buffer_load_dwordx4 v3, s[4:7], s47 offen offset:1024 lds
  s_cmp_eq_u32 s85, 640
  s_cmov_b32 s85, 0
  s_lshl1_add_u32 s48, s85, s89
  buffer_load_dwordx4 v4, s[4:7], s47 offen offset:2048 lds
  s_xor_b32 s49, s48, 128
  s_mul_i32 s57, s85, s34
  s_add_u32 s57, s57, s92
  buffer_load_dwordx4 v5, s[4:7], s47 offen offset:3072 lds
  s_add_u32 s37, s36, 4096
  s_add_u32 s86, s85, 128
  s_cmp_eq_u32 s86, 640
  s_mov_b32 m0, s36
  s_nop 0
  buffer_load_dwordx4 v10, s[8:11], s56 offen offset:0 lds
  s_cmov_b32 s86, 0
  s_lshl1_add_u32 s50, s86, s89
  s_xor_b32 s51, s50, 128
  buffer_load_dwordx4 v11, s[8:11], s56 offen offset:1024 lds
  s_mul_i32 s58, s86, s34
  s_add_u32 s58, s58, s92
  s_add_u32 s40, s36, 16384
  buffer_load_dwordx4 v12, s[8:11], s56 offen offset:2048 lds
  s_add_u32 s41, s36, 20480
  s_add_u32 s38, s36, 8192
  s_add_u32 s39, s36, 12288
  buffer_load_dwordx4 v13, s[8:11], s56 offen offset:3072 lds
  s_add_u32 s87, s86, 128
  s_cmp_eq_u32 s87, 640
  s_cmov_b32 s87, 0
  s_mov_b32 m0, s44
  s_nop 0
  buffer_load_dwordx4 v2, s[4:7], s48 offen offset:0 lds
  s_lshl1_add_u32 s52, s87, s89
  s_xor_b32 s53, s52, 128
  s_mul_i32 s59, s87, s34
  s_add_u32 s59, s59, s92
  s_add_u32 s88, s87, 128
  s_cmp_eq_u32 s88, 640
  s_cmov_b32 s88, 0
  s_lshl1_add_u32 s54, s88, s89
  buffer_load_dwordx4 v3, s[4:7], s48 offen offset:1024 lds
  s_xor_b32 s55, s54, 128
  s_mul_i32 s60, s88, s34
  s_add_u32 s60, s60, s92
  v_and_b32 v86, 31, v0
  v_lshrrev_b32 v87, 5, v0
  v_bfe_u32 v88, v0, 1, 3
  v_xor_b32 v88, v87, v88
  v_lshlrev_b32 v88, 4, v88
  buffer_load_dwordx4 v4, s[4:7], s48 offen offset:2048 lds
  v_lshl_add_u32 v88, v86, 7, v88
  v_add_u32 v6, s36, v88
  v_xor_b32 v7, 32, v6
  v_xor_b32 v8, 64, v6
  v_xor_b32 v9, 0x60, v6
  v_lshrrev_b32 v88, 4, v0
  v_bfe_u32 v89, v0, 2, 2
  v_and_b32 v90, 3, v0
  buffer_load_dwordx4 v5, s[4:7], s48 offen offset:3072 lds
  v_lshl_add_u32 v91, v87, 3, v89
  v_lshlrev_b32 v18, 7, v91
  v_lshrrev_b32 v92, 1, v89
  v_lshl_or_b32 v18, v92, 6, v18
  v_and_b32 v93, 1, v88
  v_lshl_or_b32 v18, v93, 5, v18
  v_and_b32 v94, 1, v90
  v_lshl_or_b32 v18, v94, 4, v18
  s_mov_b32 m0, s45
  s_nop 0
  buffer_load_dwordx4 v2, s[4:7], s49 offen offset:0 lds
  v_lshrrev_b32 v95, 1, v90
  v_lshl_or_b32 v18, v95, 3, v18
  s_xor_b32 s32, s28, 1
  s_mul_i32 s32, s32, 40960
  v_add_u32 v19, s32, v18
  s_xor_b32 s32, s28, 2
  s_mul_i32 s32, s32, 40960
  v_add_u32 v20, s32, v18
  buffer_load_dwordx4 v3, s[4:7], s49 offen offset:1024 lds
  s_xor_b32 s32, s28, 3
  s_mul_i32 s32, s32, 40960
  v_add_u32 v21, s32, v18
  v_add_u32 v18, s36, v18
  v_xor_b32 v22, 64, v18
  v_xor_b32 v23, 64, v19
  v_xor_b32 v24, 64, v20
  v_xor_b32 v25, 64, v21
  buffer_load_dwordx4 v4, s[4:7], s49 offen offset:2048 lds
  v_bfe_u32 v96, v0, 3, 1
  v_xor_b32 v96, v96, v87
  v_and_b32 v97, 6, v0
  v_or_b32 v96, v96, v97
  v_mov_b32 v97, 0x3f803f80
  v_cmp_eq_u32 vcc, 0, v96
  v_mov_b32 v48, 0
  v_mov_b32 v49, 0
  buffer_load_dwordx4 v5, s[4:7], s49 offen offset:3072 lds
  v_cndmask_b32 v40, 0, v97, vcc
  v_cndmask_b32 v41, 0, v97, vcc
  v_cmp_eq_u32 vcc, 4, v96
  v_mov_b32 v50, 0
  v_mov_b32 v51, 0
  v_cndmask_b32 v42, 0, v97, vcc
  v_cndmask_b32 v43, 0, v97, vcc
  v_mul_u32_u24 v44, 0xaaaa, v94
  s_mov_b32 m0, s37
  s_nop 0
  buffer_load_dwordx4 v10, s[8:11], s57 offen offset:0 lds
  v_add_u32 v44, 0x4444, v44
  v_mov_b32 v52, 0
  v_mov_b32 v53, 0
  v_mov_b32 v54, 0
  v_mov_b32 v55, 0
  s_movk_i32 s34, 3840
  s_cmp_lt_u32 s30, 7
  s_cmovk_i32 s34, 3456
  buffer_load_dwordx4 v11, s[8:11], s57 offen offset:1024 lds
  s_mul_i32 s18, s34, 640
  s_mov_b32 s19, 0x20000
  v_mad_u32_u24 v14, v84, s34, v85
  s_lshl_b32 s35, s34, 3
  s_sub_u32 s35, s35, 1024
  v_add_u32 v15, s35, v14
  v_add_u32 v16, s35, v15
  v_add_u32 v17, s35, v16
  buffer_load_dwordx4 v12, s[8:11], s57 offen offset:2048 lds
  s_add_u32 s32, s76, 1
  s_add_u32 s33, s31, 20
  s_lshl_b32 s35, s31, 1
  s_cmp_lt_u32 s30, 7
  s_cselect_b32 s77, s32, s33
  s_cselect_b32 s78, s30, s35
  s_add_u32 s79, s35, 1
  s_mul_i32 s84, s84, s34
  buffer_load_dwordx4 v13, s[8:11], s57 offen offset:3072 lds
  s_mul_i32 s85, s85, s34
  s_mul_i32 s86, s86, s34
  s_mul_i32 s87, s87, s34
  s_mul_i32 s88, s88, s34
  s_lshl_b32 s32, s77, 7
  s_add_u32 s61, s84, s32
  s_add_u32 s62, s85, s32
  s_add_u32 s63, s86, s32
  s_mov_b32 m0, s40
  s_nop 0
  buffer_load_dwordx4 v2, s[4:7], s50 offen offset:0 lds
  s_add_u32 s64, s87, s32
  s_add_u32 s65, s88, s32
  s_lshl_b32 s32, s78, 7
  s_add_u32 s66, s84, s32
  s_add_u32 s67, s85, s32
  s_add_u32 s68, s86, s32
  s_add_u32 s69, s87, s32
  s_add_u32 s70, s88, s32
  buffer_load_dwordx4 v3, s[4:7], s50 offen offset:1024 lds
  s_lshl_b32 s32, s79, 7
  s_add_u32 s71, s84, s32
  s_add_u32 s72, s85, s32
  s_add_u32 s73, s86, s32
  s_add_u32 s74, s87, s32
  s_add_u32 s75, s88, s32
  v_lshlrev_b32 v1, 4, v0
  v_lshl_add_u32 v30, v88, 1, v95
  buffer_load_dwordx4 v4, s[4:7], s50 offen offset:2048 lds
  v_lshlrev_b32 v92, 2, v92
  v_xor_b32 v30, v30, v92
  v_lshlrev_b32 v30, 4, v30
  v_lshl_or_b32 v30, v94, 3, v30
  v_lshl_or_b32 v30, v89, 7, v30
  v_add_u32 v30, s36, v30
  v_xor_b32 v31, 16, v30
  v_xor_b32 v32, 32, v30
  buffer_load_dwordx4 v5, s[4:7], s50 offen offset:3072 lds
  v_xor_b32 v33, 48, v30
  v_and_b32 v92, 2, v0
  v_lshl_or_b32 v92, v92, 1, v89
  v_xor_b32 v92, v92, v87
  v_lshlrev_b32 v26, 7, v86
  v_lshl_or_b32 v26, v92, 4, v26
  v_add_u32 v26, s36, v26
  v_xor_b32 v27, 32, v26
  s_mov_b32 m0, s41
  s_nop 0
  buffer_load_dwordx4 v2, s[4:7], s51 offen offset:0 lds
  v_xor_b32 v28, 64, v26
  v_xor_b32 v29, 0x60, v26
  v_mov_b32 v38, 38912
  v_lshl_add_u32 v38, v0, 2, v38
  v_add_u32 v39, 81920, v38
  v_add_u32 v37, s36, v38
  v_and_b32 v34, 3, v84
  v_bfe_u32 v35, v84, 2, 1
  buffer_load_dwordx4 v3, s[4:7], s51 offen offset:1024 lds
  v_mul_u32_u24 v36, 48128, v93
  v_lshl_add_u32 v36, v87, 8, v36
  v_lshl_add_u32 v36, v90, 4, v36
  v_and_b32 v92, 4, v0
  v_and_b32 v96, 8, v0
  v_lshlrev_b32 v92, 5, v92
  v_lshl_add_u32 v92, v96, 3, v92
  v_add_u32 v36, v92, v36
  buffer_load_dwordx4 v4, s[4:7], s51 offen offset:2048 lds
  v_lshl_add_u32 v79, v87, 17, v92
  v_and_b32 v92, 0x13, v0
  v_lshl_add_u32 v79, v92, 4, v79
  v_lshlrev_b32 v120, 3, v86
  v_lshlrev_b32 v121, 8, v0
  v_mov_b32 v83, 1
  s_mov_b32 s14, 268435456
  s_mov_b32 s15, 0x20000
  buffer_load_dwordx4 v5, s[4:7], s51 offen offset:3072 lds
  s_mov_b32 s26, 256
  s_mov_b32 s27, 0x20000
  s_lshl_b32 s32, s2, 2
  s_add_u32 s32, s32, s28
  s_min_u32 s32, s32, 939
  s_mul_i32 s33, s32, 6554
  s_lshr_b32 s33, s33, 16
  s_mul_i32 s34, s33, 10
  s_mov_b32 m0, s38
  s_nop 0
  buffer_load_dwordx4 v10, s[8:11], s58 offen offset:0 lds
  s_sub_u32 s34, s32, s34
  s_sub_u32 s35, s33, 40
  s_cmp_lt_u32 s33, 40
  s_cselect_b32 s35, s33, s35
  s_cselect_b32 s20, s20, s22
  s_cselect_b32 s21, s21, s23
  s_mov_b32 s22, 1105920
  s_cmov_b32 s22, 819200
  buffer_load_dwordx4 v11, s[8:11], s58 offen offset:1024 lds
  s_mov_b32 s23, 0x20000
  s_lshl_b32 s35, s35, 4
  s_mul_i32 s32, s33, 20
  s_sub_u32 s32, s32, 160
  s_cmp_lt_u32 s33, 40
  s_cselect_b32 s35, s32, s35
  s_cselect_b32 s81, 8, 4
  s_movk_i32 s80, 9216
  buffer_load_dwordx4 v12, s[8:11], s58 offen offset:2048 lds
  s_cmovk_i32 s80, 4096
  s_and_b32 s32, s33, 6
  s_add_u32 s32, s32, s33
  s_mul_i32 s32, s32, 40
  s_add_u32 s32, s32, 16
  s_cmp_lt_u32 s33, 8
  s_cselect_b32 s35, s32, s35
  s_mov_b32 s32, s81
  buffer_load_dwordx4 v13, s[8:11], s58 offen offset:3072 lds
  s_cmovk_i32 s32, 80
  s_cmovk_i32 s80, 24576
  s_mul_i32 s35, s35, 1280
  v_mad_u32_u24 v34, v35, s32, v34
  v_mul_u32_u24 v34, 1280, v34
  v_add_u32 v34, v34, v85
  v_add_u32 v35, s80, v34
  s_lshl_b32 s32, s34, 7
  s_add_u32 s80, s35, s32
  s_mul_i32 s34, s34, 376
  s_add_u32 s34, s34, s33
  s_lshl_b32 s34, s34, 9
  s_add_u32 s81, s34, 23724032
  s_mul_i32 s32, s29, 122880
  s_add_u32 s32, s32, 0
  s_mul_i32 s33, s29, 55296
  s_add_u32 s33, s33, 14024704
  s_cmp_lt_u32 s31, 3
  s_cselect_b32 s34, s32, s33
  s_cmp_lt_u32 s30, 7
  s_cselect_b32 s35, s33, s32
  s_lshl_b32 s76, s76, 12
  s_add_u32 s76, s76, s34
  s_lshl_b32 s77, s77, 12
  s_add_u32 s77, s77, s35
  s_lshl_b32 s78, s78, 12
  s_add_u32 s78, s78, s35
  s_lshl_b32 s79, s79, 12
  s_add_u32 s79, s79, s35
  s_cmp_lt_u32 s31, 5
  s_cselect_b32 s82, 0x3ea52b5c, 1.0
  s_cmp_eq_u32 s30, 0
  s_cselect_b32 s83, 0, 1.0
  s_mov_b32 s84, 0x22222222
  s_mov_b32 s85, s84
  s_lshl_b64 s[86:87], s[84:85], 1
  s_lshl_b64 s[88:89], s[84:85], 2
  s_mov_b32 s90, -1
  s_mov_b32 s91, 0
  s_lshl_b32 s32, s30, 19
  s_lshl_b32 s33, s29, 11
  s_add_u32 s32, s32, s33
  s_add_u32 s92, s32, 10354688
  s_lshr_b32 s32, s29, 2
  s_mul_i32 s32, s32, 7168
  s_lshl_b32 s33, s28, 8
  s_add_u32 s32, s32, s33
  s_add_u32 s93, s32, 25649152
  s_lshl_b32 s29, s29, 2
  s_waitcnt vmcnt(28)
  ds_read_b128 a[0:3], v6 offset:24576
  ds_read_b128 a[4:7], v7 offset:24576
  ds_read_b128 a[8:11], v8 offset:24576
  ds_read_b128 a[12:15], v9 offset:24576
  ds_read_b128 a[16:19], v6 offset:28672
  ds_read_b128 a[20:23], v7 offset:28672
  ds_read_b128 a[24:27], v8 offset:28672
  ds_read_b128 a[28:31], v9 offset:28672
  s_waitcnt vmcnt(24)
  s_barrier
  ds_read_b64_tr_b16 v[128:129], v18 offset:0
  ds_read_b64_tr_b16 v[130:131], v18 offset:512
  ds_read_b64_tr_b16 v[132:133], v22 offset:0
  ds_read_b64_tr_b16 v[134:135], v22 offset:512
  ds_read_b64_tr_b16 v[136:137], v18 offset:2048
  ds_read_b64_tr_b16 v[138:139], v18 offset:2560
  ds_read_b64_tr_b16 v[140:141], v22 offset:2048
  ds_read_b64_tr_b16 v[142:143], v22 offset:2560
  ds_read_b64_tr_b16 v[144:145], v19 offset:0
  ds_read_b64_tr_b16 v[146:147], v19 offset:512
  ds_read_b64_tr_b16 v[148:149], v23 offset:0
  ds_read_b64_tr_b16 v[150:151], v23 offset:512
  s_waitcnt lgkmcnt(8)
  v_mfma_f32_32x32x16_bf16 v[160:175], v[128:131], a[0:3], 0
  ds_read_b64_tr_b16 v[152:153], v19 offset:2048
  ds_read_b64_tr_b16 v[154:155], v19 offset:2560
  s_mov_b32 m0, s39
  s_nop 0
  v_mfma_f32_32x32x16_bf16 v[176:191], v[132:135], a[0:3], 0
  ds_read_b64_tr_b16 v[156:157], v23 offset:2048
  ds_read_b64_tr_b16 v[158:159], v23 offset:2560
  buffer_load_dwordx4 v10, s[8:11], s59 offen offset:0 lds
  v_smfmac_f32_16x16x64_bf16 v[48:51], v[40:43], v[128:135], v44
  s_waitcnt lgkmcnt(8)
  s_nop 0
  v_smfmac_f32_16x16x64_bf16 v[48:51], v[40:43], v[136:143], v44
  v_smfmac_f32_16x16x64_bf16 v[52:55], v[40:43], a[0:7], v44
  buffer_load_dwordx4 v11, s[8:11], s59 offen offset:1024 lds
  v_smfmac_f32_16x16x64_bf16 v[52:55], v[40:43], a[8:15], v44
  buffer_load_dwordx4 v12, s[8:11], s59 offen offset:2048 lds
  v_smfmac_f32_16x16x64_bf16 v[52:55], v[40:43], a[16:23], v44
  buffer_load_dwordx4 v13, s[8:11], s59 offen offset:3072 lds
  s_mov_b32 m0, s42
  s_nop 0
  v_smfmac_f32_16x16x64_bf16 v[52:55], v[40:43], a[24:31], v44
  buffer_load_dwordx4 v2, s[4:7], s52 offen offset:0 lds
  v_mfma_f32_4x4x4_16b_bf16 v[56:59], a[0:1], a[0:1], 0
  v_mfma_f32_4x4x4_16b_bf16 v[60:63], a[2:3], a[2:3], 0
  v_mfma_f32_4x4x4_16b_bf16 v[64:67], a[4:5], a[4:5], 0
  v_mfma_f32_4x4x4_16b_bf16 v[56:59], a[6:7], a[6:7], v[56:59]
  v_mfma_f32_4x4x4_16b_bf16 v[60:63], a[8:9], a[8:9], v[60:63]
  v_mfma_f32_4x4x4_16b_bf16 v[64:67], a[10:11], a[10:11], v[64:67]
  v_mfma_f32_4x4x4_16b_bf16 v[56:59], a[12:13], a[12:13], v[56:59]
  v_mfma_f32_4x4x4_16b_bf16 v[60:63], a[14:15], a[14:15], v[60:63]
  v_mfma_f32_4x4x4_16b_bf16 v[64:67], a[16:17], a[16:17], v[64:67]
  v_mfma_f32_4x4x4_16b_bf16 v[56:59], a[18:19], a[18:19], v[56:59]
  v_mfma_f32_4x4x4_16b_bf16 v[60:63], a[20:21], a[20:21], v[60:63]
  v_mfma_f32_4x4x4_16b_bf16 v[64:67], a[22:23], a[22:23], v[64:67]
  v_mfma_f32_4x4x4_16b_bf16 v[56:59], a[24:25], a[24:25], v[56:59]
  v_mfma_f32_4x4x4_16b_bf16 v[60:63], a[26:27], a[26:27], v[60:63]
  v_mfma_f32_4x4x4_16b_bf16 v[64:67], a[28:29], a[28:29], v[64:67]
  v_mfma_f32_4x4x4_16b_bf16 v[56:59], a[30:31], a[30:31], v[56:59]
  v_mfma_f32_32x32x16_bf16 v[160:175], v[136:139], a[4:7], v[160:175]
  ds_read_b64_tr_b16 v[128:129], v20 offset:0
  ds_read_b64_tr_b16 v[130:131], v20 offset:512
  buffer_load_dwordx4 v3, s[4:7], s52 offen offset:1024 lds
  v_mfma_f32_32x32x16_bf16 v[176:191], v[140:143], a[4:7], v[176:191]
  ds_read_b64_tr_b16 v[132:133], v24 offset:0
  ds_read_b64_tr_b16 v[134:135], v24 offset:512
  buffer_load_dwordx4 v4, s[4:7], s52 offen offset:2048 lds
  s_waitcnt lgkmcnt(8)
  s_nop 0
  v_mfma_f32_32x32x16_bf16 v[160:175], v[144:147], a[8:11], v[160:175]
  ds_read_b64_tr_b16 v[136:137], v20 offset:2048
  ds_read_b64_tr_b16 v[138:139], v20 offset:2560
  buffer_load_dwordx4 v5, s[4:7], s52 offen offset:3072 lds
  s_mov_b32 m0, s43
  s_nop 0
  v_mfma_f32_32x32x16_bf16 v[176:191], v[148:151], a[8:11], v[176:191]
  ds_read_b64_tr_b16 v[140:141], v24 offset:2048
  ds_read_b64_tr_b16 v[142:143], v24 offset:2560
  buffer_load_dwordx4 v2, s[4:7], s53 offen offset:0 lds
  s_waitcnt lgkmcnt(8)
  s_nop 0
  v_mfma_f32_32x32x16_bf16 v[160:175], v[152:155], a[12:15], v[160:175]
  ds_read_b64_tr_b16 v[144:145], v21 offset:0
  ds_read_b64_tr_b16 v[146:147], v21 offset:512
  buffer_load_dwordx4 v3, s[4:7], s53 offen offset:1024 lds
  v_mfma_f32_32x32x16_bf16 v[176:191], v[156:159], a[12:15], v[176:191]
  ds_read_b64_tr_b16 v[148:149], v25 offset:0
  ds_read_b64_tr_b16 v[150:151], v25 offset:512
  buffer_load_dwordx4 v4, s[4:7], s53 offen offset:2048 lds
  s_waitcnt lgkmcnt(8)
  s_nop 0
  v_mfma_f32_32x32x16_bf16 v[160:175], v[128:131], a[16:19], v[160:175]
  ds_read_b64_tr_b16 v[152:153], v21 offset:2048
  ds_read_b64_tr_b16 v[154:155], v21 offset:2560
  buffer_load_dwordx4 v5, s[4:7], s53 offen offset:3072 lds
  v_mfma_f32_32x32x16_bf16 v[176:191], v[132:135], a[16:19], v[176:191]
  ds_read_b64_tr_b16 v[156:157], v25 offset:2048
  ds_read_b64_tr_b16 v[158:159], v25 offset:2560
  s_waitcnt lgkmcnt(8)
  s_nop 0
  v_mfma_f32_32x32x16_bf16 v[160:175], v[136:139], a[20:23], v[160:175]
  s_waitcnt vmcnt(24)
  s_barrier
  ds_read_b64_tr_b16 v[128:129], v18 offset:4096
  ds_read_b64_tr_b16 v[130:131], v18 offset:4608
  ds_read_b128 a[32:35], v6 offset:32768
  ds_read_b128 a[36:39], v7 offset:32768
  v_mfma_f32_32x32x16_bf16 v[176:191], v[140:143], a[20:23], v[176:191]
  ds_read_b64_tr_b16 v[132:133], v22 offset:4096
  ds_read_b64_tr_b16 v[134:135], v22 offset:4608
  ds_read_b128 a[40:43], v8 offset:32768
  ds_read_b128 a[44:47], v9 offset:32768
  s_waitcnt lgkmcnt(12)
  s_nop 0
  v_mfma_f32_32x32x16_bf16 v[160:175], v[144:147], a[24:27], v[160:175]
  ds_read_b64_tr_b16 v[136:137], v18 offset:6144
  ds_read_b64_tr_b16 v[138:139], v18 offset:6656
  ds_read_b128 a[48:51], v6 offset:36864
  v_mfma_f32_32x32x16_bf16 v[176:191], v[148:151], a[24:27], v[176:191]
  ds_read_b64_tr_b16 v[140:141], v22 offset:6144
  ds_read_b64_tr_b16 v[142:143], v22 offset:6656
  ds_read_b128 a[52:55], v7 offset:36864
  s_waitcnt lgkmcnt(14)
  s_nop 0
  v_mfma_f32_32x32x16_bf16 v[160:175], v[152:155], a[28:31], v[160:175]
  ds_read_b64_tr_b16 v[144:145], v19 offset:4096
  ds_read_b64_tr_b16 v[146:147], v19 offset:4608
  ds_read_b128 a[56:59], v8 offset:36864
  v_mfma_f32_32x32x16_bf16 v[176:191], v[156:159], a[28:31], v[176:191]
  ds_read_b64_tr_b16 v[148:149], v23 offset:4096
  ds_read_b64_tr_b16 v[150:151], v23 offset:4608
  ds_read_b128 a[60:63], v9 offset:36864
  s_waitcnt lgkmcnt(14)
  s_nop 0
  v_mfma_f32_32x32x16_bf16 v[160:175], v[128:131], a[32:35], v[160:175]
  ds_read_b64_tr_b16 v[152:153], v19 offset:6144
  ds_read_b64_tr_b16 v[154:155], v19 offset:6656
  v_mfma_f32_32x32x16_bf16 v[176:191], v[132:135], a[32:35], v[176:191]
  ds_read_b64_tr_b16 v[156:157], v23 offset:6144
  ds_read_b64_tr_b16 v[158:159], v23 offset:6656
  v_smfmac_f32_16x16x64_bf16 v[48:51], v[40:43], v[128:135], v44
  s_waitcnt lgkmcnt(11)
  s_nop 0
  v_smfmac_f32_16x16x64_bf16 v[48:51], v[40:43], v[136:143], v44
  s_waitcnt lgkmcnt(4)
  s_nop 0
  v_smfmac_f32_16x16x64_bf16 v[52:55], v[40:43], a[32:39], v44
  s_mov_b32 m0, s44
  s_nop 0
  v_smfmac_f32_16x16x64_bf16 v[52:55], v[40:43], a[40:47], v44
  buffer_load_dwordx4 v2, s[4:7], s54 offen offset:0 lds
  v_smfmac_f32_16x16x64_bf16 v[52:55], v[40:43], a[48:55], v44
  buffer_load_dwordx4 v3, s[4:7], s54 offen offset:1024 lds
  v_smfmac_f32_16x16x64_bf16 v[52:55], v[40:43], a[56:63], v44
  buffer_load_dwordx4 v4, s[4:7], s54 offen offset:2048 lds
  v_mfma_f32_4x4x4_16b_bf16 v[56:59], a[32:33], a[32:33], v[56:59]
  v_mfma_f32_4x4x4_16b_bf16 v[60:63], a[34:35], a[34:35], v[60:63]
  v_mfma_f32_4x4x4_16b_bf16 v[64:67], a[36:37], a[36:37], v[64:67]
  v_mfma_f32_4x4x4_16b_bf16 v[56:59], a[38:39], a[38:39], v[56:59]
  v_mfma_f32_4x4x4_16b_bf16 v[60:63], a[40:41], a[40:41], v[60:63]
  v_mfma_f32_4x4x4_16b_bf16 v[64:67], a[42:43], a[42:43], v[64:67]
  v_mfma_f32_4x4x4_16b_bf16 v[56:59], a[44:45], a[44:45], v[56:59]
  v_mfma_f32_4x4x4_16b_bf16 v[60:63], a[46:47], a[46:47], v[60:63]
  v_mfma_f32_4x4x4_16b_bf16 v[64:67], a[48:49], a[48:49], v[64:67]
  v_mfma_f32_4x4x4_16b_bf16 v[56:59], a[50:51], a[50:51], v[56:59]
  v_mfma_f32_4x4x4_16b_bf16 v[60:63], a[52:53], a[52:53], v[60:63]
  v_mfma_f32_4x4x4_16b_bf16 v[64:67], a[54:55], a[54:55], v[64:67]
  v_mfma_f32_4x4x4_16b_bf16 v[56:59], a[56:57], a[56:57], v[56:59]
  v_mfma_f32_4x4x4_16b_bf16 v[60:63], a[58:59], a[58:59], v[60:63]
  v_mfma_f32_4x4x4_16b_bf16 v[64:67], a[60:61], a[60:61], v[64:67]
  v_mfma_f32_4x4x4_16b_bf16 v[56:59], a[62:63], a[62:63], v[56:59]
  v_mfma_f32_32x32x16_bf16 v[160:175], v[136:139], a[36:39], v[160:175]
  ds_read_b64_tr_b16 v[128:129], v20 offset:4096
  ds_read_b64_tr_b16 v[130:131], v20 offset:4608
  buffer_load_dwordx4 v5, s[4:7], s54 offen offset:3072 lds
  s_mov_b32 m0, s45
  s_nop 0
  v_mfma_f32_32x32x16_bf16 v[176:191], v[140:143], a[36:39], v[176:191]
  ds_read_b64_tr_b16 v[132:133], v24 offset:4096
  ds_read_b64_tr_b16 v[134:135], v24 offset:4608
  buffer_load_dwordx4 v2, s[4:7], s55 offen offset:0 lds
  v_mfma_f32_32x32x16_bf16 v[160:175], v[144:147], a[40:43], v[160:175]
  ds_read_b64_tr_b16 v[136:137], v20 offset:6144
  ds_read_b64_tr_b16 v[138:139], v20 offset:6656
  buffer_load_dwordx4 v3, s[4:7], s55 offen offset:1024 lds
  v_mfma_f32_32x32x16_bf16 v[176:191], v[148:151], a[40:43], v[176:191]
  ds_read_b64_tr_b16 v[140:141], v24 offset:6144
  ds_read_b64_tr_b16 v[142:143], v24 offset:6656
  buffer_load_dwordx4 v4, s[4:7], s55 offen offset:2048 lds
  s_waitcnt lgkmcnt(8)
  s_nop 0
  v_mfma_f32_32x32x16_bf16 v[160:175], v[152:155], a[44:47], v[160:175]
  ds_read_b64_tr_b16 v[144:145], v21 offset:4096
  ds_read_b64_tr_b16 v[146:147], v21 offset:4608
  buffer_load_dwordx4 v5, s[4:7], s55 offen offset:3072 lds
  v_mfma_f32_32x32x16_bf16 v[176:191], v[156:159], a[44:47], v[176:191]
  ds_read_b64_tr_b16 v[148:149], v25 offset:4096
  ds_read_b64_tr_b16 v[150:151], v25 offset:4608
  s_waitcnt lgkmcnt(8)
  s_nop 0
  v_mfma_f32_32x32x16_bf16 v[160:175], v[128:131], a[48:51], v[160:175]
  ds_read_b64_tr_b16 v[152:153], v21 offset:6144
  ds_read_b64_tr_b16 v[154:155], v21 offset:6656
  v_mfma_f32_32x32x16_bf16 v[176:191], v[132:135], a[48:51], v[176:191]
  ds_read_b64_tr_b16 v[156:157], v25 offset:6144
  ds_read_b64_tr_b16 v[158:159], v25 offset:6656
  s_waitcnt lgkmcnt(8)
  s_nop 0
  v_mfma_f32_32x32x16_bf16 v[160:175], v[136:139], a[52:55], v[160:175]
  s_waitcnt vmcnt(20)
  s_barrier
  ds_read_b64_tr_b16 v[128:129], v18 offset:8192
  ds_read_b64_tr_b16 v[130:131], v18 offset:8704
  ds_read_b128 a[64:67], v6 offset:16384
  ds_read_b128 a[68:71], v7 offset:16384
  v_mfma_f32_32x32x16_bf16 v[176:191], v[140:143], a[52:55], v[176:191]
  ds_read_b64_tr_b16 v[132:133], v22 offset:8192
  ds_read_b64_tr_b16 v[134:135], v22 offset:8704
  ds_read_b128 a[72:75], v8 offset:16384
  ds_read_b128 a[76:79], v9 offset:16384
  s_mov_b32 m0, s36
  s_waitcnt lgkmcnt(12)
  v_mfma_f32_32x32x16_bf16 v[160:175], v[144:147], a[56:59], v[160:175]
  ds_read_b64_tr_b16 v[136:137], v18 offset:10240
  ds_read_b64_tr_b16 v[138:139], v18 offset:10752
  ds_read_b128 a[80:83], v6 offset:20480
  buffer_load_dwordx4 v10, s[8:11], s60 offen offset:0 lds
  v_mfma_f32_32x32x16_bf16 v[176:191], v[148:151], a[56:59], v[176:191]
  ds_read_b64_tr_b16 v[140:141], v22 offset:10240
  ds_read_b64_tr_b16 v[142:143], v22 offset:10752
  ds_read_b128 a[84:87], v7 offset:20480
  buffer_load_dwordx4 v11, s[8:11], s60 offen offset:1024 lds
  s_waitcnt lgkmcnt(14)
  s_nop 0
  v_mfma_f32_32x32x16_bf16 v[160:175], v[152:155], a[60:63], v[160:175]
  ds_read_b64_tr_b16 v[144:145], v19 offset:8192
  ds_read_b64_tr_b16 v[146:147], v19 offset:8704
  ds_read_b128 a[88:91], v8 offset:20480
  buffer_load_dwordx4 v12, s[8:11], s60 offen offset:2048 lds
  v_mfma_f32_32x32x16_bf16 v[176:191], v[156:159], a[60:63], v[176:191]
  ds_read_b64_tr_b16 v[148:149], v23 offset:8192
  ds_read_b64_tr_b16 v[150:151], v23 offset:8704
  ds_read_b128 a[92:95], v9 offset:20480
  buffer_load_dwordx4 v13, s[8:11], s60 offen offset:3072 lds
  s_waitcnt lgkmcnt(14)
  s_nop 0
  v_mfma_f32_32x32x16_bf16 v[160:175], v[128:131], a[64:67], v[160:175]
  ds_read_b64_tr_b16 v[152:153], v19 offset:10240
  ds_read_b64_tr_b16 v[154:155], v19 offset:10752
  v_mfma_f32_32x32x16_bf16 v[176:191], v[132:135], a[64:67], v[176:191]
  ds_read_b64_tr_b16 v[156:157], v23 offset:10240
  ds_read_b64_tr_b16 v[158:159], v23 offset:10752
  v_smfmac_f32_16x16x64_bf16 v[48:51], v[40:43], v[128:135], v44
  s_waitcnt lgkmcnt(11)
  s_nop 0
  v_smfmac_f32_16x16x64_bf16 v[48:51], v[40:43], v[136:143], v44
  s_waitcnt lgkmcnt(4)
  s_nop 0
  v_smfmac_f32_16x16x64_bf16 v[52:55], v[40:43], a[64:71], v44
  s_mov_b32 m0, s40
  s_nop 0
  v_smfmac_f32_16x16x64_bf16 v[52:55], v[40:43], a[72:79], v44
  buffer_load_dwordx4 v14, s[16:19], s61 offen offset:0 lds
  v_smfmac_f32_16x16x64_bf16 v[52:55], v[40:43], a[80:87], v44
  buffer_load_dwordx4 v15, s[16:19], s61 offen offset:1024 lds
  v_smfmac_f32_16x16x64_bf16 v[52:55], v[40:43], a[88:95], v44
  buffer_load_dwordx4 v16, s[16:19], s61 offen offset:2048 lds
  v_mfma_f32_4x4x4_16b_bf16 v[56:59], a[64:65], a[64:65], v[56:59]
  v_mfma_f32_4x4x4_16b_bf16 v[60:63], a[66:67], a[66:67], v[60:63]
  v_mfma_f32_4x4x4_16b_bf16 v[64:67], a[68:69], a[68:69], v[64:67]
  v_mfma_f32_4x4x4_16b_bf16 v[56:59], a[70:71], a[70:71], v[56:59]
  v_mfma_f32_4x4x4_16b_bf16 v[60:63], a[72:73], a[72:73], v[60:63]
  v_mfma_f32_4x4x4_16b_bf16 v[64:67], a[74:75], a[74:75], v[64:67]
  v_mfma_f32_4x4x4_16b_bf16 v[56:59], a[76:77], a[76:77], v[56:59]
  v_mfma_f32_4x4x4_16b_bf16 v[60:63], a[78:79], a[78:79], v[60:63]
  v_mfma_f32_4x4x4_16b_bf16 v[64:67], a[80:81], a[80:81], v[64:67]
  v_mfma_f32_4x4x4_16b_bf16 v[56:59], a[82:83], a[82:83], v[56:59]
  v_mfma_f32_4x4x4_16b_bf16 v[60:63], a[84:85], a[84:85], v[60:63]
  v_mfma_f32_4x4x4_16b_bf16 v[64:67], a[86:87], a[86:87], v[64:67]
  v_mfma_f32_4x4x4_16b_bf16 v[56:59], a[88:89], a[88:89], v[56:59]
  v_mfma_f32_4x4x4_16b_bf16 v[60:63], a[90:91], a[90:91], v[60:63]
  v_mfma_f32_4x4x4_16b_bf16 v[64:67], a[92:93], a[92:93], v[64:67]
  v_mfma_f32_4x4x4_16b_bf16 v[56:59], a[94:95], a[94:95], v[56:59]
  v_mfma_f32_32x32x16_bf16 v[160:175], v[136:139], a[68:71], v[160:175]
  ds_read_b64_tr_b16 v[128:129], v20 offset:8192
  ds_read_b64_tr_b16 v[130:131], v20 offset:8704
  buffer_load_dwordx4 v17, s[16:19], s61 offen offset:3072 lds
  s_mov_b32 m0, s41
  s_nop 0
  v_mfma_f32_32x32x16_bf16 v[176:191], v[140:143], a[68:71], v[176:191]
  ds_read_b64_tr_b16 v[132:133], v24 offset:8192
  ds_read_b64_tr_b16 v[134:135], v24 offset:8704
  v_mfma_f32_32x32x16_bf16 v[160:175], v[144:147], a[72:75], v[160:175]
  ds_read_b64_tr_b16 v[136:137], v20 offset:10240
  ds_read_b64_tr_b16 v[138:139], v20 offset:10752
  buffer_load_dwordx4 v14, s[16:19], s62 offen offset:0 lds
  v_mfma_f32_32x32x16_bf16 v[176:191], v[148:151], a[72:75], v[176:191]
  ds_read_b64_tr_b16 v[140:141], v24 offset:10240
  ds_read_b64_tr_b16 v[142:143], v24 offset:10752
  s_waitcnt lgkmcnt(8)
  s_nop 0
  v_mfma_f32_32x32x16_bf16 v[160:175], v[152:155], a[76:79], v[160:175]
  ds_read_b64_tr_b16 v[144:145], v21 offset:8192
  ds_read_b64_tr_b16 v[146:147], v21 offset:8704
  buffer_load_dwordx4 v15, s[16:19], s62 offen offset:1024 lds
  v_mfma_f32_32x32x16_bf16 v[176:191], v[156:159], a[76:79], v[176:191]
  ds_read_b64_tr_b16 v[148:149], v25 offset:8192
  ds_read_b64_tr_b16 v[150:151], v25 offset:8704
  s_waitcnt lgkmcnt(8)
  s_nop 0
  v_mfma_f32_32x32x16_bf16 v[160:175], v[128:131], a[80:83], v[160:175]
  ds_read_b64_tr_b16 v[152:153], v21 offset:10240
  ds_read_b64_tr_b16 v[154:155], v21 offset:10752
  buffer_load_dwordx4 v16, s[16:19], s62 offen offset:2048 lds
  v_mfma_f32_32x32x16_bf16 v[176:191], v[132:135], a[80:83], v[176:191]
  ds_read_b64_tr_b16 v[156:157], v25 offset:10240
  ds_read_b64_tr_b16 v[158:159], v25 offset:10752
  s_waitcnt lgkmcnt(8)
  s_nop 0
  v_mfma_f32_32x32x16_bf16 v[160:175], v[136:139], a[84:87], v[160:175]
  s_waitcnt vmcnt(19)
  s_barrier
  ds_read_b64_tr_b16 v[128:129], v18 offset:12288
  ds_read_b64_tr_b16 v[130:131], v18 offset:12800
  ds_read_b128 a[96:99], v6 offset:24576
  ds_read_b128 a[100:103], v7 offset:24576
  v_mfma_f32_32x32x16_bf16 v[176:191], v[140:143], a[84:87], v[176:191]
  ds_read_b64_tr_b16 v[132:133], v22 offset:12288
  ds_read_b64_tr_b16 v[134:135], v22 offset:12800
  ds_read_b128 a[104:107], v8 offset:24576
  ds_read_b128 a[108:111], v9 offset:24576
  s_waitcnt lgkmcnt(12)
  s_nop 0
  v_mfma_f32_32x32x16_bf16 v[160:175], v[144:147], a[88:91], v[160:175]
  ds_read_b64_tr_b16 v[136:137], v18 offset:14336
  ds_read_b64_tr_b16 v[138:139], v18 offset:14848
  ds_read_b128 a[112:115], v6 offset:28672
  buffer_load_dwordx4 v17, s[16:19], s62 offen offset:3072 lds
  s_mov_b32 m0, s37
  s_nop 0
  v_mfma_f32_32x32x16_bf16 v[176:191], v[148:151], a[88:91], v[176:191]
  ds_read_b64_tr_b16 v[140:141], v22 offset:14336
  ds_read_b64_tr_b16 v[142:143], v22 offset:14848
  ds_read_b128 a[116:119], v7 offset:28672
  s_waitcnt lgkmcnt(14)
  s_nop 0
  v_mfma_f32_32x32x16_bf16 v[160:175], v[152:155], a[92:95], v[160:175]
  ds_read_b64_tr_b16 v[144:145], v19 offset:12288
  ds_read_b64_tr_b16 v[146:147], v19 offset:12800
  ds_read_b128 a[120:123], v8 offset:28672
  buffer_load_dwordx4 v14, s[16:19], s63 offen offset:0 lds
  v_mfma_f32_32x32x16_bf16 v[176:191], v[156:159], a[92:95], v[176:191]
  ds_read_b64_tr_b16 v[148:149], v23 offset:12288
  ds_read_b64_tr_b16 v[150:151], v23 offset:12800
  ds_read_b128 a[124:127], v9 offset:28672
  s_waitcnt lgkmcnt(14)
  s_nop 0
  v_mfma_f32_32x32x16_bf16 v[160:175], v[128:131], a[96:99], v[160:175]
  ds_read_b64_tr_b16 v[152:153], v19 offset:14336
  ds_read_b64_tr_b16 v[154:155], v19 offset:14848
  buffer_load_dwordx4 v15, s[16:19], s63 offen offset:1024 lds
  v_mfma_f32_32x32x16_bf16 v[176:191], v[132:135], a[96:99], v[176:191]
  ds_read_b64_tr_b16 v[156:157], v23 offset:14336
  ds_read_b64_tr_b16 v[158:159], v23 offset:14848
  v_smfmac_f32_16x16x64_bf16 v[48:51], v[40:43], v[128:135], v44
  s_waitcnt lgkmcnt(11)
  s_nop 0
  v_smfmac_f32_16x16x64_bf16 v[48:51], v[40:43], v[136:143], v44
  s_waitcnt lgkmcnt(4)
  s_nop 0
  v_smfmac_f32_16x16x64_bf16 v[52:55], v[40:43], a[96:103], v44
  buffer_load_dwordx4 v16, s[16:19], s63 offen offset:2048 lds
  v_smfmac_f32_16x16x64_bf16 v[52:55], v[40:43], a[104:111], v44
  buffer_load_dwordx4 v17, s[16:19], s63 offen offset:3072 lds
  s_mov_b32 m0, s42
  s_nop 0
  v_smfmac_f32_16x16x64_bf16 v[52:55], v[40:43], a[112:119], v44
  buffer_load_dwordx4 v14, s[16:19], s64 offen offset:0 lds
  v_smfmac_f32_16x16x64_bf16 v[52:55], v[40:43], a[120:127], v44
  buffer_load_dwordx4 v15, s[16:19], s64 offen offset:1024 lds
  v_mfma_f32_4x4x4_16b_bf16 v[56:59], a[96:97], a[96:97], v[56:59]
  v_mfma_f32_4x4x4_16b_bf16 v[60:63], a[98:99], a[98:99], v[60:63]
  v_mfma_f32_4x4x4_16b_bf16 v[64:67], a[100:101], a[100:101], v[64:67]
  v_mfma_f32_4x4x4_16b_bf16 v[56:59], a[102:103], a[102:103], v[56:59]
  v_mfma_f32_4x4x4_16b_bf16 v[60:63], a[104:105], a[104:105], v[60:63]
  v_mfma_f32_4x4x4_16b_bf16 v[64:67], a[106:107], a[106:107], v[64:67]
  v_mfma_f32_4x4x4_16b_bf16 v[56:59], a[108:109], a[108:109], v[56:59]
  v_mfma_f32_4x4x4_16b_bf16 v[60:63], a[110:111], a[110:111], v[60:63]
  v_mfma_f32_4x4x4_16b_bf16 v[64:67], a[112:113], a[112:113], v[64:67]
  v_mfma_f32_4x4x4_16b_bf16 v[56:59], a[114:115], a[114:115], v[56:59]
  v_mfma_f32_4x4x4_16b_bf16 v[60:63], a[116:117], a[116:117], v[60:63]
  v_mfma_f32_4x4x4_16b_bf16 v[64:67], a[118:119], a[118:119], v[64:67]
  v_mfma_f32_4x4x4_16b_bf16 v[56:59], a[120:121], a[120:121], v[56:59]
  v_mfma_f32_4x4x4_16b_bf16 v[60:63], a[122:123], a[122:123], v[60:63]
  v_mfma_f32_4x4x4_16b_bf16 v[64:67], a[124:125], a[124:125], v[64:67]
  v_mfma_f32_4x4x4_16b_bf16 v[56:59], a[126:127], a[126:127], v[56:59]
  v_mfma_f32_32x32x16_bf16 v[160:175], v[136:139], a[100:103], v[160:175]
  ds_read_b64_tr_b16 v[128:129], v20 offset:12288
  ds_read_b64_tr_b16 v[130:131], v20 offset:12800
  buffer_load_dwordx4 v16, s[16:19], s64 offen offset:2048 lds
  v_mfma_f32_32x32x16_bf16 v[176:191], v[140:143], a[100:103], v[176:191]
  ds_read_b64_tr_b16 v[132:133], v24 offset:12288
  ds_read_b64_tr_b16 v[134:135], v24 offset:12800
  v_mfma_f32_32x32x16_bf16 v[160:175], v[144:147], a[104:107], v[160:175]
  ds_read_b64_tr_b16 v[136:137], v20 offset:14336
  ds_read_b64_tr_b16 v[138:139], v20 offset:14848
  buffer_load_dwordx4 v17, s[16:19], s64 offen offset:3072 lds
  v_mfma_f32_32x32x16_bf16 v[176:191], v[148:151], a[104:107], v[176:191]
  ds_read_b64_tr_b16 v[140:141], v24 offset:14336
  ds_read_b64_tr_b16 v[142:143], v24 offset:14848
  s_waitcnt lgkmcnt(8)
  s_nop 0
  v_mfma_f32_32x32x16_bf16 v[160:175], v[152:155], a[108:111], v[160:175]
  ds_read_b64_tr_b16 v[144:145], v21 offset:12288
  ds_read_b64_tr_b16 v[146:147], v21 offset:12800
  v_mfma_f32_32x32x16_bf16 v[176:191], v[156:159], a[108:111], v[176:191]
  ds_read_b64_tr_b16 v[148:149], v25 offset:12288
  ds_read_b64_tr_b16 v[150:151], v25 offset:12800
  s_waitcnt lgkmcnt(8)
  s_nop 0
  v_mfma_f32_32x32x16_bf16 v[160:175], v[128:131], a[112:115], v[160:175]
  ds_read_b64_tr_b16 v[152:153], v21 offset:14336
  ds_read_b64_tr_b16 v[154:155], v21 offset:14848
  v_mfma_f32_32x32x16_bf16 v[176:191], v[132:135], a[112:115], v[176:191]
  ds_read_b64_tr_b16 v[156:157], v25 offset:14336
  ds_read_b64_tr_b16 v[158:159], v25 offset:14848
  s_waitcnt lgkmcnt(8)
  s_nop 0
  v_mfma_f32_32x32x16_bf16 v[160:175], v[136:139], a[116:119], v[160:175]
  s_waitcnt vmcnt(16)
  s_barrier
  ds_read_b64_tr_b16 v[128:129], v18 offset:0
  ds_read_b64_tr_b16 v[130:131], v18 offset:512
  ds_read_b128 a[128:131], v6 offset:32768
  ds_read_b128 a[132:135], v7 offset:32768
  v_mfma_f32_32x32x16_bf16 v[176:191], v[140:143], a[116:119], v[176:191]
  ds_read_b64_tr_b16 v[132:133], v22 offset:0
  ds_read_b64_tr_b16 v[134:135], v22 offset:512
  ds_read_b128 a[136:139], v8 offset:32768
  ds_read_b128 a[140:143], v9 offset:32768
  s_mov_b32 m0, s43
  s_waitcnt lgkmcnt(12)
  v_mfma_f32_32x32x16_bf16 v[160:175], v[144:147], a[120:123], v[160:175]
  ds_read_b64_tr_b16 v[136:137], v18 offset:2048
  ds_read_b64_tr_b16 v[138:139], v18 offset:2560
  ds_read_b128 a[144:147], v6 offset:36864
  buffer_load_dwordx4 v14, s[16:19], s65 offen offset:0 lds
  v_mfma_f32_32x32x16_bf16 v[176:191], v[148:151], a[120:123], v[176:191]
  ds_read_b64_tr_b16 v[140:141], v22 offset:2048
  ds_read_b64_tr_b16 v[142:143], v22 offset:2560
  ds_read_b128 a[148:151], v7 offset:36864
  s_waitcnt lgkmcnt(14)
  s_nop 0
  v_mfma_f32_32x32x16_bf16 v[160:175], v[152:155], a[124:127], v[160:175]
  ds_read_b64_tr_b16 v[144:145], v19 offset:0
  ds_read_b64_tr_b16 v[146:147], v19 offset:512
  ds_read_b128 a[152:155], v8 offset:36864
  buffer_load_dwordx4 v15, s[16:19], s65 offen offset:1024 lds
  v_mfma_f32_32x32x16_bf16 v[176:191], v[156:159], a[124:127], v[176:191]
  ds_read_b64_tr_b16 v[148:149], v23 offset:0
  ds_read_b64_tr_b16 v[150:151], v23 offset:512
  ds_read_b128 a[156:159], v9 offset:36864
  s_waitcnt lgkmcnt(14)
  s_nop 0
  v_mfma_f32_32x32x16_bf16 v[160:175], v[128:131], a[128:131], v[160:175]
  ds_read_b64_tr_b16 v[152:153], v19 offset:2048
  ds_read_b64_tr_b16 v[154:155], v19 offset:2560
  buffer_load_dwordx4 v16, s[16:19], s65 offen offset:2048 lds
  v_mfma_f32_32x32x16_bf16 v[176:191], v[132:135], a[128:131], v[176:191]
  ds_read_b64_tr_b16 v[156:157], v23 offset:2048
  ds_read_b64_tr_b16 v[158:159], v23 offset:2560
  v_smfmac_f32_16x16x64_bf16 v[48:51], v[40:43], v[128:135], v44
  s_waitcnt lgkmcnt(11)
  s_nop 0
  v_smfmac_f32_16x16x64_bf16 v[48:51], v[40:43], v[136:143], v44
  s_waitcnt lgkmcnt(4)
  s_nop 0
  v_smfmac_f32_16x16x64_bf16 v[52:55], v[40:43], a[128:135], v44
  buffer_load_dwordx4 v17, s[16:19], s65 offen offset:3072 lds
  v_smfmac_f32_16x16x64_bf16 v[52:55], v[40:43], a[136:143], v44
  v_smfmac_f32_16x16x64_bf16 v[52:55], v[40:43], a[144:151], v44
  v_smfmac_f32_16x16x64_bf16 v[52:55], v[40:43], a[152:159], v44
  v_mfma_f32_4x4x4_16b_bf16 v[56:59], a[128:129], a[128:129], v[56:59]
  v_mfma_f32_4x4x4_16b_bf16 v[60:63], a[130:131], a[130:131], v[60:63]
  v_mfma_f32_4x4x4_16b_bf16 v[64:67], a[132:133], a[132:133], v[64:67]
  v_mfma_f32_4x4x4_16b_bf16 v[56:59], a[134:135], a[134:135], v[56:59]
  v_mfma_f32_4x4x4_16b_bf16 v[60:63], a[136:137], a[136:137], v[60:63]
  v_mfma_f32_4x4x4_16b_bf16 v[64:67], a[138:139], a[138:139], v[64:67]
  v_mfma_f32_4x4x4_16b_bf16 v[56:59], a[140:141], a[140:141], v[56:59]
  v_mfma_f32_4x4x4_16b_bf16 v[60:63], a[142:143], a[142:143], v[60:63]
  v_mfma_f32_4x4x4_16b_bf16 v[64:67], a[144:145], a[144:145], v[64:67]
  v_mfma_f32_4x4x4_16b_bf16 v[56:59], a[146:147], a[146:147], v[56:59]
  v_mfma_f32_4x4x4_16b_bf16 v[60:63], a[148:149], a[148:149], v[60:63]
  v_mfma_f32_4x4x4_16b_bf16 v[64:67], a[150:151], a[150:151], v[64:67]
  v_mfma_f32_4x4x4_16b_bf16 v[56:59], a[152:153], a[152:153], v[56:59]
  v_mfma_f32_4x4x4_16b_bf16 v[60:63], a[154:155], a[154:155], v[60:63]
  v_mfma_f32_4x4x4_16b_bf16 v[64:67], a[156:157], a[156:157], v[64:67]
  v_mfma_f32_4x4x4_16b_bf16 v[56:59], a[158:159], a[158:159], v[56:59]
  v_mfma_f32_32x32x16_bf16 v[160:175], v[136:139], a[132:135], v[160:175]
  ds_read_b64_tr_b16 v[128:129], v20 offset:0
  ds_read_b64_tr_b16 v[130:131], v20 offset:512
  s_mov_b32 m0, s38
  v_add_f32 v78, v48, v49
  v_add_f32 v56, v56, v60
  v_add_f32 v57, v57, v61
  v_mfma_f32_32x32x16_bf16 v[176:191], v[140:143], a[132:135], v[176:191]
  ds_read_b64_tr_b16 v[132:133], v24 offset:0
  ds_read_b64_tr_b16 v[134:135], v24 offset:512
  ds_write_b32 v37, v78
  v_mov_b32 v48, 0
  v_mov_b32 v49, 0
  v_mfma_f32_32x32x16_bf16 v[160:175], v[144:147], a[136:139], v[160:175]
  ds_read_b64_tr_b16 v[136:137], v20 offset:2048
  ds_read_b64_tr_b16 v[138:139], v20 offset:2560
  buffer_load_dwordx4 v14, s[16:19], s66 offen offset:0 lds
  v_add_f32 v52, v52, v53
  v_mov_b32 v53, v52
  v_add_f32_e64 v58, v58, v62
  v_mfma_f32_32x32x16_bf16 v[176:191], v[148:151], a[136:139], v[176:191]
  ds_read_b64_tr_b16 v[140:141], v24 offset:2048
  ds_read_b64_tr_b16 v[142:143], v24 offset:2560
  v_permlane32_swap_b32 v52, v53
  v_add_f32 v59, v59, v63
  v_add_f32 v56, v56, v64
  s_waitcnt lgkmcnt(9)
  v_mfma_f32_32x32x16_bf16 v[160:175], v[152:155], a[140:143], v[160:175]
  ds_read_b64_tr_b16 v[144:145], v21 offset:0
  ds_read_b64_tr_b16 v[146:147], v21 offset:512
  buffer_load_dwordx4 v15, s[16:19], s66 offen offset:1024 lds
  v_add_f32_e64 v52, v52, v53
  v_mul_f32 v45, 0xbacccccd, v52
  v_cvt_pk_bf16_f32 v52, v45, v45
  v_mfma_f32_32x32x16_bf16 v[176:191], v[156:159], a[140:143], v[176:191]
  s_waitcnt vmcnt(18) lgkmcnt(6)
  s_barrier
  ds_read2st64_b32 v[74:75], v38 offset1:160
  ds_read2st64_b32 v[76:77], v39 offset1:160
  ds_read_b64_tr_b16 v[148:149], v25 offset:0
  ds_read_b64_tr_b16 v[150:151], v25 offset:512
  v_mfma_f32_32x32x16_bf16 v[160:175], v[128:131], a[144:147], v[160:175]
  ds_read_b64_tr_b16 v[152:153], v21 offset:2048
  ds_read_b64_tr_b16 v[154:155], v21 offset:2560
  buffer_load_dwordx4 v16, s[16:19], s66 offen offset:2048 lds
  v_and_b32 v53, 0xffff0000, v52
  v_sub_f32_e64 v53, v45, v53
  v_cvt_pk_bf16_f32 v53, v53, v53
  v_mfma_f32_32x32x16_bf16 v[176:191], v[132:135], a[144:147], v[176:191]
  ds_read_b64_tr_b16 v[156:157], v25 offset:2048
  ds_read_b64_tr_b16 v[158:159], v25 offset:2560
  v_cndmask_b32 v70, 0, v52, s[90:91]
  v_cndmask_b32 v71, 0, v53, s[90:91]
  v_cndmask_b32 v72, v52, 0, s[90:91]
  s_waitcnt lgkmcnt(10)
  s_nop 0
  v_mfma_f32_32x32x16_bf16 v[160:175], v[136:139], a[148:151], v[160:175]
  ds_read_b64_tr_b16 v[128:129], v18 offset:16384
  ds_read_b64_tr_b16 v[130:131], v18 offset:16896
  buffer_load_dwordx4 v17, s[16:19], s66 offen offset:3072 lds
  v_cndmask_b32 v73, v53, 0, s[90:91]
  v_add_f32 v57, v57, v65
  v_add_f32 v58, v58, v66
  v_mfma_f32_32x32x16_bf16 v[176:191], v[140:143], a[148:151], v[176:191]
  ds_read_b64_tr_b16 v[132:133], v22 offset:16384
  ds_read_b64_tr_b16 v[134:135], v22 offset:16896
  v_add_f32 v59, v59, v67
  v_cndmask_b32 v56, v56, v57, s[84:85]
  v_cndmask_b32 v56, v56, v58, s[86:87]
  s_waitcnt lgkmcnt(8)
  v_mfma_f32_32x32x16_bf16 v[160:175], v[144:147], a[152:155], v[160:175]
  ds_read_b64_tr_b16 v[136:137], v18 offset:18432
  ds_read_b64_tr_b16 v[138:139], v18 offset:18944
  s_mov_b32 m0, s39
  v_add_f32 v74, v74, v75
  v_add_f32 v76, v76, v77
  v_add_f32 v74, v74, v76
  v_mfma_f32_32x32x16_bf16 v[176:191], v[148:151], a[152:155], v[176:191]
  ds_read_b64_tr_b16 v[140:141], v22 offset:18432
  ds_read_b64_tr_b16 v[142:143], v22 offset:18944
  v_cvt_pk_bf16_f32 v75, v74, v74
  v_and_b32 v75, 0xffff0000, v75
  v_sub_f32 v75, v74, v75
  s_waitcnt lgkmcnt(8)
  v_mfma_f32_32x32x16_bf16 v[160:175], v[152:155], a[156:159], v[160:175]
  ds_read_b64_tr_b16 v[144:145], v19 offset:16384
  ds_read_b64_tr_b16 v[146:147], v19 offset:16896
  buffer_load_dwordx4 v14, s[16:19], s67 offen offset:0 lds
  v_cvt_pk_bf16_f32 v68, v74, v75
  v_cvt_pk_bf16_f32 v69, v74, v75
  v_cndmask_b32 v56, v56, v59, s[88:89]
  v_mfma_f32_32x32x16_bf16 v[176:191], v[156:159], a[156:159], v[176:191]
  ds_read_b64_tr_b16 v[148:149], v23 offset:16384
  ds_read_b64_tr_b16 v[150:151], v23 offset:16896
  v_mov_b32_e64 v57, v56
  v_mfma_f32_32x32x8_bf16 v[160:175], v[68:69], v[70:71], v[160:175]
  buffer_load_dwordx4 v15, s[16:19], s67 offen offset:1024 lds
  v_permlane32_swap_b32 v56, v57
  s_nop 0
  v_mfma_f32_32x32x8_bf16 v[176:191], v[68:69], v[72:73], v[176:191]
  buffer_load_dwordx4 v16, s[16:19], s67 offen offset:2048 lds
  v_add_f32 v56, v56, v57
  v_mul_f32 v56, 0x3acccccd, v56
  v_fma_f32 v56, -v45, v45, v56
  v_max_f32_e64 v56, 0, v56
  s_cmp_lt_u32 s30, 7
  s_cbranch_scc1 K1_C
  s_cmp_lt_u32 s31, 2
  s_cbranch_scc1 K1_AQ
  s_cmp_eq_u32 s31, 2
  s_cbranch_scc1 K1_AV
  s_waitcnt lgkmcnt(8)
  v_mfma_f32_32x32x16_bf16 v[192:207], v[128:131], a[0:3], 0
  ds_read_b64_tr_b16 v[152:153], v19 offset:18432
  ds_read_b64_tr_b16 v[154:155], v19 offset:18944
  buffer_load_dwordx4 v17, s[16:19], s67 offen offset:3072 lds
  v_add_f32 v56, 0x3727c5ac, v56
  v_rsq_f32_e64 v46, v56
  v_mfma_f32_32x32x16_bf16 v[208:223], v[132:135], a[0:3], 0
  ds_read_b64_tr_b16 v[156:157], v23 offset:18432
  ds_read_b64_tr_b16 v[158:159], v23 offset:18944
  v_mul_f32 v47, s82, v46
  v_mul_f32 v82, v56, v46
  v_mul_f32 v81, 0xc0135761, v46
  v_mul_f32_e64 v80, v46, v46
  v_smfmac_f32_16x16x64_bf16 v[48:51], v[40:43], v[128:135], v44
  s_waitcnt lgkmcnt(8)
  s_nop 0
  v_smfmac_f32_16x16x64_bf16 v[48:51], v[40:43], v[136:143], v44
  v_mfma_f32_32x32x16_bf16 v[192:207], v[136:139], a[4:7], v[192:207]
  ds_read_b64_tr_b16 v[128:129], v20 offset:16384
  ds_read_b64_tr_b16 v[130:131], v20 offset:16896
  s_mov_b32 m0, s45
  v_mul_f32 v80, v80, v81
  v_mul_f32 v80, 0x3d372713, v80
  v_mul_f32_e64 v84, v160, v160
  v_mfma_f32_32x32x16_bf16 v[208:223], v[140:143], a[4:7], v[208:223]
  ds_read_b64_tr_b16 v[132:133], v24 offset:16384
  ds_read_b64_tr_b16 v[134:135], v24 offset:16896
  v_mul_f32 v85, v161, v161
  v_fma_f32 v84, v84, v80, v81
  v_fma_f32 v85, v85, v80, v81
  s_waitcnt lgkmcnt(8)
  v_mfma_f32_32x32x16_bf16 v[192:207], v[144:147], a[8:11], v[192:207]
  ds_read_b64_tr_b16 v[136:137], v20 offset:18432
  ds_read_b64_tr_b16 v[138:139], v20 offset:18944
  buffer_load_dwordx4 v34, s[20:23], s80 offen lds
  v_mul_f32 v84, v84, v160
  v_mul_f32 v85, v85, v161
  v_mfma_f32_32x32x16_bf16 v[208:223], v[148:151], a[8:11], v[208:223]
  ds_read_b64_tr_b16 v[140:141], v24 offset:18432
  ds_read_b64_tr_b16 v[142:143], v24 offset:18944
  v_exp_f32 v84, v84
  s_waitcnt lgkmcnt(8)
  v_mfma_f32_32x32x16_bf16 v[192:207], v[152:155], a[12:15], v[192:207]
  ds_read_b64_tr_b16 v[144:145], v21 offset:16384
  ds_read_b64_tr_b16 v[146:147], v21 offset:16896
  buffer_load_dwordx4 v35, s[20:23], s80 offen offset:1024 lds
  v_exp_f32_e64 v85, v85
  v_fma_f32 v84, v84, v82, v82
  v_mfma_f32_32x32x16_bf16 v[208:223], v[156:159], a[12:15], v[208:223]
  s_waitcnt vmcnt(22)
  s_barrier
  ds_read_b64_tr_b16 v[148:149], v25 offset:16384
  ds_read_b64_tr_b16 v[150:151], v25 offset:16896
  v_fma_f32 v85, v85, v82, v82
  s_waitcnt lgkmcnt(8)
  s_nop 0
  v_mfma_f32_32x32x16_bf16 v[192:207], v[128:131], a[16:19], v[192:207]
  ds_read_b64_tr_b16 v[152:153], v21 offset:18432
  ds_read_b64_tr_b16 v[154:155], v21 offset:18944
  s_mov_b32 m0, s36
  v_rcp_f32 v84, v84
  v_mfma_f32_32x32x16_bf16 v[208:223], v[132:135], a[16:19], v[208:223]
  ds_read_b64_tr_b16 v[156:157], v25 offset:18432
  ds_read_b64_tr_b16 v[158:159], v25 offset:18944
  v_rcp_f32 v85, v85
  v_mul_f32_e64 v160, v160, v84
  s_waitcnt lgkmcnt(8)
  v_mfma_f32_32x32x16_bf16 v[192:207], v[136:139], a[20:23], v[192:207]
  ds_read_b64_tr_b16 v[128:129], v18 offset:20480
  ds_read_b64_tr_b16 v[130:131], v18 offset:20992
  buffer_load_dwordx4 v14, s[16:19], s68 offen offset:0 lds
  v_mul_f32 v161, v161, v85
  v_mul_f32 v86, v162, v162
  v_mul_f32_e64 v87, v163, v163
  v_mfma_f32_32x32x16_bf16 v[208:223], v[140:143], a[20:23], v[208:223]
  ds_read_b64_tr_b16 v[132:133], v22 offset:20480
  ds_read_b64_tr_b16 v[134:135], v22 offset:20992
  v_fma_f32 v86, v86, v80, v81
  v_fma_f32 v87, v87, v80, v81
  v_mul_f32 v86, v86, v162
  s_waitcnt lgkmcnt(8)
  v_mfma_f32_32x32x16_bf16 v[192:207], v[144:147], a[24:27], v[192:207]
  ds_read_b64_tr_b16 v[136:137], v18 offset:22528
  ds_read_b64_tr_b16 v[138:139], v18 offset:23040
  buffer_load_dwordx4 v15, s[16:19], s68 offen offset:1024 lds
  v_mul_f32 v87, v87, v163
  v_exp_f32 v86, v86
  v_mfma_f32_32x32x16_bf16 v[208:223], v[148:151], a[24:27], v[208:223]
  ds_read_b64_tr_b16 v[140:141], v22 offset:22528
  ds_read_b64_tr_b16 v[142:143], v22 offset:23040
  v_exp_f32 v87, v87
  v_fma_f32 v86, v86, v82, v82
  s_waitcnt lgkmcnt(8)
  v_mfma_f32_32x32x16_bf16 v[192:207], v[152:155], a[28:31], v[192:207]
  ds_read_b64_tr_b16 v[144:145], v19 offset:20480
  ds_read_b64_tr_b16 v[146:147], v19 offset:20992
  buffer_load_dwordx4 v16, s[16:19], s68 offen offset:2048 lds
  v_fma_f32 v87, v87, v82, v82
  v_rcp_f32_e64 v86, v86
  v_mfma_f32_32x32x16_bf16 v[208:223], v[156:159], a[28:31], v[208:223]
  ds_read_b64_tr_b16 v[148:149], v23 offset:20480
  ds_read_b64_tr_b16 v[150:151], v23 offset:20992
  v_rcp_f32 v87, v87
  v_mul_f32_e64 v162, v162, v86
  s_waitcnt lgkmcnt(8)
  v_mfma_f32_32x32x16_bf16 v[192:207], v[128:131], a[32:35], v[192:207]
  ds_read_b64_tr_b16 v[152:153], v19 offset:22528
  ds_read_b64_tr_b16 v[154:155], v19 offset:23040
  buffer_load_dwordx4 v17, s[16:19], s68 offen offset:3072 lds
  v_mul_f32 v163, v163, v87
  v_mul_f32 v84, v164, v164
  v_mul_f32_e64 v85, v165, v165
  v_mfma_f32_32x32x16_bf16 v[208:223], v[132:135], a[32:35], v[208:223]
  ds_read_b64_tr_b16 v[156:157], v23 offset:22528
  ds_read_b64_tr_b16 v[158:159], v23 offset:23040
  v_fma_f32 v84, v84, v80, v81
  v_fma_f32 v85, v85, v80, v81
  v_mul_f32 v84, v84, v164
  v_mul_f32 v85, v85, v165
  v_smfmac_f32_16x16x64_bf16 v[48:51], v[40:43], v[128:135], v44
  s_waitcnt lgkmcnt(8)
  s_nop 0
  v_smfmac_f32_16x16x64_bf16 v[48:51], v[40:43], v[136:143], v44
  v_mfma_f32_32x32x16_bf16 v[192:207], v[136:139], a[36:39], v[192:207]
  ds_read_b64_tr_b16 v[128:129], v20 offset:20480
  ds_read_b64_tr_b16 v[130:131], v20 offset:20992
  v_exp_f32 v84, v84
  v_exp_f32 v85, v85
  v_mfma_f32_32x32x16_bf16 v[208:223], v[140:143], a[36:39], v[208:223]
  ds_read_b64_tr_b16 v[132:133], v24 offset:20480
  ds_read_b64_tr_b16 v[134:135], v24 offset:20992
  v_fma_f32 v84, v84, v82, v82
  v_fma_f32 v85, v85, v82, v82
  s_waitcnt lgkmcnt(8)
  s_nop 0
  v_mfma_f32_32x32x16_bf16 v[192:207], v[144:147], a[40:43], v[192:207]
  ds_read_b64_tr_b16 v[136:137], v20 offset:22528
  ds_read_b64_tr_b16 v[138:139], v20 offset:23040
  v_rcp_f32 v84, v84
  v_rcp_f32 v85, v85
  v_mfma_f32_32x32x16_bf16 v[208:223], v[148:151], a[40:43], v[208:223]
  ds_read_b64_tr_b16 v[140:141], v24 offset:22528
  ds_read_b64_tr_b16 v[142:143], v24 offset:23040
  v_mul_f32 v164, v164, v84
  v_mul_f32 v165, v165, v85
  v_mul_f32 v86, v166, v166
  s_waitcnt lgkmcnt(8)
  v_mfma_f32_32x32x16_bf16 v[192:207], v[152:155], a[44:47], v[192:207]
  ds_read_b64_tr_b16 v[144:145], v21 offset:20480
  ds_read_b64_tr_b16 v[146:147], v21 offset:20992
  v_mul_f32 v87, v167, v167
  v_fma_f32 v86, v86, v80, v81
  v_fma_f32 v87, v87, v80, v81
  v_mul_f32 v86, v86, v166
  v_mfma_f32_32x32x16_bf16 v[208:223], v[156:159], a[44:47], v[208:223]
  s_waitcnt vmcnt(22)
  s_barrier
  ds_read_b64_tr_b16 v[148:149], v25 offset:20480
  ds_read_b64_tr_b16 v[150:151], v25 offset:20992
  v_mul_f32 v87, v87, v167
  s_waitcnt lgkmcnt(8)
  v_mfma_f32_32x32x16_bf16 v[192:207], v[128:131], a[48:51], v[192:207]
  ds_read_b64_tr_b16 v[152:153], v21 offset:22528
  ds_read_b64_tr_b16 v[154:155], v21 offset:23040
  v_exp_f32 v86, v86
  v_exp_f32 v87, v87
  v_mfma_f32_32x32x16_bf16 v[208:223], v[132:135], a[48:51], v[208:223]
  ds_read_b64_tr_b16 v[156:157], v25 offset:22528
  ds_read_b64_tr_b16 v[158:159], v25 offset:23040
  s_mov_b32 m0, s40
  v_fma_f32 v86, v86, v82, v82
  v_fma_f32 v87, v87, v82, v82
  s_waitcnt lgkmcnt(8)
  v_mfma_f32_32x32x16_bf16 v[192:207], v[136:139], a[52:55], v[192:207]
  ds_read_b64_tr_b16 v[128:129], v18 offset:4096
  ds_read_b64_tr_b16 v[130:131], v18 offset:4608
  v_rcp_f32 v86, v86
  v_rcp_f32 v87, v87
  v_mfma_f32_32x32x16_bf16 v[208:223], v[140:143], a[52:55], v[208:223]
  ds_read_b64_tr_b16 v[132:133], v22 offset:4096
  ds_read_b64_tr_b16 v[134:135], v22 offset:4608
  v_mul_f32 v166, v166, v86
  v_mul_f32_e64 v167, v167, v87
  v_cvt_pk_bf16_f32 v160, v160, v161
  s_waitcnt lgkmcnt(8)
  v_mfma_f32_32x32x16_bf16 v[192:207], v[144:147], a[56:59], v[192:207]
  ds_read_b64_tr_b16 v[136:137], v18 offset:6144
  ds_read_b64_tr_b16 v[138:139], v18 offset:6656
  buffer_load_dwordx4 v14, s[16:19], s69 offen offset:0 lds
  v_cvt_pk_bf16_f32 v161, v162, v163
  v_cvt_pk_bf16_f32 v162, v164, v165
  v_cvt_pk_bf16_f32 v163, v166, v167
  v_mfma_f32_32x32x16_bf16 v[208:223], v[148:151], a[56:59], v[208:223]
  ds_read_b64_tr_b16 v[140:141], v22 offset:6144
  ds_read_b64_tr_b16 v[142:143], v22 offset:6656
  buffer_store_dwordx4 v[160:163], v1, s[12:15], s76 offen offset:0 sc1
  v_mul_f32 v84, v168, v168
  v_mul_f32_e64 v85, v169, v169
  s_waitcnt lgkmcnt(8)
  v_mfma_f32_32x32x16_bf16 v[192:207], v[152:155], a[60:63], v[192:207]
  ds_read_b64_tr_b16 v[144:145], v19 offset:4096
  ds_read_b64_tr_b16 v[146:147], v19 offset:4608
  v_fma_f32 v84, v84, v80, v81
  v_fma_f32 v85, v85, v80, v81
  v_mul_f32 v84, v84, v168
  v_mul_f32 v85, v85, v169
  v_mfma_f32_32x32x16_bf16 v[208:223], v[156:159], a[60:63], v[208:223]
  ds_read_b64_tr_b16 v[148:149], v23 offset:4096
  ds_read_b64_tr_b16 v[150:151], v23 offset:4608
  buffer_load_dwordx4 v15, s[16:19], s69 offen offset:1024 lds
  v_exp_f32 v84, v84
  s_waitcnt lgkmcnt(8)
  v_mfma_f32_32x32x16_bf16 v[192:207], v[128:131], a[64:67], v[192:207]
  ds_read_b64_tr_b16 v[152:153], v19 offset:6144
  ds_read_b64_tr_b16 v[154:155], v19 offset:6656
  buffer_load_dwordx4 v16, s[16:19], s69 offen offset:2048 lds
  v_exp_f32_e64 v85, v85
  v_fma_f32 v84, v84, v82, v82
  v_mfma_f32_32x32x16_bf16 v[208:223], v[132:135], a[64:67], v[208:223]
  ds_read_b64_tr_b16 v[156:157], v23 offset:6144
  ds_read_b64_tr_b16 v[158:159], v23 offset:6656
  v_fma_f32 v85, v85, v82, v82
  v_rcp_f32_e64 v84, v84
  v_smfmac_f32_16x16x64_bf16 v[48:51], v[40:43], v[128:135], v44
  s_waitcnt lgkmcnt(8)
  s_nop 0
  v_smfmac_f32_16x16x64_bf16 v[48:51], v[40:43], v[136:143], v44
  v_mfma_f32_32x32x16_bf16 v[192:207], v[136:139], a[68:71], v[192:207]
  ds_read_b64_tr_b16 v[128:129], v20 offset:4096
  ds_read_b64_tr_b16 v[130:131], v20 offset:4608
  v_rcp_f32 v85, v85
  v_mul_f32 v168, v168, v84
  v_mul_f32_e64 v169, v169, v85
  v_mfma_f32_32x32x16_bf16 v[208:223], v[140:143], a[68:71], v[208:223]
  ds_read_b64_tr_b16 v[132:133], v24 offset:4096
  ds_read_b64_tr_b16 v[134:135], v24 offset:4608
  buffer_load_dwordx4 v17, s[16:19], s69 offen offset:3072 lds
  v_mul_f32 v86, v170, v170
  v_mul_f32_e64 v87, v171, v171
  s_waitcnt lgkmcnt(8)
  v_mfma_f32_32x32x16_bf16 v[192:207], v[144:147], a[72:75], v[192:207]
  ds_read_b64_tr_b16 v[136:137], v20 offset:6144
  ds_read_b64_tr_b16 v[138:139], v20 offset:6656
  v_fma_f32 v86, v86, v80, v81
  v_fma_f32 v87, v87, v80, v81
  v_mul_f32 v86, v86, v170
  v_mul_f32 v87, v87, v171
  v_mfma_f32_32x32x16_bf16 v[208:223], v[148:151], a[72:75], v[208:223]
  ds_read_b64_tr_b16 v[140:141], v24 offset:6144
  ds_read_b64_tr_b16 v[142:143], v24 offset:6656
  v_exp_f32_e64 v86, v86
  s_mov_b32 s4, s100
  s_waitcnt lgkmcnt(8)
  v_mfma_f32_32x32x16_bf16 v[192:207], v[152:155], a[76:79], v[192:207]
  ds_read_b64_tr_b16 v[144:145], v21 offset:4096
  ds_read_b64_tr_b16 v[146:147], v21 offset:4608
  s_mov_b32 s5, s101
  s_mov_b32 s6, 8192
  v_lshrrev_b32 v2, 3, v0
  v_lshlrev_b32_e64 v2, 10, v2
  v_mfma_f32_32x32x16_bf16 v[208:223], v[156:159], a[76:79], v[208:223]
  s_waitcnt vmcnt(23)
  s_barrier
  ds_read_b64_tr_b16 v[148:149], v25 offset:4096
  ds_read_b64_tr_b16 v[150:151], v25 offset:4608
  s_waitcnt lgkmcnt(8)
  s_nop 0
  v_mfma_f32_32x32x16_bf16 v[192:207], v[128:131], a[80:83], v[192:207]
  ds_read_b64_tr_b16 v[152:153], v21 offset:6144
  ds_read_b64_tr_b16 v[154:155], v21 offset:6656
  v_exp_f32_e64 v87, v87
  v_fma_f32 v86, v86, v82, v82
  v_fma_f32 v87, v87, v82, v82
  v_mfma_f32_32x32x16_bf16 v[208:223], v[132:135], a[80:83], v[208:223]
  ds_read_b64_tr_b16 v[156:157], v25 offset:6144
  ds_read_b64_tr_b16 v[158:159], v25 offset:6656
  buffer_load_dword v4, v2, s[4:7], 0 offen offset:0
  v_rcp_f32 v86, v86
  s_waitcnt lgkmcnt(8)
  v_mfma_f32_32x32x16_bf16 v[192:207], v[136:139], a[84:87], v[192:207]
  ds_read_b64_tr_b16 v[128:129], v18 offset:24576
  ds_read_b64_tr_b16 v[130:131], v18 offset:25088
  v_rcp_f32 v87, v87
  v_mul_f32 v170, v170, v86
  v_mul_f32_e64 v171, v171, v87
  v_mfma_f32_32x32x16_bf16 v[208:223], v[140:143], a[84:87], v[208:223]
  ds_read_b64_tr_b16 v[132:133], v22 offset:24576
  ds_read_b64_tr_b16 v[134:135], v22 offset:25088
  v_mul_f32 v84, v172, v172
  v_mul_f32_e64 v85, v173, v173
  v_fma_f32 v84, v84, v80, v81
  s_waitcnt lgkmcnt(8)
  v_mfma_f32_32x32x16_bf16 v[192:207], v[144:147], a[88:91], v[192:207]
  ds_read_b64_tr_b16 v[136:137], v18 offset:26624
  ds_read_b64_tr_b16 v[138:139], v18 offset:27136
  s_mov_b32 m0, s41
  v_fma_f32 v85, v85, v80, v81
  v_mul_f32 v84, v84, v172
  v_mul_f32_e64 v85, v85, v173
  v_mfma_f32_32x32x16_bf16 v[208:223], v[148:151], a[88:91], v[208:223]
  ds_read_b64_tr_b16 v[140:141], v22 offset:26624
  ds_read_b64_tr_b16 v[142:143], v22 offset:27136
  v_exp_f32 v84, v84
  s_waitcnt lgkmcnt(8)
  v_mfma_f32_32x32x16_bf16 v[192:207], v[152:155], a[92:95], v[192:207]
  ds_read_b64_tr_b16 v[144:145], v19 offset:24576
  ds_read_b64_tr_b16 v[146:147], v19 offset:25088
  v_exp_f32_e64 v85, v85
  v_fma_f32 v84, v84, v82, v82
  v_fma_f32 v85, v85, v82, v82
  v_mfma_f32_32x32x16_bf16 v[208:223], v[156:159], a[92:95], v[208:223]
  ds_read_b64_tr_b16 v[148:149], v23 offset:24576
  ds_read_b64_tr_b16 v[150:151], v23 offset:25088
  buffer_load_dwordx4 v14, s[16:19], s70 offen offset:0 lds
  v_rcp_f32 v84, v84
  s_waitcnt lgkmcnt(8)
  v_mfma_f32_32x32x16_bf16 v[192:207], v[128:131], a[96:99], v[192:207]
  ds_read_b64_tr_b16 v[152:153], v19 offset:26624
  ds_read_b64_tr_b16 v[154:155], v19 offset:27136
  buffer_load_dwordx4 v15, s[16:19], s70 offen offset:1024 lds
  v_rcp_f32 v85, v85
  v_mul_f32 v172, v172, v84
  v_mfma_f32_32x32x16_bf16 v[208:223], v[132:135], a[96:99], v[208:223]
  ds_read_b64_tr_b16 v[156:157], v23 offset:26624
  ds_read_b64_tr_b16 v[158:159], v23 offset:27136
  v_mul_f32 v173, v173, v85
  v_mul_f32 v86, v174, v174
  v_mul_f32_e64 v87, v175, v175
  v_fma_f32 v86, v86, v80, v81
  v_smfmac_f32_16x16x64_bf16 v[48:51], v[40:43], v[128:135], v44
  s_waitcnt lgkmcnt(8)
  s_nop 0
  v_smfmac_f32_16x16x64_bf16 v[48:51], v[40:43], v[136:143], v44
  v_mfma_f32_32x32x16_bf16 v[192:207], v[136:139], a[100:103], v[192:207]
  ds_read_b64_tr_b16 v[128:129], v20 offset:24576
  ds_read_b64_tr_b16 v[130:131], v20 offset:25088
  v_fma_f32 v87, v87, v80, v81
  v_mul_f32 v86, v86, v174
  v_mul_f32 v87, v87, v175
  v_mfma_f32_32x32x16_bf16 v[208:223], v[140:143], a[100:103], v[208:223]
  ds_read_b64_tr_b16 v[132:133], v24 offset:24576
  ds_read_b64_tr_b16 v[134:135], v24 offset:25088
  buffer_load_dwordx4 v16, s[16:19], s70 offen offset:2048 lds
  v_exp_f32 v86, v86
  s_waitcnt lgkmcnt(8)
  v_mfma_f32_32x32x16_bf16 v[192:207], v[144:147], a[104:107], v[192:207]
  ds_read_b64_tr_b16 v[136:137], v20 offset:26624
  ds_read_b64_tr_b16 v[138:139], v20 offset:27136
  v_exp_f32_e64 v87, v87
  v_fma_f32 v86, v86, v82, v82
  v_fma_f32 v87, v87, v82, v82
  v_mfma_f32_32x32x16_bf16 v[208:223], v[148:151], a[104:107], v[208:223]
  ds_read_b64_tr_b16 v[140:141], v24 offset:26624
  ds_read_b64_tr_b16 v[142:143], v24 offset:27136
  v_rcp_f32 v86, v86
  s_waitcnt lgkmcnt(8)
  v_mfma_f32_32x32x16_bf16 v[192:207], v[152:155], a[108:111], v[192:207]
  ds_read_b64_tr_b16 v[144:145], v21 offset:24576
  ds_read_b64_tr_b16 v[146:147], v21 offset:25088
  buffer_load_dwordx4 v17, s[16:19], s70 offen offset:3072 lds
  v_rcp_f32 v87, v87
  v_mul_f32 v174, v174, v86
  v_mfma_f32_32x32x16_bf16 v[208:223], v[156:159], a[108:111], v[208:223]
  s_waitcnt vmcnt(24)
  s_barrier
  ds_read_b64_tr_b16 v[148:149], v25 offset:24576
  ds_read_b64_tr_b16 v[150:151], v25 offset:25088
  v_mul_f32 v175, v175, v87
  s_waitcnt lgkmcnt(8)
  v_mfma_f32_32x32x16_bf16 v[192:207], v[128:131], a[112:115], v[192:207]
  ds_read_b64_tr_b16 v[152:153], v21 offset:26624
  ds_read_b64_tr_b16 v[154:155], v21 offset:27136
  v_cvt_pk_bf16_f32 v168, v168, v169
  v_cvt_pk_bf16_f32 v169, v170, v171
  v_cvt_pk_bf16_f32 v170, v172, v173
  v_cvt_pk_bf16_f32 v171, v174, v175
  v_mfma_f32_32x32x16_bf16 v[208:223], v[132:135], a[112:115], v[208:223]
  ds_read_b64_tr_b16 v[156:157], v25 offset:26624
  ds_read_b64_tr_b16 v[158:159], v25 offset:27136
  s_mov_b32 m0, s37
  buffer_store_dwordx4 v[168:171], v1, s[12:15], s76 offen offset:1024 sc1
  v_mul_f32_e64 v84, v176, v176
  s_waitcnt lgkmcnt(8)
  v_mfma_f32_32x32x16_bf16 v[192:207], v[136:139], a[116:119], v[192:207]
  ds_read_b64_tr_b16 v[128:129], v18 offset:28672
  ds_read_b64_tr_b16 v[130:131], v18 offset:29184
  v_mul_f32 v85, v177, v177
  v_fma_f32 v84, v84, v80, v81
  v_fma_f32 v85, v85, v80, v81
  v_mul_f32 v84, v84, v176
  v_mfma_f32_32x32x16_bf16 v[208:223], v[140:143], a[116:119], v[208:223]
  ds_read_b64_tr_b16 v[132:133], v22 offset:28672
  ds_read_b64_tr_b16 v[134:135], v22 offset:29184
  v_mul_f32 v85, v85, v177
  v_exp_f32_e64 v84, v84
  s_waitcnt lgkmcnt(8)
  v_mfma_f32_32x32x16_bf16 v[192:207], v[144:147], a[120:123], v[192:207]
  ds_read_b64_tr_b16 v[136:137], v18 offset:30720
  ds_read_b64_tr_b16 v[138:139], v18 offset:31232
  buffer_load_dwordx4 v14, s[16:19], s71 offen offset:0 lds
  v_exp_f32_e64 v85, v85
  v_fma_f32 v84, v84, v82, v82
  v_mfma_f32_32x32x16_bf16 v[208:223], v[148:151], a[120:123], v[208:223]
  ds_read_b64_tr_b16 v[140:141], v22 offset:30720
  ds_read_b64_tr_b16 v[142:143], v22 offset:31232
  v_fma_f32 v85, v85, v82, v82
  v_rcp_f32 v84, v84
  s_waitcnt lgkmcnt(8)
  v_mfma_f32_32x32x16_bf16 v[192:207], v[152:155], a[124:127], v[192:207]
  ds_read_b64_tr_b16 v[144:145], v19 offset:28672
  ds_read_b64_tr_b16 v[146:147], v19 offset:29184
  v_rcp_f32 v85, v85
  v_mul_f32 v176, v176, v84
  v_mul_f32_e64 v177, v177, v85
  v_mfma_f32_32x32x16_bf16 v[208:223], v[156:159], a[124:127], v[208:223]
  ds_read_b64_tr_b16 v[148:149], v23 offset:28672
  ds_read_b64_tr_b16 v[150:151], v23 offset:29184
  buffer_load_dwordx4 v15, s[16:19], s71 offen offset:1024 lds
  v_mul_f32 v86, v178, v178
  v_mul_f32_e64 v87, v179, v179
  s_waitcnt lgkmcnt(8)
  v_mfma_f32_32x32x16_bf16 v[192:207], v[128:131], a[128:131], v[192:207]
  ds_read_b64_tr_b16 v[152:153], v19 offset:30720
  ds_read_b64_tr_b16 v[154:155], v19 offset:31232
  buffer_load_dwordx4 v16, s[16:19], s71 offen offset:2048 lds
  v_fma_f32 v86, v86, v80, v81
  v_fma_f32 v87, v87, v80, v81
  v_mul_f32_e64 v86, v86, v178
  v_mfma_f32_32x32x16_bf16 v[208:223], v[132:135], a[128:131], v[208:223]
  ds_read_b64_tr_b16 v[156:157], v23 offset:30720
  ds_read_b64_tr_b16 v[158:159], v23 offset:31232
  v_mul_f32 v87, v87, v179
  v_exp_f32 v86, v86
  v_smfmac_f32_16x16x64_bf16 v[48:51], v[40:43], v[128:135], v44
  s_waitcnt lgkmcnt(8)
  s_nop 0
  v_smfmac_f32_16x16x64_bf16 v[48:51], v[40:43], v[136:143], v44
  v_mfma_f32_32x32x16_bf16 v[192:207], v[136:139], a[132:135], v[192:207]
  ds_read_b64_tr_b16 v[128:129], v20 offset:28672
  ds_read_b64_tr_b16 v[130:131], v20 offset:29184
  v_exp_f32 v87, v87
  v_fma_f32 v86, v86, v82, v82
  v_add_f32 v78, v48, v49
  v_mfma_f32_32x32x16_bf16 v[208:223], v[140:143], a[132:135], v[208:223]
  ds_read_b64_tr_b16 v[132:133], v24 offset:28672
  ds_read_b64_tr_b16 v[134:135], v24 offset:29184
  buffer_load_dwordx4 v17, s[16:19], s71 offen offset:3072 lds
  ds_write_b32 v37, v78
  v_mov_b32 v48, 0
  s_waitcnt lgkmcnt(9)
  v_mfma_f32_32x32x16_bf16 v[192:207], v[144:147], a[136:139], v[192:207]
  ds_read_b64_tr_b16 v[136:137], v20 offset:30720
  ds_read_b64_tr_b16 v[138:139], v20 offset:31232
  v_mov_b32 v49, 0
  v_fma_f32 v87, v87, v82, v82
  v_rcp_f32 v86, v86
  v_mfma_f32_32x32x16_bf16 v[208:223], v[148:151], a[136:139], v[208:223]
  ds_read_b64_tr_b16 v[140:141], v24 offset:30720
  ds_read_b64_tr_b16 v[142:143], v24 offset:31232
  v_rcp_f32 v87, v87
  v_mul_f32_e64 v178, v178, v86
  s_waitcnt lgkmcnt(9)
  v_mfma_f32_32x32x16_bf16 v[192:207], v[152:155], a[140:143], v[192:207]
  ds_read_b64_tr_b16 v[144:145], v21 offset:28672
  ds_read_b64_tr_b16 v[146:147], v21 offset:29184
  v_mul_f32 v179, v179, v87
  v_mul_f32 v84, v180, v180
  v_mul_f32_e64 v85, v181, v181
  v_fma_f32 v84, v84, v80, v81
  v_mfma_f32_32x32x16_bf16 v[208:223], v[156:159], a[140:143], v[208:223]
  s_waitcnt vmcnt(25) lgkmcnt(6)
  s_barrier
  ds_read2st64_b32 v[74:75], v38 offset1:160
  ds_read2st64_b32 v[76:77], v39 offset1:160
  ds_read_b64_tr_b16 v[148:149], v25 offset:28672
  ds_read_b64_tr_b16 v[150:151], v25 offset:29184
  v_mfma_f32_32x32x16_bf16 v[192:207], v[128:131], a[144:147], v[192:207]
  ds_read_b64_tr_b16 v[152:153], v21 offset:30720
  ds_read_b64_tr_b16 v[154:155], v21 offset:31232
  v_fma_f32 v85, v85, v80, v81
  v_mul_f32 v84, v84, v180
  v_mul_f32_e64 v85, v85, v181
  s_mov_b32 m0, s42
  v_mfma_f32_32x32x16_bf16 v[208:223], v[132:135], a[144:147], v[208:223]
  ds_read_b64_tr_b16 v[156:157], v25 offset:30720
  ds_read_b64_tr_b16 v[158:159], v25 offset:31232
  buffer_load_dwordx4 v14, s[16:19], s72 offen offset:0 lds
  v_exp_f32 v84, v84
  s_waitcnt lgkmcnt(10)
  v_mfma_f32_32x32x16_bf16 v[192:207], v[136:139], a[148:151], v[192:207]
  ds_read_b64_tr_b16 v[128:129], v18 offset:8192
  ds_read_b64_tr_b16 v[130:131], v18 offset:8704
  v_exp_f32_e64 v85, v85
  v_fma_f32 v84, v84, v82, v82
  v_fma_f32 v85, v85, v82, v82
  v_mfma_f32_32x32x16_bf16 v[208:223], v[140:143], a[148:151], v[208:223]
  ds_read_b64_tr_b16 v[132:133], v22 offset:8192
  ds_read_b64_tr_b16 v[134:135], v22 offset:8704
  v_rcp_f32 v84, v84
  s_waitcnt lgkmcnt(8)
  v_mfma_f32_32x32x16_bf16 v[192:207], v[144:147], a[152:155], v[192:207]
  ds_read_b64_tr_b16 v[136:137], v18 offset:10240
  ds_read_b64_tr_b16 v[138:139], v18 offset:10752
  buffer_load_dwordx4 v15, s[16:19], s72 offen offset:1024 lds
  v_add_f32 v74, v74, v75
  v_add_f32 v76, v76, v77
  v_add_f32_e64 v74, v74, v76
  v_mfma_f32_32x32x16_bf16 v[208:223], v[148:151], a[152:155], v[208:223]
  ds_read_b64_tr_b16 v[140:141], v22 offset:10240
  ds_read_b64_tr_b16 v[142:143], v22 offset:10752
  v_cvt_pk_bf16_f32 v75, v74, v74
  v_and_b32 v75, 0xffff0000, v75
  v_sub_f32 v75, v74, v75
  s_waitcnt lgkmcnt(8)
  v_mfma_f32_32x32x16_bf16 v[192:207], v[152:155], a[156:159], v[192:207]
  ds_read_b64_tr_b16 v[144:145], v19 offset:8192
  ds_read_b64_tr_b16 v[146:147], v19 offset:8704
  v_cvt_pk_bf16_f32 v68, v74, v75
  v_cvt_pk_bf16_f32 v69, v74, v75
  v_rcp_f32_e64 v85, v85
  v_mfma_f32_32x32x16_bf16 v[208:223], v[156:159], a[156:159], v[208:223]
  ds_read_b64_tr_b16 v[148:149], v23 offset:8192
  ds_read_b64_tr_b16 v[150:151], v23 offset:8704
  buffer_load_dwordx4 v16, s[16:19], s72 offen offset:2048 lds
  v_mul_f32 v180, v180, v84
  v_mul_f32 v181, v181, v85
  v_mfma_f32_32x32x8_bf16 v[192:207], v[68:69], v[70:71], v[192:207]
  buffer_load_dwordx4 v17, s[16:19], s72 offen offset:3072 lds
  v_mul_f32 v86, v182, v182
  v_mul_f32 v87, v183, v183
  v_fma_f32 v86, v86, v80, v81
  v_fma_f32 v87, v87, v80, v81
  v_mul_f32_e64 v86, v86, v182
  v_mfma_f32_32x32x8_bf16 v[208:223], v[68:69], v[72:73], v[208:223]
  buffer_load_dword v4, v2, s[4:7], 0 offen offset:128
  v_mul_f32 v87, v87, v183
  v_exp_f32_e64 v86, v86
  s_waitcnt lgkmcnt(8)
  v_mfma_f32_32x32x16_bf16 v[224:239], v[128:131], a[0:3], 0
  ds_read_b64_tr_b16 v[152:153], v19 offset:10240
  ds_read_b64_tr_b16 v[154:155], v19 offset:10752
  v_exp_f32_e64 v87, v87
  v_fma_f32 v86, v86, v82, v82
  v_fma_f32 v87, v87, v82, v82
  v_mfma_f32_32x32x16_bf16 v[240:255], v[132:135], a[0:3], 0
  ds_read_b64_tr_b16 v[156:157], v23 offset:10240
  ds_read_b64_tr_b16 v[158:159], v23 offset:10752
  v_rcp_f32 v86, v86
  v_rcp_f32 v87, v87
  v_smfmac_f32_16x16x64_bf16 v[48:51], v[40:43], v[128:135], v44
  s_waitcnt lgkmcnt(8)
  s_nop 0
  v_smfmac_f32_16x16x64_bf16 v[48:51], v[40:43], v[136:143], v44
  v_mfma_f32_32x32x16_bf16 v[224:239], v[136:139], a[4:7], v[224:239]
  ds_read_b64_tr_b16 v[128:129], v20 offset:8192
  ds_read_b64_tr_b16 v[130:131], v20 offset:8704
  v_mul_f32 v182, v182, v86
  v_mul_f32 v183, v183, v87
  v_cvt_pk_bf16_f32 v176, v176, v177
  v_cvt_pk_bf16_f32 v177, v178, v179
  v_mfma_f32_32x32x16_bf16 v[240:255], v[140:143], a[4:7], v[240:255]
  ds_read_b64_tr_b16 v[132:133], v24 offset:8192
  ds_read_b64_tr_b16 v[134:135], v24 offset:8704
  v_cvt_pk_bf16_f32 v178, v180, v181
  v_cvt_pk_bf16_f32 v179, v182, v183
  s_waitcnt lgkmcnt(8)
  s_nop 0
  v_mfma_f32_32x32x16_bf16 v[224:239], v[144:147], a[8:11], v[224:239]
  ds_read_b64_tr_b16 v[136:137], v20 offset:10240
  ds_read_b64_tr_b16 v[138:139], v20 offset:10752
  buffer_store_dwordx4 v[176:179], v1, s[12:15], s76 offen offset:2048 sc1
  v_mul_f32 v84, v184, v184
  v_mul_f32 v85, v185, v185
  v_fma_f32 v84, v84, v80, v81
  v_mfma_f32_32x32x16_bf16 v[240:255], v[148:151], a[8:11], v[240:255]
  ds_read_b64_tr_b16 v[140:141], v24 offset:10240
  ds_read_b64_tr_b16 v[142:143], v24 offset:10752
  v_fma_f32 v85, v85, v80, v81
  v_mul_f32 v84, v84, v184
  v_mul_f32_e64 v85, v85, v185
  s_waitcnt lgkmcnt(8)
  v_mfma_f32_32x32x16_bf16 v[224:239], v[152:155], a[12:15], v[224:239]
  ds_read_b64_tr_b16 v[144:145], v21 offset:8192
  ds_read_b64_tr_b16 v[146:147], v21 offset:8704
  v_exp_f32 v84, v84
  v_exp_f32 v85, v85
  v_mfma_f32_32x32x16_bf16 v[240:255], v[156:159], a[12:15], v[240:255]
  s_waitcnt vmcnt(27)
  s_barrier
  ds_read_b64_tr_b16 v[148:149], v25 offset:8192
  ds_read_b64_tr_b16 v[150:151], v25 offset:8704
  v_fma_f32 v84, v84, v82, v82
  s_waitcnt lgkmcnt(8)
  s_nop 0
  v_mfma_f32_32x32x16_bf16 v[224:239], v[128:131], a[16:19], v[224:239]
  ds_read_b64_tr_b16 v[152:153], v21 offset:10240
  ds_read_b64_tr_b16 v[154:155], v21 offset:10752
  v_fma_f32 v85, v85, v82, v82
  v_rcp_f32 v84, v84
  s_mov_b32 m0, s43
  v_mfma_f32_32x32x16_bf16 v[240:255], v[132:135], a[16:19], v[240:255]
  ds_read_b64_tr_b16 v[156:157], v25 offset:10240
  ds_read_b64_tr_b16 v[158:159], v25 offset:10752
  buffer_load_dwordx4 v14, s[16:19], s73 offen offset:0 lds
  v_rcp_f32 v85, v85
  s_waitcnt lgkmcnt(8)
  v_mfma_f32_32x32x16_bf16 v[224:239], v[136:139], a[20:23], v[224:239]
  ds_read_b64_tr_b16 v[128:129], v18 offset:12288
  ds_read_b64_tr_b16 v[130:131], v18 offset:12800
  v_mul_f32 v184, v184, v84
  v_mul_f32 v185, v185, v85
  v_mul_f32 v86, v186, v186
  v_mul_f32 v87, v187, v187
  v_mfma_f32_32x32x16_bf16 v[240:255], v[140:143], a[20:23], v[240:255]
  ds_read_b64_tr_b16 v[132:133], v22 offset:12288
  ds_read_b64_tr_b16 v[134:135], v22 offset:12800
  v_fma_f32 v86, v86, v80, v81
  v_fma_f32 v87, v87, v80, v81
  v_mul_f32 v86, v86, v186
  s_waitcnt lgkmcnt(8)
  v_mfma_f32_32x32x16_bf16 v[224:239], v[144:147], a[24:27], v[224:239]
  ds_read_b64_tr_b16 v[136:137], v18 offset:14336
  ds_read_b64_tr_b16 v[138:139], v18 offset:14848
  buffer_load_dwordx4 v15, s[16:19], s73 offen offset:1024 lds
  v_mul_f32 v87, v87, v187
  v_exp_f32 v86, v86
  v_mfma_f32_32x32x16_bf16 v[240:255], v[148:151], a[24:27], v[240:255]
  ds_read_b64_tr_b16 v[140:141], v22 offset:14336
  ds_read_b64_tr_b16 v[142:143], v22 offset:14848
  v_exp_f32 v87, v87
  v_fma_f32 v86, v86, v82, v82
  s_waitcnt lgkmcnt(8)
  v_mfma_f32_32x32x16_bf16 v[224:239], v[152:155], a[28:31], v[224:239]
  ds_read_b64_tr_b16 v[144:145], v19 offset:12288
  ds_read_b64_tr_b16 v[146:147], v19 offset:12800
  v_fma_f32 v87, v87, v82, v82
  v_rcp_f32_e64 v86, v86
  v_mfma_f32_32x32x16_bf16 v[240:255], v[156:159], a[28:31], v[240:255]
  ds_read_b64_tr_b16 v[148:149], v23 offset:12288
  ds_read_b64_tr_b16 v[150:151], v23 offset:12800
  buffer_load_dwordx4 v16, s[16:19], s73 offen offset:2048 lds
  v_rcp_f32 v87, v87
  s_waitcnt lgkmcnt(8)
  v_mfma_f32_32x32x16_bf16 v[224:239], v[128:131], a[32:35], v[224:239]
  ds_read_b64_tr_b16 v[152:153], v19 offset:14336
  ds_read_b64_tr_b16 v[154:155], v19 offset:14848
  buffer_load_dwordx4 v17, s[16:19], s73 offen offset:3072 lds
  v_mul_f32 v186, v186, v86
  v_mul_f32 v187, v187, v87
  v_mul_f32_e64 v84, v188, v188
  v_mfma_f32_32x32x16_bf16 v[240:255], v[132:135], a[32:35], v[240:255]
  ds_read_b64_tr_b16 v[156:157], v23 offset:14336
  ds_read_b64_tr_b16 v[158:159], v23 offset:14848
  v_mul_f32 v85, v189, v189
  v_fma_f32 v84, v84, v80, v81
  v_fma_f32 v85, v85, v80, v81
  v_mul_f32 v84, v84, v188
  v_smfmac_f32_16x16x64_bf16 v[48:51], v[40:43], v[128:135], v44
  s_waitcnt lgkmcnt(8)
  s_nop 0
  v_smfmac_f32_16x16x64_bf16 v[48:51], v[40:43], v[136:143], v44
  v_mfma_f32_32x32x16_bf16 v[224:239], v[136:139], a[36:39], v[224:239]
  ds_read_b64_tr_b16 v[128:129], v20 offset:12288
  ds_read_b64_tr_b16 v[130:131], v20 offset:12800
  v_mul_f32 v85, v85, v189
  v_exp_f32 v84, v84
  v_mfma_f32_32x32x16_bf16 v[240:255], v[140:143], a[36:39], v[240:255]
  ds_read_b64_tr_b16 v[132:133], v24 offset:12288
  ds_read_b64_tr_b16 v[134:135], v24 offset:12800
  v_exp_f32 v85, v85
  v_fma_f32 v84, v84, v82, v82
  s_waitcnt lgkmcnt(8)
  v_mfma_f32_32x32x16_bf16 v[224:239], v[144:147], a[40:43], v[224:239]
  ds_read_b64_tr_b16 v[136:137], v20 offset:14336
  ds_read_b64_tr_b16 v[138:139], v20 offset:14848
  v_fma_f32 v85, v85, v82, v82
  v_rcp_f32_e64 v84, v84
  v_mfma_f32_32x32x16_bf16 v[240:255], v[148:151], a[40:43], v[240:255]
  ds_read_b64_tr_b16 v[140:141], v24 offset:14336
  ds_read_b64_tr_b16 v[142:143], v24 offset:14848
  v_rcp_f32 v85, v85
  v_mul_f32_e64 v188, v188, v84
  s_waitcnt lgkmcnt(8)
  v_mfma_f32_32x32x16_bf16 v[224:239], v[152:155], a[44:47], v[224:239]
  ds_read_b64_tr_b16 v[144:145], v21 offset:12288
  ds_read_b64_tr_b16 v[146:147], v21 offset:12800
  v_mul_f32 v189, v189, v85
  v_mul_f32 v86, v190, v190
  v_mul_f32_e64 v87, v191, v191
  v_fma_f32 v86, v86, v80, v81
  v_mfma_f32_32x32x16_bf16 v[240:255], v[156:159], a[44:47], v[240:255]
  s_waitcnt vmcnt(25)
  s_barrier
  ds_read_b64_tr_b16 v[148:149], v25 offset:12288
  ds_read_b64_tr_b16 v[150:151], v25 offset:12800
  v_fma_f32 v87, v87, v80, v81
  s_waitcnt lgkmcnt(8)
  s_nop 0
  v_mfma_f32_32x32x16_bf16 v[224:239], v[128:131], a[48:51], v[224:239]
  ds_read_b64_tr_b16 v[152:153], v21 offset:14336
  ds_read_b64_tr_b16 v[154:155], v21 offset:14848
  v_mul_f32 v86, v86, v190
  v_mul_f32 v87, v87, v191
  v_exp_f32_e64 v86, v86
  v_mfma_f32_32x32x16_bf16 v[240:255], v[132:135], a[48:51], v[240:255]
  ds_read_b64_tr_b16 v[156:157], v25 offset:14336
  ds_read_b64_tr_b16 v[158:159], v25 offset:14848
  s_mov_b32 m0, s38
  v_exp_f32_e64 v87, v87
  s_waitcnt lgkmcnt(8)
  v_mfma_f32_32x32x16_bf16 v[224:239], v[136:139], a[52:55], v[224:239]
  ds_read_b64_tr_b16 v[128:129], v18 offset:0
  ds_read_b64_tr_b16 v[130:131], v18 offset:512
  v_fma_f32 v86, v86, v82, v82
  v_fma_f32 v87, v87, v82, v82
  v_rcp_f32_e64 v86, v86
  v_mfma_f32_32x32x16_bf16 v[240:255], v[140:143], a[52:55], v[240:255]
  ds_read_b64_tr_b16 v[132:133], v22 offset:0
  ds_read_b64_tr_b16 v[134:135], v22 offset:512
  v_rcp_f32 v87, v87
  v_mul_f32_e64 v190, v190, v86
  s_waitcnt lgkmcnt(8)
  v_mfma_f32_32x32x16_bf16 v[224:239], v[144:147], a[56:59], v[224:239]
  ds_read_b64_tr_b16 v[136:137], v18 offset:2048
  ds_read_b64_tr_b16 v[138:139], v18 offset:2560
  buffer_load_dwordx4 v14, s[16:19], s74 offen offset:0 lds
  v_mul_f32_e64 v191, v191, v87
  v_cvt_pk_bf16_f32 v184, v184, v185
  v_cvt_pk_bf16_f32 v185, v186, v187
  v_mfma_f32_32x32x16_bf16 v[240:255], v[148:151], a[56:59], v[240:255]
  ds_read_b64_tr_b16 v[140:141], v22 offset:2048
  ds_read_b64_tr_b16 v[142:143], v22 offset:2560
  v_cvt_pk_bf16_f32 v186, v188, v189
  v_cvt_pk_bf16_f32 v187, v190, v191
  s_waitcnt lgkmcnt(8)
  s_nop 0
  v_mfma_f32_32x32x16_bf16 v[224:239], v[152:155], a[60:63], v[224:239]
  ds_read_b64_tr_b16 v[144:145], v19 offset:0
  ds_read_b64_tr_b16 v[146:147], v19 offset:512
  buffer_store_dwordx4 v[184:187], v1, s[12:15], s76 offen offset:3072 sc1
  v_mul_f32 v192, v46, v192
  v_mul_f32 v193, v46, v193
  v_mul_f32_e64 v194, v46, v194
  v_mfma_f32_32x32x16_bf16 v[240:255], v[156:159], a[60:63], v[240:255]
  ds_read_b64_tr_b16 v[148:149], v23 offset:0
  ds_read_b64_tr_b16 v[150:151], v23 offset:512
  buffer_load_dwordx4 v15, s[16:19], s74 offen offset:1024 lds
  v_mul_f32 v195, v46, v195
  v_mul_f32_e64 v196, v46, v196
  s_waitcnt lgkmcnt(8)
  v_mfma_f32_32x32x16_bf16 v[224:239], v[128:131], a[64:67], v[224:239]
  ds_read_b64_tr_b16 v[152:153], v19 offset:2048
  ds_read_b64_tr_b16 v[154:155], v19 offset:2560
  buffer_load_dwordx4 v16, s[16:19], s74 offen offset:2048 lds
  ds_read_b64_tr_b16 v[112:113], v18 offset:36864
  ds_read_b64_tr_b16 v[114:115], v18 offset:37376
  ds_read_b64_tr_b16 v[116:117], v22 offset:36864
  v_mfma_f32_32x32x16_bf16 v[240:255], v[132:135], a[64:67], v[240:255]
  ds_read_b64_tr_b16 v[156:157], v23 offset:2048
  ds_read_b64_tr_b16 v[158:159], v23 offset:2560
  ds_read_b64_tr_b16 v[118:119], v22 offset:37376
  s_add_u32 s80, s81, 96256
  v_mul_f32 v197, v46, v197
  v_mul_f32 v198, v46, v198
  v_smfmac_f32_16x16x64_bf16 v[48:51], v[40:43], v[128:135], v44
  s_waitcnt lgkmcnt(12)
  s_nop 0
  v_smfmac_f32_16x16x64_bf16 v[48:51], v[40:43], v[136:143], v44
  v_mfma_f32_32x32x16_bf16 v[224:239], v[136:139], a[68:71], v[224:239]
  ds_read_b64_tr_b16 v[128:129], v20 offset:0
  ds_read_b64_tr_b16 v[130:131], v20 offset:512
  v_mul_f32_e64 v199, v46, v199
  v_cvt_pk_bf16_f32 v192, v192, v193
  v_cvt_pk_bf16_f32 v193, v194, v195
  v_cvt_pk_bf16_f32 v194, v196, v197
  v_mfma_f32_32x32x16_bf16 v[240:255], v[140:143], a[68:71], v[240:255]
  ds_read_b64_tr_b16 v[132:133], v24 offset:0
  ds_read_b64_tr_b16 v[134:135], v24 offset:512
  buffer_load_dwordx4 v17, s[16:19], s74 offen offset:3072 lds
  v_cvt_pk_bf16_f32 v195, v198, v199
  s_waitcnt lgkmcnt(12)
  s_nop 0
  v_mfma_f32_32x32x16_bf16 v[224:239], v[144:147], a[72:75], v[224:239]
  ds_read_b64_tr_b16 v[136:137], v20 offset:2048
  ds_read_b64_tr_b16 v[138:139], v20 offset:2560
  ds_write_b128 v26, v[192:195] offset:32768
  v_mul_f32 v200, v46, v200
  v_mul_f32 v201, v46, v201
  v_mul_f32_e64 v202, v46, v202
  v_mfma_f32_32x32x16_bf16 v[240:255], v[148:151], a[72:75], v[240:255]
  ds_read_b64_tr_b16 v[140:141], v24 offset:2048
  ds_read_b64_tr_b16 v[142:143], v24 offset:2560
  v_mul_f32 v203, v46, v203
  v_mul_f32 v204, v46, v204
  v_mul_f32 v205, v46, v205
  s_waitcnt lgkmcnt(10)
  v_mfma_f32_32x32x16_bf16 v[224:239], v[152:155], a[76:79], v[224:239]
  ds_read_b64_tr_b16 v[144:145], v21 offset:0
  ds_read_b64_tr_b16 v[146:147], v21 offset:512
  v_mul_f32 v206, v46, v206
  v_mul_f32 v207, v46, v207
  v_cvt_pk_bf16_f32 v200, v200, v201
  v_cvt_pk_bf16_f32 v201, v202, v203
  v_mfma_f32_32x32x16_bf16 v[240:255], v[156:159], a[76:79], v[240:255]
  s_waitcnt vmcnt(25)
  s_barrier
  ds_read_b64_tr_b16 v[148:149], v25 offset:0
  ds_read_b64_tr_b16 v[150:151], v25 offset:512
  v_cvt_pk_bf16_f32 v202, v204, v205
  s_waitcnt lgkmcnt(9)
  s_nop 0
  v_mfma_f32_32x32x16_bf16 v[224:239], v[128:131], a[80:83], v[224:239]
  ds_read_b64_tr_b16 v[152:153], v21 offset:2048
  ds_read_b64_tr_b16 v[154:155], v21 offset:2560
  buffer_store_dwordx4 v[112:115], v36, s[12:15], s81 offen sc1
  buffer_store_dwordx4 v[116:119], v36, s[12:15], s80 offen sc1
  v_cvt_pk_bf16_f32 v203, v206, v207
  s_mov_b32 m0, s39
  s_nop 0
  v_mfma_f32_32x32x16_bf16 v[240:255], v[132:135], a[80:83], v[240:255]
  ds_read_b64_tr_b16 v[156:157], v25 offset:2048
  ds_read_b64_tr_b16 v[158:159], v25 offset:2560
  buffer_load_dwordx4 v14, s[16:19], s75 offen offset:0 lds
  ds_write_b128 v27, v[200:203] offset:32768
  v_mul_f32 v208, v46, v208
  s_waitcnt lgkmcnt(9)
  v_mfma_f32_32x32x16_bf16 v[224:239], v[136:139], a[84:87], v[224:239]
  ds_read_b64_tr_b16 v[128:129], v18 offset:16384
  ds_read_b64_tr_b16 v[130:131], v18 offset:16896
  v_mul_f32 v209, v46, v209
  v_mul_f32 v210, v46, v210
  v_mul_f32 v211, v46, v211
  v_mul_f32 v212, v46, v212
  v_mfma_f32_32x32x16_bf16 v[240:255], v[140:143], a[84:87], v[240:255]
  ds_read_b64_tr_b16 v[132:133], v22 offset:16384
  ds_read_b64_tr_b16 v[134:135], v22 offset:16896
  v_mul_f32 v213, v46, v213
  v_mul_f32 v214, v46, v214
  v_mul_f32 v215, v46, v215
  s_waitcnt lgkmcnt(9)
  v_mfma_f32_32x32x16_bf16 v[224:239], v[144:147], a[88:91], v[224:239]
  ds_read_b64_tr_b16 v[136:137], v18 offset:18432
  ds_read_b64_tr_b16 v[138:139], v18 offset:18944
  buffer_load_dwordx4 v15, s[16:19], s75 offen offset:1024 lds
  v_cvt_pk_bf16_f32 v208, v208, v209
  v_cvt_pk_bf16_f32 v209, v210, v211
  v_cvt_pk_bf16_f32 v210, v212, v213
  v_mfma_f32_32x32x16_bf16 v[240:255], v[148:151], a[88:91], v[240:255]
  ds_read_b64_tr_b16 v[140:141], v22 offset:18432
  ds_read_b64_tr_b16 v[142:143], v22 offset:18944
  v_cvt_pk_bf16_f32 v211, v214, v215
  s_waitcnt lgkmcnt(9)
  s_nop 0
  v_mfma_f32_32x32x16_bf16 v[224:239], v[152:155], a[92:95], v[224:239]
  ds_read_b64_tr_b16 v[144:145], v19 offset:16384
  ds_read_b64_tr_b16 v[146:147], v19 offset:16896
  ds_write_b128 v28, v[208:211] offset:32768
  v_mul_f32 v216, v46, v216
  v_mul_f32 v217, v46, v217
  v_mul_f32_e64 v218, v46, v218
  v_mfma_f32_32x32x16_bf16 v[240:255], v[156:159], a[92:95], v[240:255]
  ds_read_b64_tr_b16 v[148:149], v23 offset:16384
  ds_read_b64_tr_b16 v[150:151], v23 offset:16896
  buffer_load_dwordx4 v16, s[16:19], s75 offen offset:2048 lds
  v_mul_f32 v219, v46, v219
  v_mul_f32_e64 v220, v46, v220
  s_waitcnt lgkmcnt(9)
  v_mfma_f32_32x32x16_bf16 v[224:239], v[128:131], a[96:99], v[224:239]
  ds_read_b64_tr_b16 v[152:153], v19 offset:18432
  ds_read_b64_tr_b16 v[154:155], v19 offset:18944
  buffer_load_dwordx4 v17, s[16:19], s75 offen offset:3072 lds
  v_mul_f32 v221, v46, v221
  v_mul_f32 v222, v46, v222
  v_mul_f32_e64 v223, v46, v223
  v_mfma_f32_32x32x16_bf16 v[240:255], v[132:135], a[96:99], v[240:255]
  ds_read_b64_tr_b16 v[156:157], v23 offset:18432
  ds_read_b64_tr_b16 v[158:159], v23 offset:18944
  v_cvt_pk_bf16_f32 v216, v216, v217
  v_cvt_pk_bf16_f32 v217, v218, v219
  v_cvt_pk_bf16_f32 v218, v220, v221
  v_cvt_pk_bf16_f32 v219, v222, v223
  v_smfmac_f32_16x16x64_bf16 v[48:51], v[40:43], v[128:135], v44
  s_waitcnt lgkmcnt(9)
  s_nop 0
  v_smfmac_f32_16x16x64_bf16 v[48:51], v[40:43], v[136:143], v44
  v_mfma_f32_32x32x16_bf16 v[224:239], v[136:139], a[100:103], v[224:239]
  ds_read_b64_tr_b16 v[128:129], v20 offset:16384
  ds_read_b64_tr_b16 v[130:131], v20 offset:16896
  ds_write_b128 v29, v[216:219] offset:32768
  ds_read_b64_tr_b16 v[196:197], v30 offset:32768
  ds_read_b64_tr_b16 v[198:199], v31 offset:33280
  ds_read_b64_tr_b16 v[204:205], v32 offset:33792
  v_mfma_f32_32x32x16_bf16 v[240:255], v[140:143], a[100:103], v[240:255]
  ds_read_b64_tr_b16 v[132:133], v24 offset:16384
  ds_read_b64_tr_b16 v[134:135], v24 offset:16896
  buffer_load_dword v4, v2, s[4:7], 0 offen offset:256
  ds_read_b64_tr_b16 v[206:207], v33 offset:34304
  ds_read_b64_tr_b16 v[212:213], v30 offset:34816
  s_waitcnt lgkmcnt(14)
  s_nop 0
  v_mfma_f32_32x32x16_bf16 v[224:239], v[144:147], a[104:107], v[224:239]
  ds_read_b64_tr_b16 v[136:137], v20 offset:18432
  ds_read_b64_tr_b16 v[138:139], v20 offset:18944
  ds_read_b64_tr_b16 v[214:215], v31 offset:35328
  ds_read_b64_tr_b16 v[220:221], v32 offset:35840
  ds_read_b64_tr_b16 v[222:223], v33 offset:36352
  v_mfma_f32_32x32x16_bf16 v[240:255], v[148:151], a[104:107], v[240:255]
  ds_read_b64_tr_b16 v[140:141], v24 offset:18432
  ds_read_b64_tr_b16 v[142:143], v24 offset:18944
  s_waitcnt lgkmcnt(15)
  s_nop 0
  v_mfma_f32_32x32x16_bf16 v[224:239], v[152:155], a[108:111], v[224:239]
  ds_read_b64_tr_b16 v[144:145], v21 offset:16384
  ds_read_b64_tr_b16 v[146:147], v21 offset:16896
  v_mfma_f32_32x32x16_bf16 v[240:255], v[156:159], a[108:111], v[240:255]
  s_waitcnt vmcnt(27)
  s_barrier
  ds_read_b64_tr_b16 v[148:149], v25 offset:16384
  ds_read_b64_tr_b16 v[150:151], v25 offset:16896
  s_waitcnt lgkmcnt(13)
  s_nop 0
  v_mfma_f32_32x32x16_bf16 v[224:239], v[128:131], a[112:115], v[224:239]
  ds_read_b64_tr_b16 v[152:153], v21 offset:18432
  ds_read_b64_tr_b16 v[154:155], v21 offset:18944
  buffer_store_dwordx4 v[196:199], v1, s[12:15], s77 offen offset:0 sc1
  v_mfma_f32_32x32x16_bf16 v[240:255], v[132:135], a[112:115], v[240:255]
  ds_read_b64_tr_b16 v[156:157], v25 offset:18432
  ds_read_b64_tr_b16 v[158:159], v25 offset:18944
  s_waitcnt lgkmcnt(8)
  s_nop 0
  v_mfma_f32_32x32x16_bf16 v[224:239], v[136:139], a[116:119], v[224:239]
  ds_read_b64_tr_b16 v[128:129], v18 offset:20480
  ds_read_b64_tr_b16 v[130:131], v18 offset:20992
  buffer_store_dwordx4 v[204:207], v1, s[12:15], s77 offen offset:1024 sc1
  buffer_store_dwordx4 v[212:215], v1, s[12:15], s77 offen offset:2048 sc1
  buffer_store_dwordx4 v[220:223], v1, s[12:15], s77 offen offset:3072 sc1
  v_mfma_f32_32x32x16_bf16 v[240:255], v[140:143], a[116:119], v[240:255]
  ds_read_b64_tr_b16 v[132:133], v22 offset:20480
  ds_read_b64_tr_b16 v[134:135], v22 offset:20992
  s_waitcnt lgkmcnt(8)
  s_nop 0
  v_mfma_f32_32x32x16_bf16 v[224:239], v[144:147], a[120:123], v[224:239]
  ds_read_b64_tr_b16 v[136:137], v18 offset:22528
  ds_read_b64_tr_b16 v[138:139], v18 offset:23040
  v_mfma_f32_32x32x16_bf16 v[240:255], v[148:151], a[120:123], v[240:255]
  ds_read_b64_tr_b16 v[140:141], v22 offset:22528
  ds_read_b64_tr_b16 v[142:143], v22 offset:23040
  s_waitcnt lgkmcnt(8)
  s_nop 0
  v_mfma_f32_32x32x16_bf16 v[224:239], v[152:155], a[124:127], v[224:239]
  ds_read_b64_tr_b16 v[144:145], v19 offset:20480
  ds_read_b64_tr_b16 v[146:147], v19 offset:20992
  v_mfma_f32_32x32x16_bf16 v[240:255], v[156:159], a[124:127], v[240:255]
  ds_read_b64_tr_b16 v[148:149], v23 offset:20480
  ds_read_b64_tr_b16 v[150:151], v23 offset:20992
  s_waitcnt lgkmcnt(8)
  s_nop 0
  v_mfma_f32_32x32x16_bf16 v[224:239], v[128:131], a[128:131], v[224:239]
  ds_read_b64_tr_b16 v[152:153], v19 offset:22528
  ds_read_b64_tr_b16 v[154:155], v19 offset:23040
  v_mfma_f32_32x32x16_bf16 v[240:255], v[132:135], a[128:131], v[240:255]
  ds_read_b64_tr_b16 v[156:157], v23 offset:22528
  ds_read_b64_tr_b16 v[158:159], v23 offset:23040
  v_smfmac_f32_16x16x64_bf16 v[48:51], v[40:43], v[128:135], v44
  s_waitcnt lgkmcnt(8)
  s_nop 0
  v_smfmac_f32_16x16x64_bf16 v[48:51], v[40:43], v[136:143], v44
  v_mfma_f32_32x32x16_bf16 v[224:239], v[136:139], a[132:135], v[224:239]
  ds_read_b64_tr_b16 v[128:129], v20 offset:20480
  ds_read_b64_tr_b16 v[130:131], v20 offset:20992
  v_mfma_f32_32x32x16_bf16 v[240:255], v[140:143], a[132:135], v[240:255]
  ds_read_b64_tr_b16 v[132:133], v24 offset:20480
  ds_read_b64_tr_b16 v[134:135], v24 offset:20992
  v_add_f32 v78, v48, v49
  s_waitcnt lgkmcnt(8)
  v_mfma_f32_32x32x16_bf16 v[224:239], v[144:147], a[136:139], v[224:239]
  ds_read_b64_tr_b16 v[136:137], v20 offset:22528
  ds_read_b64_tr_b16 v[138:139], v20 offset:23040
  ds_write_b32 v37, v78
  v_mov_b32 v48, 0
  v_mov_b32 v49, 0
  v_mfma_f32_32x32x16_bf16 v[240:255], v[148:151], a[136:139], v[240:255]
  ds_read_b64_tr_b16 v[140:141], v24 offset:22528
  ds_read_b64_tr_b16 v[142:143], v24 offset:23040
  s_waitcnt lgkmcnt(9)
  s_nop 0
  v_mfma_f32_32x32x16_bf16 v[224:239], v[152:155], a[140:143], v[224:239]
  ds_read_b64_tr_b16 v[144:145], v21 offset:20480
  ds_read_b64_tr_b16 v[146:147], v21 offset:20992
  v_mfma_f32_32x32x16_bf16 v[240:255], v[156:159], a[140:143], v[240:255]
  s_waitcnt vmcnt(26) lgkmcnt(4)
  s_barrier
  ds_read2st64_b32 v[74:75], v38 offset1:160
  ds_read2st64_b32 v[76:77], v39 offset1:160
  ds_read_b64_tr_b16 v[148:149], v25 offset:20480
  ds_read_b64_tr_b16 v[150:151], v25 offset:20992
  v_mfma_f32_32x32x16_bf16 v[224:239], v[128:131], a[144:147], v[224:239]
  ds_read_b64_tr_b16 v[152:153], v21 offset:22528
  ds_read_b64_tr_b16 v[154:155], v21 offset:23040
  v_mfma_f32_32x32x16_bf16 v[240:255], v[132:135], a[144:147], v[240:255]
  ds_read_b64_tr_b16 v[156:157], v25 offset:22528
  ds_read_b64_tr_b16 v[158:159], v25 offset:23040
  s_waitcnt lgkmcnt(10)
  s_nop 0
  v_mfma_f32_32x32x16_bf16 v[224:239], v[136:139], a[148:151], v[224:239]
  ds_read_b64_tr_b16 v[128:129], v18 offset:4096
  ds_read_b64_tr_b16 v[130:131], v18 offset:4608
  v_mfma_f32_32x32x16_bf16 v[240:255], v[140:143], a[148:151], v[240:255]
  ds_read_b64_tr_b16 v[132:133], v22 offset:4096
  ds_read_b64_tr_b16 v[134:135], v22 offset:4608
  s_waitcnt lgkmcnt(8)
  s_nop 0
  v_mfma_f32_32x32x16_bf16 v[224:239], v[144:147], a[152:155], v[224:239]
  ds_read_b64_tr_b16 v[136:137], v18 offset:6144
  ds_read_b64_tr_b16 v[138:139], v18 offset:6656
  v_add_f32 v74, v74, v75
  v_add_f32 v76, v76, v77
  v_add_f32_e64 v74, v74, v76
  v_cvt_pk_bf16_f32 v75, v74, v74
  v_mfma_f32_32x32x16_bf16 v[240:255], v[148:151], a[152:155], v[240:255]
  ds_read_b64_tr_b16 v[140:141], v22 offset:6144
  ds_read_b64_tr_b16 v[142:143], v22 offset:6656
  v_and_b32 v75, 0xffff0000, v75
  v_sub_f32 v75, v74, v75
  v_cvt_pk_bf16_f32 v68, v74, v75
  s_waitcnt lgkmcnt(8)
  v_mfma_f32_32x32x16_bf16 v[224:239], v[152:155], a[156:159], v[224:239]
  ds_read_b64_tr_b16 v[144:145], v19 offset:4096
  ds_read_b64_tr_b16 v[146:147], v19 offset:4608
  v_cvt_pk_bf16_f32 v69, v74, v75
  v_mfma_f32_32x32x16_bf16 v[240:255], v[156:159], a[156:159], v[240:255]
  ds_read_b64_tr_b16 v[148:149], v23 offset:4096
  ds_read_b64_tr_b16 v[150:151], v23 offset:4608
  v_mfma_f32_32x32x8_bf16 v[224:239], v[68:69], v[70:71], v[224:239]
  v_mfma_f32_32x32x8_bf16 v[240:255], v[68:69], v[72:73], v[240:255]
  s_waitcnt lgkmcnt(8)
  s_nop 0
  v_mfma_f32_32x32x16_bf16 v[160:175], v[128:131], a[0:3], 0
  ds_read_b64_tr_b16 v[152:153], v19 offset:6144
  ds_read_b64_tr_b16 v[154:155], v19 offset:6656
  v_mul_f32 v224, v47, v224
  v_mul_f32 v225, v47, v225
  v_mul_f32 v226, v47, v226
  v_mul_f32 v227, v47, v227
  v_mfma_f32_32x32x16_bf16 v[176:191], v[132:135], a[0:3], 0
  ds_read_b64_tr_b16 v[156:157], v23 offset:6144
  ds_read_b64_tr_b16 v[158:159], v23 offset:6656
  v_mul_f32 v228, v47, v228
  v_mul_f32 v229, v47, v229
  v_mul_f32 v230, v47, v230
  v_mul_f32 v231, v47, v231
  v_smfmac_f32_16x16x64_bf16 v[48:51], v[40:43], v[128:135], v44
  s_waitcnt lgkmcnt(8)
  s_nop 0
  v_smfmac_f32_16x16x64_bf16 v[48:51], v[40:43], v[136:143], v44
  v_mfma_f32_32x32x16_bf16 v[160:175], v[136:139], a[4:7], v[160:175]
  ds_read_b64_tr_b16 v[128:129], v20 offset:4096
  ds_read_b64_tr_b16 v[130:131], v20 offset:4608
  v_cvt_pk_bf16_f32 v224, v224, v225
  v_cvt_pk_bf16_f32 v225, v226, v227
  v_cvt_pk_bf16_f32 v226, v228, v229
  v_cvt_pk_bf16_f32 v227, v230, v231
  v_mfma_f32_32x32x16_bf16 v[176:191], v[140:143], a[4:7], v[176:191]
  ds_read_b64_tr_b16 v[132:133], v24 offset:4096
  ds_read_b64_tr_b16 v[134:135], v24 offset:4608
  buffer_store_dwordx4 v[224:227], v1, s[12:15], s78 offen offset:0 sc1
  v_mul_f32 v232, v47, v232
  v_mul_f32_e64 v233, v47, v233
  s_waitcnt lgkmcnt(8)
  v_mfma_f32_32x32x16_bf16 v[160:175], v[144:147], a[8:11], v[160:175]
  ds_read_b64_tr_b16 v[136:137], v20 offset:6144
  ds_read_b64_tr_b16 v[138:139], v20 offset:6656
  v_mul_f32 v234, v47, v234
  v_mul_f32 v235, v47, v235
  v_mul_f32 v236, v47, v236
  v_mul_f32 v237, v47, v237
  v_mfma_f32_32x32x16_bf16 v[176:191], v[148:151], a[8:11], v[176:191]
  ds_read_b64_tr_b16 v[140:141], v24 offset:6144
  ds_read_b64_tr_b16 v[142:143], v24 offset:6656
  v_mul_f32 v238, v47, v238
  v_mul_f32_e64 v239, v47, v239
  v_cvt_pk_bf16_f32 v232, v232, v233
  s_waitcnt lgkmcnt(8)
  v_mfma_f32_32x32x16_bf16 v[160:175], v[152:155], a[12:15], v[160:175]
  ds_read_b64_tr_b16 v[144:145], v21 offset:4096
  ds_read_b64_tr_b16 v[146:147], v21 offset:4608
  v_cvt_pk_bf16_f32 v233, v234, v235
  v_cvt_pk_bf16_f32 v234, v236, v237
  v_cvt_pk_bf16_f32 v235, v238, v239
  v_mfma_f32_32x32x16_bf16 v[176:191], v[156:159], a[12:15], v[176:191]
  s_waitcnt vmcnt(23)
  s_barrier
  ds_read_b64_tr_b16 v[148:149], v25 offset:4096
  ds_read_b64_tr_b16 v[150:151], v25 offset:4608
  buffer_store_dwordx4 v[232:235], v1, s[12:15], s78 offen offset:1024 sc1
  s_waitcnt lgkmcnt(8)
  s_nop 0
  v_mfma_f32_32x32x16_bf16 v[160:175], v[128:131], a[16:19], v[160:175]
  ds_read_b64_tr_b16 v[152:153], v21 offset:6144
  ds_read_b64_tr_b16 v[154:155], v21 offset:6656
  v_mul_f32 v240, v47, v240
  v_mul_f32 v241, v47, v241
  v_mul_f32 v242, v47, v242
  v_mul_f32 v243, v47, v243
  v_mfma_f32_32x32x16_bf16 v[176:191], v[132:135], a[16:19], v[176:191]
  ds_read_b64_tr_b16 v[156:157], v25 offset:6144
  ds_read_b64_tr_b16 v[158:159], v25 offset:6656
  buffer_load_dword v4, v2, s[4:7], 0 offen offset:384
  v_mul_f32 v244, v47, v244
  v_mul_f32_e64 v245, v47, v245
  s_waitcnt lgkmcnt(8)
  v_mfma_f32_32x32x16_bf16 v[160:175], v[136:139], a[20:23], v[160:175]
  ds_read_b64_tr_b16 v[128:129], v18 offset:24576
  ds_read_b64_tr_b16 v[130:131], v18 offset:25088
  v_mul_f32 v246, v47, v246
  v_mul_f32 v247, v47, v247
  v_cvt_pk_bf16_f32 v240, v240, v241
  v_cvt_pk_bf16_f32 v241, v242, v243
  v_mfma_f32_32x32x16_bf16 v[176:191], v[140:143], a[20:23], v[176:191]
  ds_read_b64_tr_b16 v[132:133], v22 offset:24576
  ds_read_b64_tr_b16 v[134:135], v22 offset:25088
  v_cvt_pk_bf16_f32 v242, v244, v245
  v_cvt_pk_bf16_f32 v243, v246, v247
  s_waitcnt lgkmcnt(8)
  s_nop 0
  v_mfma_f32_32x32x16_bf16 v[160:175], v[144:147], a[24:27], v[160:175]
  ds_read_b64_tr_b16 v[136:137], v18 offset:26624
  ds_read_b64_tr_b16 v[138:139], v18 offset:27136
  buffer_store_dwordx4 v[240:243], v1, s[12:15], s78 offen offset:2048 sc1
  v_mul_f32 v248, v47, v248
  v_mul_f32 v249, v47, v249
  v_mul_f32_e64 v250, v47, v250
  v_mfma_f32_32x32x16_bf16 v[176:191], v[148:151], a[24:27], v[176:191]
  ds_read_b64_tr_b16 v[140:141], v22 offset:26624
  ds_read_b64_tr_b16 v[142:143], v22 offset:27136
  v_mul_f32 v251, v47, v251
  v_mul_f32 v252, v47, v252
  v_mul_f32 v253, v47, v253
  s_waitcnt lgkmcnt(8)
  v_mfma_f32_32x32x16_bf16 v[160:175], v[152:155], a[28:31], v[160:175]
  ds_read_b64_tr_b16 v[144:145], v19 offset:24576
  ds_read_b64_tr_b16 v[146:147], v19 offset:25088
  v_mul_f32 v254, v47, v254
  v_mul_f32 v255, v47, v255
  v_cvt_pk_bf16_f32 v248, v248, v249
  v_cvt_pk_bf16_f32 v249, v250, v251
  v_mfma_f32_32x32x16_bf16 v[176:191], v[156:159], a[28:31], v[176:191]
  ds_read_b64_tr_b16 v[148:149], v23 offset:24576
  ds_read_b64_tr_b16 v[150:151], v23 offset:25088
  v_cvt_pk_bf16_f32 v250, v252, v253
  v_cvt_pk_bf16_f32 v251, v254, v255
  s_waitcnt lgkmcnt(8)
  s_nop 0
  v_mfma_f32_32x32x16_bf16 v[160:175], v[128:131], a[32:35], v[160:175]
  ds_read_b64_tr_b16 v[152:153], v19 offset:26624
  ds_read_b64_tr_b16 v[154:155], v19 offset:27136
  buffer_store_dwordx4 v[248:251], v1, s[12:15], s78 offen offset:3072 sc1
  v_mfma_f32_32x32x16_bf16 v[176:191], v[132:135], a[32:35], v[176:191]
  ds_read_b64_tr_b16 v[156:157], v23 offset:26624
  ds_read_b64_tr_b16 v[158:159], v23 offset:27136
  v_smfmac_f32_16x16x64_bf16 v[48:51], v[40:43], v[128:135], v44
  s_waitcnt lgkmcnt(8)
  s_nop 0
  v_smfmac_f32_16x16x64_bf16 v[48:51], v[40:43], v[136:143], v44
  v_mfma_f32_32x32x16_bf16 v[160:175], v[136:139], a[36:39], v[160:175]
  ds_read_b64_tr_b16 v[128:129], v20 offset:24576
  ds_read_b64_tr_b16 v[130:131], v20 offset:25088
  v_mfma_f32_32x32x16_bf16 v[176:191], v[140:143], a[36:39], v[176:191]
  ds_read_b64_tr_b16 v[132:133], v24 offset:24576
  ds_read_b64_tr_b16 v[134:135], v24 offset:25088
  s_waitcnt lgkmcnt(8)
  s_nop 0
  v_mfma_f32_32x32x16_bf16 v[160:175], v[144:147], a[40:43], v[160:175]
  ds_read_b64_tr_b16 v[136:137], v20 offset:26624
  ds_read_b64_tr_b16 v[138:139], v20 offset:27136
  v_mfma_f32_32x32x16_bf16 v[176:191], v[148:151], a[40:43], v[176:191]
  ds_read_b64_tr_b16 v[140:141], v24 offset:26624
  ds_read_b64_tr_b16 v[142:143], v24 offset:27136
  s_waitcnt lgkmcnt(8)
  s_nop 0
  v_mfma_f32_32x32x16_bf16 v[160:175], v[152:155], a[44:47], v[160:175]
  ds_read_b64_tr_b16 v[144:145], v21 offset:24576
  ds_read_b64_tr_b16 v[146:147], v21 offset:25088
  v_mfma_f32_32x32x16_bf16 v[176:191], v[156:159], a[44:47], v[176:191]
  s_waitcnt vmcnt(21)
  s_barrier
  ds_read_b64_tr_b16 v[148:149], v25 offset:24576
  ds_read_b64_tr_b16 v[150:151], v25 offset:25088
  s_waitcnt lgkmcnt(8)
  s_nop 0
  v_mfma_f32_32x32x16_bf16 v[160:175], v[128:131], a[48:51], v[160:175]
  ds_read_b64_tr_b16 v[152:153], v21 offset:26624
  ds_read_b64_tr_b16 v[154:155], v21 offset:27136
  v_mfma_f32_32x32x16_bf16 v[176:191], v[132:135], a[48:51], v[176:191]
  ds_read_b64_tr_b16 v[156:157], v25 offset:26624
  ds_read_b64_tr_b16 v[158:159], v25 offset:27136
  s_waitcnt lgkmcnt(8)
  s_nop 0
  v_mfma_f32_32x32x16_bf16 v[160:175], v[136:139], a[52:55], v[160:175]
  ds_read_b64_tr_b16 v[128:129], v18 offset:28672
  ds_read_b64_tr_b16 v[130:131], v18 offset:29184
  v_mfma_f32_32x32x16_bf16 v[176:191], v[140:143], a[52:55], v[176:191]
  ds_read_b64_tr_b16 v[132:133], v22 offset:28672
  ds_read_b64_tr_b16 v[134:135], v22 offset:29184
  s_waitcnt lgkmcnt(8)
  s_nop 0
  v_mfma_f32_32x32x16_bf16 v[160:175], v[144:147], a[56:59], v[160:175]
  ds_read_b64_tr_b16 v[136:137], v18 offset:30720
  ds_read_b64_tr_b16 v[138:139], v18 offset:31232
  v_mfma_f32_32x32x16_bf16 v[176:191], v[148:151], a[56:59], v[176:191]
  ds_read_b64_tr_b16 v[140:141], v22 offset:30720
  ds_read_b64_tr_b16 v[142:143], v22 offset:31232
  s_waitcnt lgkmcnt(8)
  s_nop 0
  v_mfma_f32_32x32x16_bf16 v[160:175], v[152:155], a[60:63], v[160:175]
  ds_read_b64_tr_b16 v[144:145], v19 offset:28672
  ds_read_b64_tr_b16 v[146:147], v19 offset:29184
  v_mfma_f32_32x32x16_bf16 v[176:191], v[156:159], a[60:63], v[176:191]
  ds_read_b64_tr_b16 v[148:149], v23 offset:28672
  ds_read_b64_tr_b16 v[150:151], v23 offset:29184
  s_waitcnt lgkmcnt(8)
  s_nop 0
  v_mfma_f32_32x32x16_bf16 v[160:175], v[128:131], a[64:67], v[160:175]
  ds_read_b64_tr_b16 v[152:153], v19 offset:30720
  ds_read_b64_tr_b16 v[154:155], v19 offset:31232
  v_mfma_f32_32x32x16_bf16 v[176:191], v[132:135], a[64:67], v[176:191]
  ds_read_b64_tr_b16 v[156:157], v23 offset:30720
  ds_read_b64_tr_b16 v[158:159], v23 offset:31232
  v_smfmac_f32_16x16x64_bf16 v[48:51], v[40:43], v[128:135], v44
  s_waitcnt lgkmcnt(8)
  s_nop 0
  v_smfmac_f32_16x16x64_bf16 v[48:51], v[40:43], v[136:143], v44
  v_mfma_f32_32x32x16_bf16 v[160:175], v[136:139], a[68:71], v[160:175]
  ds_read_b64_tr_b16 v[128:129], v20 offset:28672
  ds_read_b64_tr_b16 v[130:131], v20 offset:29184
  v_mfma_f32_32x32x16_bf16 v[176:191], v[140:143], a[68:71], v[176:191]
  ds_read_b64_tr_b16 v[132:133], v24 offset:28672
  ds_read_b64_tr_b16 v[134:135], v24 offset:29184
  s_waitcnt lgkmcnt(8)
  s_nop 0
  v_mfma_f32_32x32x16_bf16 v[160:175], v[144:147], a[72:75], v[160:175]
  ds_read_b64_tr_b16 v[136:137], v20 offset:30720
  ds_read_b64_tr_b16 v[138:139], v20 offset:31232
  v_mfma_f32_32x32x16_bf16 v[176:191], v[148:151], a[72:75], v[176:191]
  ds_read_b64_tr_b16 v[140:141], v24 offset:30720
  ds_read_b64_tr_b16 v[142:143], v24 offset:31232
  s_waitcnt lgkmcnt(8)
  s_nop 0
  v_mfma_f32_32x32x16_bf16 v[160:175], v[152:155], a[76:79], v[160:175]
  ds_read_b64_tr_b16 v[144:145], v21 offset:28672
  ds_read_b64_tr_b16 v[146:147], v21 offset:29184
  v_mfma_f32_32x32x16_bf16 v[176:191], v[156:159], a[76:79], v[176:191]
  s_waitcnt vmcnt(16)
  s_barrier
  ds_read_b64_tr_b16 v[148:149], v25 offset:28672
  ds_read_b64_tr_b16 v[150:151], v25 offset:29184
  s_waitcnt lgkmcnt(8)
  s_nop 0
  v_mfma_f32_32x32x16_bf16 v[160:175], v[128:131], a[80:83], v[160:175]
  ds_read_b64_tr_b16 v[152:153], v21 offset:30720
  ds_read_b64_tr_b16 v[154:155], v21 offset:31232
  v_mfma_f32_32x32x16_bf16 v[176:191], v[132:135], a[80:83], v[176:191]
  ds_read_b64_tr_b16 v[156:157], v25 offset:30720
  ds_read_b64_tr_b16 v[158:159], v25 offset:31232
  s_waitcnt lgkmcnt(8)
  s_nop 0
  v_mfma_f32_32x32x16_bf16 v[160:175], v[136:139], a[84:87], v[160:175]
  ds_read_b64_tr_b16 v[128:129], v18 offset:8192
  ds_read_b64_tr_b16 v[130:131], v18 offset:8704
  v_mfma_f32_32x32x16_bf16 v[176:191], v[140:143], a[84:87], v[176:191]
  ds_read_b64_tr_b16 v[132:133], v22 offset:8192
  ds_read_b64_tr_b16 v[134:135], v22 offset:8704
  s_waitcnt lgkmcnt(8)
  s_nop 0
  v_mfma_f32_32x32x16_bf16 v[160:175], v[144:147], a[88:91], v[160:175]
  ds_read_b64_tr_b16 v[136:137], v18 offset:10240
  ds_read_b64_tr_b16 v[138:139], v18 offset:10752
  v_mfma_f32_32x32x16_bf16 v[176:191], v[148:151], a[88:91], v[176:191]
  ds_read_b64_tr_b16 v[140:141], v22 offset:10240
  ds_read_b64_tr_b16 v[142:143], v22 offset:10752
  s_waitcnt lgkmcnt(8)
  s_nop 0
  v_mfma_f32_32x32x16_bf16 v[160:175], v[152:155], a[92:95], v[160:175]
  ds_read_b64_tr_b16 v[144:145], v19 offset:8192
  ds_read_b64_tr_b16 v[146:147], v19 offset:8704
  v_mfma_f32_32x32x16_bf16 v[176:191], v[156:159], a[92:95], v[176:191]
  ds_read_b64_tr_b16 v[148:149], v23 offset:8192
  ds_read_b64_tr_b16 v[150:151], v23 offset:8704
  s_waitcnt lgkmcnt(8)
  s_nop 0
  v_mfma_f32_32x32x16_bf16 v[160:175], v[128:131], a[96:99], v[160:175]
  ds_read_b64_tr_b16 v[152:153], v19 offset:10240
  ds_read_b64_tr_b16 v[154:155], v19 offset:10752
  v_mfma_f32_32x32x16_bf16 v[176:191], v[132:135], a[96:99], v[176:191]
  ds_read_b64_tr_b16 v[156:157], v23 offset:10240
  ds_read_b64_tr_b16 v[158:159], v23 offset:10752
  v_smfmac_f32_16x16x64_bf16 v[48:51], v[40:43], v[128:135], v44
  s_waitcnt lgkmcnt(8)
  s_nop 0
  v_smfmac_f32_16x16x64_bf16 v[48:51], v[40:43], v[136:143], v44
  v_mfma_f32_32x32x16_bf16 v[160:175], v[136:139], a[100:103], v[160:175]
  ds_read_b64_tr_b16 v[128:129], v20 offset:8192
  ds_read_b64_tr_b16 v[130:131], v20 offset:8704
  v_mfma_f32_32x32x16_bf16 v[176:191], v[140:143], a[100:103], v[176:191]
  ds_read_b64_tr_b16 v[132:133], v24 offset:8192
  ds_read_b64_tr_b16 v[134:135], v24 offset:8704
  s_waitcnt lgkmcnt(8)
  s_nop 0
  v_mfma_f32_32x32x16_bf16 v[160:175], v[144:147], a[104:107], v[160:175]
  ds_read_b64_tr_b16 v[136:137], v20 offset:10240
  ds_read_b64_tr_b16 v[138:139], v20 offset:10752
  v_mfma_f32_32x32x16_bf16 v[176:191], v[148:151], a[104:107], v[176:191]
  ds_read_b64_tr_b16 v[140:141], v24 offset:10240
  ds_read_b64_tr_b16 v[142:143], v24 offset:10752
  s_waitcnt lgkmcnt(8)
  s_nop 0
  v_mfma_f32_32x32x16_bf16 v[160:175], v[152:155], a[108:111], v[160:175]
  ds_read_b64_tr_b16 v[144:145], v21 offset:8192
  ds_read_b64_tr_b16 v[146:147], v21 offset:8704
  v_mfma_f32_32x32x16_bf16 v[176:191], v[156:159], a[108:111], v[176:191]
  s_waitcnt vmcnt(10)
  s_barrier
  ds_read_b64_tr_b16 v[148:149], v25 offset:8192
  ds_read_b64_tr_b16 v[150:151], v25 offset:8704
  s_waitcnt lgkmcnt(8)
  s_nop 0
  v_mfma_f32_32x32x16_bf16 v[160:175], v[128:131], a[112:115], v[160:175]
  ds_read_b64_tr_b16 v[152:153], v21 offset:10240
  ds_read_b64_tr_b16 v[154:155], v21 offset:10752
  v_mfma_f32_32x32x16_bf16 v[176:191], v[132:135], a[112:115], v[176:191]
  ds_read_b64_tr_b16 v[156:157], v25 offset:10240
  ds_read_b64_tr_b16 v[158:159], v25 offset:10752
  s_waitcnt lgkmcnt(8)
  s_nop 0
  v_mfma_f32_32x32x16_bf16 v[160:175], v[136:139], a[116:119], v[160:175]
  ds_read_b64_tr_b16 v[128:129], v18 offset:12288
  ds_read_b64_tr_b16 v[130:131], v18 offset:12800
  v_mfma_f32_32x32x16_bf16 v[176:191], v[140:143], a[116:119], v[176:191]
  ds_read_b64_tr_b16 v[132:133], v22 offset:12288
  ds_read_b64_tr_b16 v[134:135], v22 offset:12800
  s_waitcnt lgkmcnt(8)
  s_nop 0
  v_mfma_f32_32x32x16_bf16 v[160:175], v[144:147], a[120:123], v[160:175]
  ds_read_b64_tr_b16 v[136:137], v18 offset:14336
  ds_read_b64_tr_b16 v[138:139], v18 offset:14848
  v_mfma_f32_32x32x16_bf16 v[176:191], v[148:151], a[120:123], v[176:191]
  ds_read_b64_tr_b16 v[140:141], v22 offset:14336
  ds_read_b64_tr_b16 v[142:143], v22 offset:14848
  s_waitcnt lgkmcnt(8)
  s_nop 0
  v_mfma_f32_32x32x16_bf16 v[160:175], v[152:155], a[124:127], v[160:175]
  ds_read_b64_tr_b16 v[144:145], v19 offset:12288
  ds_read_b64_tr_b16 v[146:147], v19 offset:12800
  v_mfma_f32_32x32x16_bf16 v[176:191], v[156:159], a[124:127], v[176:191]
  ds_read_b64_tr_b16 v[148:149], v23 offset:12288
  ds_read_b64_tr_b16 v[150:151], v23 offset:12800
  s_waitcnt lgkmcnt(8)
  s_nop 0
  v_mfma_f32_32x32x16_bf16 v[160:175], v[128:131], a[128:131], v[160:175]
  ds_read_b64_tr_b16 v[152:153], v19 offset:14336
  ds_read_b64_tr_b16 v[154:155], v19 offset:14848
  v_mfma_f32_32x32x16_bf16 v[176:191], v[132:135], a[128:131], v[176:191]
  ds_read_b64_tr_b16 v[156:157], v23 offset:14336
  ds_read_b64_tr_b16 v[158:159], v23 offset:14848
  v_smfmac_f32_16x16x64_bf16 v[48:51], v[40:43], v[128:135], v44
  s_waitcnt lgkmcnt(8)
  s_nop 0
  v_smfmac_f32_16x16x64_bf16 v[48:51], v[40:43], v[136:143], v44
  v_mfma_f32_32x32x16_bf16 v[160:175], v[136:139], a[132:135], v[160:175]
  ds_read_b64_tr_b16 v[128:129], v20 offset:12288
  ds_read_b64_tr_b16 v[130:131], v20 offset:12800
  v_mfma_f32_32x32x16_bf16 v[176:191], v[140:143], a[132:135], v[176:191]
  ds_read_b64_tr_b16 v[132:133], v24 offset:12288
  ds_read_b64_tr_b16 v[134:135], v24 offset:12800
  v_add_f32 v78, v48, v49
  s_waitcnt lgkmcnt(8)
  v_mfma_f32_32x32x16_bf16 v[160:175], v[144:147], a[136:139], v[160:175]
  ds_read_b64_tr_b16 v[136:137], v20 offset:14336
  ds_read_b64_tr_b16 v[138:139], v20 offset:14848
  ds_write_b32 v37, v78
  v_mov_b32 v48, 0
  v_mov_b32 v49, 0
  v_mfma_f32_32x32x16_bf16 v[176:191], v[148:151], a[136:139], v[176:191]
  ds_read_b64_tr_b16 v[140:141], v24 offset:14336
  ds_read_b64_tr_b16 v[142:143], v24 offset:14848
  s_waitcnt lgkmcnt(9)
  s_nop 0
  v_mfma_f32_32x32x16_bf16 v[160:175], v[152:155], a[140:143], v[160:175]
  ds_read_b64_tr_b16 v[144:145], v21 offset:12288
  ds_read_b64_tr_b16 v[146:147], v21 offset:12800
  v_mfma_f32_32x32x16_bf16 v[176:191], v[156:159], a[140:143], v[176:191]
  s_waitcnt lgkmcnt(4)
  s_barrier
  ds_read2st64_b32 v[74:75], v38 offset1:160
  ds_read2st64_b32 v[76:77], v39 offset1:160
  ds_read_b64_tr_b16 v[148:149], v25 offset:12288
  ds_read_b64_tr_b16 v[150:151], v25 offset:12800
  v_mfma_f32_32x32x16_bf16 v[160:175], v[128:131], a[144:147], v[160:175]
  ds_read_b64_tr_b16 v[152:153], v21 offset:14336
  ds_read_b64_tr_b16 v[154:155], v21 offset:14848
  v_mfma_f32_32x32x16_bf16 v[176:191], v[132:135], a[144:147], v[176:191]
  ds_read_b64_tr_b16 v[156:157], v25 offset:14336
  ds_read_b64_tr_b16 v[158:159], v25 offset:14848
  s_waitcnt lgkmcnt(10)
  s_nop 0
  v_mfma_f32_32x32x16_bf16 v[160:175], v[136:139], a[148:151], v[160:175]
  v_mfma_f32_32x32x16_bf16 v[176:191], v[140:143], a[148:151], v[176:191]
  s_waitcnt lgkmcnt(4)
  s_nop 0
  v_mfma_f32_32x32x16_bf16 v[160:175], v[144:147], a[152:155], v[160:175]
  v_add_f32 v74, v74, v75
  v_add_f32 v76, v76, v77
  v_add_f32 v74, v74, v76
  v_cvt_pk_bf16_f32 v75, v74, v74
  v_and_b32 v75, 0xffff0000, v75
  v_sub_f32 v75, v74, v75
  v_mfma_f32_32x32x16_bf16 v[176:191], v[148:151], a[152:155], v[176:191]
  v_cvt_pk_bf16_f32 v68, v74, v75
  v_cvt_pk_bf16_f32 v69, v74, v75
  s_waitcnt lgkmcnt(0)
  s_nop 0
  v_mfma_f32_32x32x16_bf16 v[160:175], v[152:155], a[156:159], v[160:175]
  v_mfma_f32_32x32x16_bf16 v[176:191], v[156:159], a[156:159], v[176:191]
  v_mfma_f32_32x32x8_bf16 v[160:175], v[68:69], v[70:71], v[160:175]
  v_mfma_f32_32x32x8_bf16 v[176:191], v[68:69], v[72:73], v[176:191]
  s_nop 3
  v_pk_mul_f32 v[160:161], v[160:161], v[46:47] op_sel:[0,1] op_sel_hi:[1,1]
  v_pk_mul_f32 v[162:163], v[162:163], v[46:47] op_sel:[0,1] op_sel_hi:[1,1]
  v_pk_mul_f32 v[164:165], v[164:165], v[46:47] op_sel:[0,1] op_sel_hi:[1,1]
  v_pk_mul_f32 v[166:167], v[166:167], v[46:47] op_sel:[0,1] op_sel_hi:[1,1]
  v_cvt_pk_bf16_f32 v160, v160, v161
  v_cvt_pk_bf16_f32 v161, v162, v163
  v_cvt_pk_bf16_f32 v162, v164, v165
  v_cvt_pk_bf16_f32 v163, v166, v167
  buffer_store_dwordx4 v[160:163], v1, s[12:15], s79 offen offset:0 sc1
  v_pk_mul_f32 v[168:169], v[168:169], v[46:47] op_sel:[0,1] op_sel_hi:[1,1]
  v_pk_mul_f32 v[170:171], v[170:171], v[46:47] op_sel:[0,1] op_sel_hi:[1,1]
  v_pk_mul_f32 v[172:173], v[172:173], v[46:47] op_sel:[0,1] op_sel_hi:[1,1]
  v_pk_mul_f32 v[174:175], v[174:175], v[46:47] op_sel:[0,1] op_sel_hi:[1,1]
  v_cvt_pk_bf16_f32 v168, v168, v169
  v_cvt_pk_bf16_f32 v169, v170, v171
  v_cvt_pk_bf16_f32 v170, v172, v173
  v_cvt_pk_bf16_f32 v171, v174, v175
  buffer_store_dwordx4 v[168:171], v1, s[12:15], s79 offen offset:1024 sc1
  v_pk_mul_f32 v[176:177], v[176:177], v[46:47] op_sel:[0,1] op_sel_hi:[1,1]
  v_pk_mul_f32 v[178:179], v[178:179], v[46:47] op_sel:[0,1] op_sel_hi:[1,1]
  v_pk_mul_f32 v[180:181], v[180:181], v[46:47] op_sel:[0,1] op_sel_hi:[1,1]
  v_pk_mul_f32 v[182:183], v[182:183], v[46:47] op_sel:[0,1] op_sel_hi:[1,1]
  v_cvt_pk_bf16_f32 v176, v176, v177
  v_cvt_pk_bf16_f32 v177, v178, v179
  v_cvt_pk_bf16_f32 v178, v180, v181
  v_cvt_pk_bf16_f32 v179, v182, v183
  buffer_store_dwordx4 v[176:179], v1, s[12:15], s79 offen offset:2048 sc1
  v_pk_mul_f32 v[184:185], v[184:185], v[46:47] op_sel:[0,1] op_sel_hi:[1,1]
  v_pk_mul_f32 v[186:187], v[186:187], v[46:47] op_sel:[0,1] op_sel_hi:[1,1]
  v_pk_mul_f32 v[188:189], v[188:189], v[46:47] op_sel:[0,1] op_sel_hi:[1,1]
  v_pk_mul_f32 v[190:191], v[190:191], v[46:47] op_sel:[0,1] op_sel_hi:[1,1]
  v_cvt_pk_bf16_f32 v184, v184, v185
  v_cvt_pk_bf16_f32 v185, v186, v187
  v_cvt_pk_bf16_f32 v186, v188, v189
  v_cvt_pk_bf16_f32 v187, v190, v191
  buffer_store_dwordx4 v[184:187], v1, s[12:15], s79 offen offset:3072 sc1
  v_mov_b32 v4, 0
  s_lshl_b32 s32, s2, 2
  s_add_u32 s32, s32, 26812416
  s_mov_b64 exec, 1
  buffer_store_dword v4, off, s[12:15], s32
  s_endpgm
.p2align 5
K1_AQ:
  s_waitcnt lgkmcnt(8)
  s_nop 0
  v_mfma_f32_32x32x16_bf16 v[192:207], v[128:131], a[0:3], 0
  ds_read_b64_tr_b16 v[152:153], v19 offset:18432
  ds_read_b64_tr_b16 v[154:155], v19 offset:18944
  buffer_load_dwordx4 v17, s[16:19], s67 offen offset:3072 lds
  v_add_f32 v56, 0x3727c5ac, v56
  v_rsq_f32_e64 v46, v56
  v_mfma_f32_32x32x16_bf16 v[208:223], v[132:135], a[0:3], 0
  ds_read_b64_tr_b16 v[156:157], v23 offset:18432
  ds_read_b64_tr_b16 v[158:159], v23 offset:18944
  v_mul_f32 v47, s82, v46
  v_mul_f32 v82, v56, v46
  v_mul_f32 v81, 0xc0135761, v46
  v_mul_f32_e64 v80, v46, v46
  v_smfmac_f32_16x16x64_bf16 v[48:51], v[40:43], v[128:135], v44
  s_waitcnt lgkmcnt(8)
  s_nop 0
  v_smfmac_f32_16x16x64_bf16 v[48:51], v[40:43], v[136:143], v44
  v_mfma_f32_32x32x16_bf16 v[192:207], v[136:139], a[4:7], v[192:207]
  ds_read_b64_tr_b16 v[128:129], v20 offset:16384
  ds_read_b64_tr_b16 v[130:131], v20 offset:16896
  s_mov_b32 m0, s45
  v_mul_f32 v80, v80, v81
  v_mul_f32 v80, 0x3d372713, v80
  v_mul_f32_e64 v160, v46, v160
  v_mfma_f32_32x32x16_bf16 v[208:223], v[140:143], a[4:7], v[208:223]
  ds_read_b64_tr_b16 v[132:133], v24 offset:16384
  ds_read_b64_tr_b16 v[134:135], v24 offset:16896
  v_mul_f32 v161, v46, v161
  v_mul_f32 v162, v46, v162
  v_mul_f32 v163, v46, v163
  s_waitcnt lgkmcnt(8)
  v_mfma_f32_32x32x16_bf16 v[192:207], v[144:147], a[8:11], v[192:207]
  ds_read_b64_tr_b16 v[136:137], v20 offset:18432
  ds_read_b64_tr_b16 v[138:139], v20 offset:18944
  buffer_load_dwordx4 v34, s[20:23], s80 offen lds
  v_mul_f32 v164, v46, v164
  v_mul_f32 v165, v46, v165
  v_mul_f32_e64 v166, v46, v166
  v_mfma_f32_32x32x16_bf16 v[208:223], v[148:151], a[8:11], v[208:223]
  ds_read_b64_tr_b16 v[140:141], v24 offset:18432
  ds_read_b64_tr_b16 v[142:143], v24 offset:18944
  v_mul_f32 v167, v46, v167
  v_cvt_pk_bf16_f32 v160, v160, v161
  v_cvt_pk_bf16_f32 v161, v162, v163
  s_waitcnt lgkmcnt(8)
  v_mfma_f32_32x32x16_bf16 v[192:207], v[152:155], a[12:15], v[192:207]
  ds_read_b64_tr_b16 v[144:145], v21 offset:16384
  ds_read_b64_tr_b16 v[146:147], v21 offset:16896
  buffer_load_dwordx4 v35, s[20:23], s80 offen offset:1024 lds
  v_cvt_pk_bf16_f32 v162, v164, v165
  v_cvt_pk_bf16_f32 v163, v166, v167
  v_mfma_f32_32x32x16_bf16 v[208:223], v[156:159], a[12:15], v[208:223]
  s_waitcnt vmcnt(22)
  s_barrier
  ds_read_b64_tr_b16 v[148:149], v25 offset:16384
  ds_read_b64_tr_b16 v[150:151], v25 offset:16896
  buffer_store_dwordx4 v[160:163], v1, s[12:15], s76 offen offset:0 sc1
  s_waitcnt lgkmcnt(8)
  s_nop 0
  v_mfma_f32_32x32x16_bf16 v[192:207], v[128:131], a[16:19], v[192:207]
  ds_read_b64_tr_b16 v[152:153], v21 offset:18432
  ds_read_b64_tr_b16 v[154:155], v21 offset:18944
  s_mov_b32 m0, s36
  v_mul_f32 v168, v46, v168
  v_mul_f32 v169, v46, v169
  v_mul_f32 v170, v46, v170
  v_mfma_f32_32x32x16_bf16 v[208:223], v[132:135], a[16:19], v[208:223]
  ds_read_b64_tr_b16 v[156:157], v25 offset:18432
  ds_read_b64_tr_b16 v[158:159], v25 offset:18944
  v_mul_f32 v171, v46, v171
  v_mul_f32 v172, v46, v172
  v_mul_f32 v173, v46, v173
  s_waitcnt lgkmcnt(8)
  v_mfma_f32_32x32x16_bf16 v[192:207], v[136:139], a[20:23], v[192:207]
  ds_read_b64_tr_b16 v[128:129], v18 offset:20480
  ds_read_b64_tr_b16 v[130:131], v18 offset:20992
  buffer_load_dwordx4 v14, s[16:19], s68 offen offset:0 lds
  v_mul_f32 v174, v46, v174
  v_mul_f32 v175, v46, v175
  v_cvt_pk_bf16_f32 v168, v168, v169
  v_mfma_f32_32x32x16_bf16 v[208:223], v[140:143], a[20:23], v[208:223]
  ds_read_b64_tr_b16 v[132:133], v22 offset:20480
  ds_read_b64_tr_b16 v[134:135], v22 offset:20992
  v_cvt_pk_bf16_f32 v169, v170, v171
  v_cvt_pk_bf16_f32 v170, v172, v173
  v_cvt_pk_bf16_f32 v171, v174, v175
  s_waitcnt lgkmcnt(8)
  s_nop 0
  v_mfma_f32_32x32x16_bf16 v[192:207], v[144:147], a[24:27], v[192:207]
  ds_read_b64_tr_b16 v[136:137], v18 offset:22528
  ds_read_b64_tr_b16 v[138:139], v18 offset:23040
  buffer_load_dwordx4 v15, s[16:19], s68 offen offset:1024 lds
  buffer_store_dwordx4 v[168:171], v1, s[12:15], s76 offen offset:1024 sc1
  v_mul_f32 v176, v46, v176
  v_mul_f32 v177, v46, v177
  v_mfma_f32_32x32x16_bf16 v[208:223], v[148:151], a[24:27], v[208:223]
  ds_read_b64_tr_b16 v[140:141], v22 offset:22528
  ds_read_b64_tr_b16 v[142:143], v22 offset:23040
  v_mul_f32 v178, v46, v178
  v_mul_f32 v179, v46, v179
  v_mul_f32 v180, v46, v180
  s_waitcnt lgkmcnt(8)
  v_mfma_f32_32x32x16_bf16 v[192:207], v[152:155], a[28:31], v[192:207]
  ds_read_b64_tr_b16 v[144:145], v19 offset:20480
  ds_read_b64_tr_b16 v[146:147], v19 offset:20992
  buffer_load_dwordx4 v16, s[16:19], s68 offen offset:2048 lds
  v_mul_f32 v181, v46, v181
  v_mul_f32 v182, v46, v182
  v_mul_f32_e64 v183, v46, v183
  v_mfma_f32_32x32x16_bf16 v[208:223], v[156:159], a[28:31], v[208:223]
  ds_read_b64_tr_b16 v[148:149], v23 offset:20480
  ds_read_b64_tr_b16 v[150:151], v23 offset:20992
  v_cvt_pk_bf16_f32 v176, v176, v177
  v_cvt_pk_bf16_f32 v177, v178, v179
  v_cvt_pk_bf16_f32 v178, v180, v181
  s_waitcnt lgkmcnt(8)
  s_nop 0
  v_mfma_f32_32x32x16_bf16 v[192:207], v[128:131], a[32:35], v[192:207]
  ds_read_b64_tr_b16 v[152:153], v19 offset:22528
  ds_read_b64_tr_b16 v[154:155], v19 offset:23040
  buffer_load_dwordx4 v17, s[16:19], s68 offen offset:3072 lds
  v_cvt_pk_bf16_f32 v179, v182, v183
  v_mfma_f32_32x32x16_bf16 v[208:223], v[132:135], a[32:35], v[208:223]
  ds_read_b64_tr_b16 v[156:157], v23 offset:22528
  ds_read_b64_tr_b16 v[158:159], v23 offset:23040
  buffer_store_dwordx4 v[176:179], v1, s[12:15], s76 offen offset:2048 sc1
  v_mul_f32 v184, v46, v184
  v_mul_f32 v185, v46, v185
  v_mul_f32_e64 v186, v46, v186
  v_smfmac_f32_16x16x64_bf16 v[48:51], v[40:43], v[128:135], v44
  s_waitcnt lgkmcnt(8)
  s_nop 0
  v_smfmac_f32_16x16x64_bf16 v[48:51], v[40:43], v[136:143], v44
  v_mfma_f32_32x32x16_bf16 v[192:207], v[136:139], a[36:39], v[192:207]
  ds_read_b64_tr_b16 v[128:129], v20 offset:20480
  ds_read_b64_tr_b16 v[130:131], v20 offset:20992
  v_mul_f32 v187, v46, v187
  v_mul_f32 v188, v46, v188
  v_mul_f32 v189, v46, v189
  v_mul_f32 v190, v46, v190
  v_mfma_f32_32x32x16_bf16 v[208:223], v[140:143], a[36:39], v[208:223]
  ds_read_b64_tr_b16 v[132:133], v24 offset:20480
  ds_read_b64_tr_b16 v[134:135], v24 offset:20992
  v_mul_f32 v191, v46, v191
  v_cvt_pk_bf16_f32 v184, v184, v185
  v_cvt_pk_bf16_f32 v185, v186, v187
  s_waitcnt lgkmcnt(8)
  v_mfma_f32_32x32x16_bf16 v[192:207], v[144:147], a[40:43], v[192:207]
  ds_read_b64_tr_b16 v[136:137], v20 offset:22528
  ds_read_b64_tr_b16 v[138:139], v20 offset:23040
  v_cvt_pk_bf16_f32 v186, v188, v189
  v_cvt_pk_bf16_f32 v187, v190, v191
  v_mfma_f32_32x32x16_bf16 v[208:223], v[148:151], a[40:43], v[208:223]
  ds_read_b64_tr_b16 v[140:141], v24 offset:22528
  ds_read_b64_tr_b16 v[142:143], v24 offset:23040
  buffer_store_dwordx4 v[184:187], v1, s[12:15], s76 offen offset:3072 sc1
  s_waitcnt lgkmcnt(8)
  s_nop 0
  v_mfma_f32_32x32x16_bf16 v[192:207], v[152:155], a[44:47], v[192:207]
  ds_read_b64_tr_b16 v[144:145], v21 offset:20480
  ds_read_b64_tr_b16 v[146:147], v21 offset:20992
  v_mfma_f32_32x32x16_bf16 v[208:223], v[156:159], a[44:47], v[208:223]
  s_waitcnt vmcnt(26)
  s_barrier
  ds_read_b64_tr_b16 v[148:149], v25 offset:20480
  ds_read_b64_tr_b16 v[150:151], v25 offset:20992
  s_mov_b32 m0, s40
  s_waitcnt lgkmcnt(8)
  v_mfma_f32_32x32x16_bf16 v[192:207], v[128:131], a[48:51], v[192:207]
  ds_read_b64_tr_b16 v[152:153], v21 offset:22528
  ds_read_b64_tr_b16 v[154:155], v21 offset:23040
  v_mfma_f32_32x32x16_bf16 v[208:223], v[132:135], a[48:51], v[208:223]
  ds_read_b64_tr_b16 v[156:157], v25 offset:22528
  ds_read_b64_tr_b16 v[158:159], v25 offset:23040
  buffer_load_dwordx4 v14, s[16:19], s69 offen offset:0 lds
  s_waitcnt lgkmcnt(8)
  s_nop 0
  v_mfma_f32_32x32x16_bf16 v[192:207], v[136:139], a[52:55], v[192:207]
  ds_read_b64_tr_b16 v[128:129], v18 offset:4096
  ds_read_b64_tr_b16 v[130:131], v18 offset:4608
  v_mfma_f32_32x32x16_bf16 v[208:223], v[140:143], a[52:55], v[208:223]
  ds_read_b64_tr_b16 v[132:133], v22 offset:4096
  ds_read_b64_tr_b16 v[134:135], v22 offset:4608
  s_waitcnt lgkmcnt(8)
  s_nop 0
  v_mfma_f32_32x32x16_bf16 v[192:207], v[144:147], a[56:59], v[192:207]
  ds_read_b64_tr_b16 v[136:137], v18 offset:6144
  ds_read_b64_tr_b16 v[138:139], v18 offset:6656
  buffer_load_dwordx4 v15, s[16:19], s69 offen offset:1024 lds
  v_mfma_f32_32x32x16_bf16 v[208:223], v[148:151], a[56:59], v[208:223]
  ds_read_b64_tr_b16 v[140:141], v22 offset:6144
  ds_read_b64_tr_b16 v[142:143], v22 offset:6656
  s_waitcnt lgkmcnt(8)
  s_nop 0
  v_mfma_f32_32x32x16_bf16 v[192:207], v[152:155], a[60:63], v[192:207]
  ds_read_b64_tr_b16 v[144:145], v19 offset:4096
  ds_read_b64_tr_b16 v[146:147], v19 offset:4608
  v_mfma_f32_32x32x16_bf16 v[208:223], v[156:159], a[60:63], v[208:223]
  ds_read_b64_tr_b16 v[148:149], v23 offset:4096
  ds_read_b64_tr_b16 v[150:151], v23 offset:4608
  buffer_load_dwordx4 v16, s[16:19], s69 offen offset:2048 lds
  s_waitcnt lgkmcnt(8)
  s_nop 0
  v_mfma_f32_32x32x16_bf16 v[192:207], v[128:131], a[64:67], v[192:207]
  ds_read_b64_tr_b16 v[152:153], v19 offset:6144
  ds_read_b64_tr_b16 v[154:155], v19 offset:6656
  buffer_load_dwordx4 v17, s[16:19], s69 offen offset:3072 lds
  s_mov_b32 s4, s100
  s_nop 0
  v_mfma_f32_32x32x16_bf16 v[208:223], v[132:135], a[64:67], v[208:223]
  ds_read_b64_tr_b16 v[156:157], v23 offset:6144
  ds_read_b64_tr_b16 v[158:159], v23 offset:6656
  s_mov_b32 s5, s101
  s_nop 0
  v_smfmac_f32_16x16x64_bf16 v[48:51], v[40:43], v[128:135], v44
  s_waitcnt lgkmcnt(8)
  s_nop 0
  v_smfmac_f32_16x16x64_bf16 v[48:51], v[40:43], v[136:143], v44
  v_mfma_f32_32x32x16_bf16 v[192:207], v[136:139], a[68:71], v[192:207]
  ds_read_b64_tr_b16 v[128:129], v20 offset:4096
  ds_read_b64_tr_b16 v[130:131], v20 offset:4608
  s_mov_b32 s6, 8192
  v_mfma_f32_32x32x16_bf16 v[208:223], v[140:143], a[68:71], v[208:223]
  ds_read_b64_tr_b16 v[132:133], v24 offset:4096
  ds_read_b64_tr_b16 v[134:135], v24 offset:4608
  v_lshrrev_b32 v2, 3, v0
  v_lshlrev_b32_e64 v2, 10, v2
  buffer_load_dword v4, v2, s[4:7], 0 offen offset:0
  s_waitcnt lgkmcnt(8)
  v_mfma_f32_32x32x16_bf16 v[192:207], v[144:147], a[72:75], v[192:207]
  ds_read_b64_tr_b16 v[136:137], v20 offset:6144
  ds_read_b64_tr_b16 v[138:139], v20 offset:6656
  v_mfma_f32_32x32x16_bf16 v[208:223], v[148:151], a[72:75], v[208:223]
  ds_read_b64_tr_b16 v[140:141], v24 offset:6144
  ds_read_b64_tr_b16 v[142:143], v24 offset:6656
  s_waitcnt lgkmcnt(8)
  s_nop 0
  v_mfma_f32_32x32x16_bf16 v[192:207], v[152:155], a[76:79], v[192:207]
  ds_read_b64_tr_b16 v[144:145], v21 offset:4096
  ds_read_b64_tr_b16 v[146:147], v21 offset:4608
  v_mfma_f32_32x32x16_bf16 v[208:223], v[156:159], a[76:79], v[208:223]
  s_waitcnt vmcnt(27)
  s_barrier
  ds_read_b64_tr_b16 v[148:149], v25 offset:4096
  ds_read_b64_tr_b16 v[150:151], v25 offset:4608
  s_mov_b32 m0, s41
  s_waitcnt lgkmcnt(8)
  v_mfma_f32_32x32x16_bf16 v[192:207], v[128:131], a[80:83], v[192:207]
  ds_read_b64_tr_b16 v[152:153], v21 offset:6144
  ds_read_b64_tr_b16 v[154:155], v21 offset:6656
  v_mfma_f32_32x32x16_bf16 v[208:223], v[132:135], a[80:83], v[208:223]
  ds_read_b64_tr_b16 v[156:157], v25 offset:6144
  ds_read_b64_tr_b16 v[158:159], v25 offset:6656
  buffer_load_dwordx4 v14, s[16:19], s70 offen offset:0 lds
  s_waitcnt lgkmcnt(8)
  s_nop 0
  v_mfma_f32_32x32x16_bf16 v[192:207], v[136:139], a[84:87], v[192:207]
  ds_read_b64_tr_b16 v[128:129], v18 offset:24576
  ds_read_b64_tr_b16 v[130:131], v18 offset:25088
  v_mfma_f32_32x32x16_bf16 v[208:223], v[140:143], a[84:87], v[208:223]
  ds_read_b64_tr_b16 v[132:133], v22 offset:24576
  ds_read_b64_tr_b16 v[134:135], v22 offset:25088
  s_waitcnt lgkmcnt(8)
  s_nop 0
  v_mfma_f32_32x32x16_bf16 v[192:207], v[144:147], a[88:91], v[192:207]
  ds_read_b64_tr_b16 v[136:137], v18 offset:26624
  ds_read_b64_tr_b16 v[138:139], v18 offset:27136
  buffer_load_dwordx4 v15, s[16:19], s70 offen offset:1024 lds
  v_mfma_f32_32x32x16_bf16 v[208:223], v[148:151], a[88:91], v[208:223]
  ds_read_b64_tr_b16 v[140:141], v22 offset:26624
  ds_read_b64_tr_b16 v[142:143], v22 offset:27136
  s_waitcnt lgkmcnt(8)
  s_nop 0
  v_mfma_f32_32x32x16_bf16 v[192:207], v[152:155], a[92:95], v[192:207]
  ds_read_b64_tr_b16 v[144:145], v19 offset:24576
  ds_read_b64_tr_b16 v[146:147], v19 offset:25088
  v_mfma_f32_32x32x16_bf16 v[208:223], v[156:159], a[92:95], v[208:223]
  ds_read_b64_tr_b16 v[148:149], v23 offset:24576
  ds_read_b64_tr_b16 v[150:151], v23 offset:25088
  buffer_load_dwordx4 v16, s[16:19], s70 offen offset:2048 lds
  s_waitcnt lgkmcnt(8)
  s_nop 0
  v_mfma_f32_32x32x16_bf16 v[192:207], v[128:131], a[96:99], v[192:207]
  ds_read_b64_tr_b16 v[152:153], v19 offset:26624
  ds_read_b64_tr_b16 v[154:155], v19 offset:27136
  buffer_load_dwordx4 v17, s[16:19], s70 offen offset:3072 lds
  v_mfma_f32_32x32x16_bf16 v[208:223], v[132:135], a[96:99], v[208:223]
  ds_read_b64_tr_b16 v[156:157], v23 offset:26624
  ds_read_b64_tr_b16 v[158:159], v23 offset:27136
  v_smfmac_f32_16x16x64_bf16 v[48:51], v[40:43], v[128:135], v44
  s_waitcnt lgkmcnt(8)
  s_nop 0
  v_smfmac_f32_16x16x64_bf16 v[48:51], v[40:43], v[136:143], v44
  v_mfma_f32_32x32x16_bf16 v[192:207], v[136:139], a[100:103], v[192:207]
  ds_read_b64_tr_b16 v[128:129], v20 offset:24576
  ds_read_b64_tr_b16 v[130:131], v20 offset:25088
  v_mfma_f32_32x32x16_bf16 v[208:223], v[140:143], a[100:103], v[208:223]
  ds_read_b64_tr_b16 v[132:133], v24 offset:24576
  ds_read_b64_tr_b16 v[134:135], v24 offset:25088
  s_waitcnt lgkmcnt(8)
  s_nop 0
  v_mfma_f32_32x32x16_bf16 v[192:207], v[144:147], a[104:107], v[192:207]
  ds_read_b64_tr_b16 v[136:137], v20 offset:26624
  ds_read_b64_tr_b16 v[138:139], v20 offset:27136
  v_mfma_f32_32x32x16_bf16 v[208:223], v[148:151], a[104:107], v[208:223]
  ds_read_b64_tr_b16 v[140:141], v24 offset:26624
  ds_read_b64_tr_b16 v[142:143], v24 offset:27136
  s_waitcnt lgkmcnt(8)
  s_nop 0
  v_mfma_f32_32x32x16_bf16 v[192:207], v[152:155], a[108:111], v[192:207]
  ds_read_b64_tr_b16 v[144:145], v21 offset:24576
  ds_read_b64_tr_b16 v[146:147], v21 offset:25088
  v_mfma_f32_32x32x16_bf16 v[208:223], v[156:159], a[108:111], v[208:223]
  s_waitcnt vmcnt(27)
  s_barrier
  ds_read_b64_tr_b16 v[148:149], v25 offset:24576
  ds_read_b64_tr_b16 v[150:151], v25 offset:25088
  s_mov_b32 m0, s37
  s_waitcnt lgkmcnt(8)
  v_mfma_f32_32x32x16_bf16 v[192:207], v[128:131], a[112:115], v[192:207]
  ds_read_b64_tr_b16 v[152:153], v21 offset:26624
  ds_read_b64_tr_b16 v[154:155], v21 offset:27136
  v_mfma_f32_32x32x16_bf16 v[208:223], v[132:135], a[112:115], v[208:223]
  ds_read_b64_tr_b16 v[156:157], v25 offset:26624
  ds_read_b64_tr_b16 v[158:159], v25 offset:27136
  buffer_load_dwordx4 v14, s[16:19], s71 offen offset:0 lds
  s_waitcnt lgkmcnt(8)
  s_nop 0
  v_mfma_f32_32x32x16_bf16 v[192:207], v[136:139], a[116:119], v[192:207]
  ds_read_b64_tr_b16 v[128:129], v18 offset:28672
  ds_read_b64_tr_b16 v[130:131], v18 offset:29184
  v_mfma_f32_32x32x16_bf16 v[208:223], v[140:143], a[116:119], v[208:223]
  ds_read_b64_tr_b16 v[132:133], v22 offset:28672
  ds_read_b64_tr_b16 v[134:135], v22 offset:29184
  s_waitcnt lgkmcnt(8)
  s_nop 0
  v_mfma_f32_32x32x16_bf16 v[192:207], v[144:147], a[120:123], v[192:207]
  ds_read_b64_tr_b16 v[136:137], v18 offset:30720
  ds_read_b64_tr_b16 v[138:139], v18 offset:31232
  buffer_load_dwordx4 v15, s[16:19], s71 offen offset:1024 lds
  v_mfma_f32_32x32x16_bf16 v[208:223], v[148:151], a[120:123], v[208:223]
  ds_read_b64_tr_b16 v[140:141], v22 offset:30720
  ds_read_b64_tr_b16 v[142:143], v22 offset:31232
  s_waitcnt lgkmcnt(8)
  s_nop 0
  v_mfma_f32_32x32x16_bf16 v[192:207], v[152:155], a[124:127], v[192:207]
  ds_read_b64_tr_b16 v[144:145], v19 offset:28672
  ds_read_b64_tr_b16 v[146:147], v19 offset:29184
  v_mfma_f32_32x32x16_bf16 v[208:223], v[156:159], a[124:127], v[208:223]
  ds_read_b64_tr_b16 v[148:149], v23 offset:28672
  ds_read_b64_tr_b16 v[150:151], v23 offset:29184
  buffer_load_dwordx4 v16, s[16:19], s71 offen offset:2048 lds
  s_waitcnt lgkmcnt(8)
  s_nop 0
  v_mfma_f32_32x32x16_bf16 v[192:207], v[128:131], a[128:131], v[192:207]
  ds_read_b64_tr_b16 v[152:153], v19 offset:30720
  ds_read_b64_tr_b16 v[154:155], v19 offset:31232
  buffer_load_dwordx4 v17, s[16:19], s71 offen offset:3072 lds
  v_mfma_f32_32x32x16_bf16 v[208:223], v[132:135], a[128:131], v[208:223]
  ds_read_b64_tr_b16 v[156:157], v23 offset:30720
  ds_read_b64_tr_b16 v[158:159], v23 offset:31232
  v_smfmac_f32_16x16x64_bf16 v[48:51], v[40:43], v[128:135], v44
  s_waitcnt lgkmcnt(8)
  s_nop 0
  v_smfmac_f32_16x16x64_bf16 v[48:51], v[40:43], v[136:143], v44
  v_mfma_f32_32x32x16_bf16 v[192:207], v[136:139], a[132:135], v[192:207]
  ds_read_b64_tr_b16 v[128:129], v20 offset:28672
  ds_read_b64_tr_b16 v[130:131], v20 offset:29184
  v_mfma_f32_32x32x16_bf16 v[208:223], v[140:143], a[132:135], v[208:223]
  ds_read_b64_tr_b16 v[132:133], v24 offset:28672
  ds_read_b64_tr_b16 v[134:135], v24 offset:29184
  v_add_f32 v78, v48, v49
  s_waitcnt lgkmcnt(8)
  v_mfma_f32_32x32x16_bf16 v[192:207], v[144:147], a[136:139], v[192:207]
  ds_read_b64_tr_b16 v[136:137], v20 offset:30720
  ds_read_b64_tr_b16 v[138:139], v20 offset:31232
  ds_write_b32 v37, v78
  v_mov_b32 v48, 0
  v_mov_b32 v49, 0
  v_mfma_f32_32x32x16_bf16 v[208:223], v[148:151], a[136:139], v[208:223]
  ds_read_b64_tr_b16 v[140:141], v24 offset:30720
  ds_read_b64_tr_b16 v[142:143], v24 offset:31232
  s_waitcnt lgkmcnt(9)
  s_nop 0
  v_mfma_f32_32x32x16_bf16 v[192:207], v[152:155], a[140:143], v[192:207]
  ds_read_b64_tr_b16 v[144:145], v21 offset:28672
  ds_read_b64_tr_b16 v[146:147], v21 offset:29184
  v_mfma_f32_32x32x16_bf16 v[208:223], v[156:159], a[140:143], v[208:223]
  s_waitcnt vmcnt(27) lgkmcnt(4)
  s_barrier
  ds_read2st64_b32 v[74:75], v38 offset1:160
  ds_read2st64_b32 v[76:77], v39 offset1:160
  ds_read_b64_tr_b16 v[148:149], v25 offset:28672
  ds_read_b64_tr_b16 v[150:151], v25 offset:29184
  v_mfma_f32_32x32x16_bf16 v[192:207], v[128:131], a[144:147], v[192:207]
  ds_read_b64_tr_b16 v[152:153], v21 offset:30720
  ds_read_b64_tr_b16 v[154:155], v21 offset:31232
  s_mov_b32 m0, s42
  s_nop 0
  v_mfma_f32_32x32x16_bf16 v[208:223], v[132:135], a[144:147], v[208:223]
  ds_read_b64_tr_b16 v[156:157], v25 offset:30720
  ds_read_b64_tr_b16 v[158:159], v25 offset:31232
  buffer_load_dwordx4 v14, s[16:19], s72 offen offset:0 lds
  s_waitcnt lgkmcnt(10)
  s_nop 0
  v_mfma_f32_32x32x16_bf16 v[192:207], v[136:139], a[148:151], v[192:207]
  ds_read_b64_tr_b16 v[128:129], v18 offset:8192
  ds_read_b64_tr_b16 v[130:131], v18 offset:8704
  v_mfma_f32_32x32x16_bf16 v[208:223], v[140:143], a[148:151], v[208:223]
  ds_read_b64_tr_b16 v[132:133], v22 offset:8192
  ds_read_b64_tr_b16 v[134:135], v22 offset:8704
  s_waitcnt lgkmcnt(8)
  s_nop 0
  v_mfma_f32_32x32x16_bf16 v[192:207], v[144:147], a[152:155], v[192:207]
  ds_read_b64_tr_b16 v[136:137], v18 offset:10240
  ds_read_b64_tr_b16 v[138:139], v18 offset:10752
  buffer_load_dwordx4 v15, s[16:19], s72 offen offset:1024 lds
  v_add_f32 v74, v74, v75
  v_add_f32 v76, v76, v77
  v_add_f32_e64 v74, v74, v76
  v_mfma_f32_32x32x16_bf16 v[208:223], v[148:151], a[152:155], v[208:223]
  ds_read_b64_tr_b16 v[140:141], v22 offset:10240
  ds_read_b64_tr_b16 v[142:143], v22 offset:10752
  v_cvt_pk_bf16_f32 v75, v74, v74
  v_and_b32 v75, 0xffff0000, v75
  v_sub_f32 v75, v74, v75
  s_waitcnt lgkmcnt(8)
  v_mfma_f32_32x32x16_bf16 v[192:207], v[152:155], a[156:159], v[192:207]
  ds_read_b64_tr_b16 v[144:145], v19 offset:8192
  ds_read_b64_tr_b16 v[146:147], v19 offset:8704
  v_cvt_pk_bf16_f32 v68, v74, v75
  v_cvt_pk_bf16_f32 v69, v74, v75
  v_mfma_f32_32x32x16_bf16 v[208:223], v[156:159], a[156:159], v[208:223]
  ds_read_b64_tr_b16 v[148:149], v23 offset:8192
  ds_read_b64_tr_b16 v[150:151], v23 offset:8704
  buffer_load_dwordx4 v16, s[16:19], s72 offen offset:2048 lds
  v_mfma_f32_32x32x8_bf16 v[192:207], v[68:69], v[70:71], v[192:207]
  buffer_load_dwordx4 v17, s[16:19], s72 offen offset:3072 lds
  v_mfma_f32_32x32x8_bf16 v[208:223], v[68:69], v[72:73], v[208:223]
  buffer_load_dword v4, v2, s[4:7], 0 offen offset:128
  s_waitcnt lgkmcnt(8)
  s_nop 0
  v_mfma_f32_32x32x16_bf16 v[224:239], v[128:131], a[0:3], 0
  ds_read_b64_tr_b16 v[152:153], v19 offset:10240
  ds_read_b64_tr_b16 v[154:155], v19 offset:10752
  v_mul_f32 v192, v46, v192
  v_mul_f32 v193, v46, v193
  v_mul_f32 v194, v46, v194
  v_mul_f32 v195, v46, v195
  v_mfma_f32_32x32x16_bf16 v[240:255], v[132:135], a[0:3], 0
  ds_read_b64_tr_b16 v[156:157], v23 offset:10240
  ds_read_b64_tr_b16 v[158:159], v23 offset:10752
  v_mul_f32 v196, v46, v196
  v_mul_f32 v197, v46, v197
  v_mul_f32 v198, v46, v198
  v_mul_f32 v199, v46, v199
  v_smfmac_f32_16x16x64_bf16 v[48:51], v[40:43], v[128:135], v44
  s_waitcnt lgkmcnt(8)
  s_nop 0
  v_smfmac_f32_16x16x64_bf16 v[48:51], v[40:43], v[136:143], v44
  v_mfma_f32_32x32x16_bf16 v[224:239], v[136:139], a[4:7], v[224:239]
  ds_read_b64_tr_b16 v[128:129], v20 offset:8192
  ds_read_b64_tr_b16 v[130:131], v20 offset:8704
  v_cvt_pk_bf16_f32 v192, v192, v193
  v_cvt_pk_bf16_f32 v193, v194, v195
  v_cvt_pk_bf16_f32 v194, v196, v197
  v_cvt_pk_bf16_f32 v195, v198, v199
  v_mfma_f32_32x32x16_bf16 v[240:255], v[140:143], a[4:7], v[240:255]
  ds_read_b64_tr_b16 v[132:133], v24 offset:8192
  ds_read_b64_tr_b16 v[134:135], v24 offset:8704
  ds_write_b128 v26, v[192:195] offset:32768
  v_mul_f32 v200, v46, v200
  v_mul_f32_e64 v201, v46, v201
  s_waitcnt lgkmcnt(9)
  v_mfma_f32_32x32x16_bf16 v[224:239], v[144:147], a[8:11], v[224:239]
  ds_read_b64_tr_b16 v[136:137], v20 offset:10240
  ds_read_b64_tr_b16 v[138:139], v20 offset:10752
  v_mul_f32 v202, v46, v202
  v_mul_f32 v203, v46, v203
  v_mul_f32 v204, v46, v204
  v_mul_f32 v205, v46, v205
  v_mfma_f32_32x32x16_bf16 v[240:255], v[148:151], a[8:11], v[240:255]
  ds_read_b64_tr_b16 v[140:141], v24 offset:10240
  ds_read_b64_tr_b16 v[142:143], v24 offset:10752
  v_mul_f32 v206, v46, v206
  v_mul_f32_e64 v207, v46, v207
  v_cvt_pk_bf16_f32 v200, v200, v201
  s_waitcnt lgkmcnt(9)
  v_mfma_f32_32x32x16_bf16 v[224:239], v[152:155], a[12:15], v[224:239]
  ds_read_b64_tr_b16 v[144:145], v21 offset:8192
  ds_read_b64_tr_b16 v[146:147], v21 offset:8704
  v_cvt_pk_bf16_f32 v201, v202, v203
  v_cvt_pk_bf16_f32 v202, v204, v205
  v_cvt_pk_bf16_f32 v203, v206, v207
  v_mfma_f32_32x32x16_bf16 v[240:255], v[156:159], a[12:15], v[240:255]
  s_waitcnt vmcnt(28)
  s_barrier
  ds_read_b64_tr_b16 v[148:149], v25 offset:8192
  ds_read_b64_tr_b16 v[150:151], v25 offset:8704
  ds_write_b128 v27, v[200:203] offset:32768
  s_waitcnt lgkmcnt(10)
  s_nop 0
  v_mfma_f32_32x32x16_bf16 v[224:239], v[128:131], a[16:19], v[224:239]
  ds_read_b64_tr_b16 v[152:153], v21 offset:10240
  ds_read_b64_tr_b16 v[154:155], v21 offset:10752
  v_mul_f32 v208, v46, v208
  v_mul_f32 v209, v46, v209
  v_mul_f32 v210, v46, v210
  v_mul_f32 v211, v46, v211
  v_mfma_f32_32x32x16_bf16 v[240:255], v[132:135], a[16:19], v[240:255]
  ds_read_b64_tr_b16 v[156:157], v25 offset:10240
  ds_read_b64_tr_b16 v[158:159], v25 offset:10752
  s_mov_b32 m0, s43
  v_mul_f32 v212, v46, v212
  v_mul_f32 v213, v46, v213
  s_waitcnt lgkmcnt(9)
  v_mfma_f32_32x32x16_bf16 v[224:239], v[136:139], a[20:23], v[224:239]
  ds_read_b64_tr_b16 v[128:129], v18 offset:12288
  ds_read_b64_tr_b16 v[130:131], v18 offset:12800
  v_mul_f32 v214, v46, v214
  v_mul_f32 v215, v46, v215
  v_cvt_pk_bf16_f32 v208, v208, v209
  v_cvt_pk_bf16_f32 v209, v210, v211
  v_mfma_f32_32x32x16_bf16 v[240:255], v[140:143], a[20:23], v[240:255]
  ds_read_b64_tr_b16 v[132:133], v22 offset:12288
  ds_read_b64_tr_b16 v[134:135], v22 offset:12800
  v_cvt_pk_bf16_f32 v210, v212, v213
  v_cvt_pk_bf16_f32 v211, v214, v215
  s_waitcnt lgkmcnt(9)
  s_nop 0
  v_mfma_f32_32x32x16_bf16 v[224:239], v[144:147], a[24:27], v[224:239]
  ds_read_b64_tr_b16 v[136:137], v18 offset:14336
  ds_read_b64_tr_b16 v[138:139], v18 offset:14848
  buffer_load_dwordx4 v14, s[16:19], s73 offen offset:0 lds
  ds_write_b128 v28, v[208:211] offset:32768
  v_mul_f32 v216, v46, v216
  v_mul_f32 v217, v46, v217
  v_mfma_f32_32x32x16_bf16 v[240:255], v[148:151], a[24:27], v[240:255]
  ds_read_b64_tr_b16 v[140:141], v22 offset:14336
  ds_read_b64_tr_b16 v[142:143], v22 offset:14848
  v_mul_f32 v218, v46, v218
  v_mul_f32 v219, v46, v219
  v_mul_f32 v220, v46, v220
  s_waitcnt lgkmcnt(9)
  v_mfma_f32_32x32x16_bf16 v[224:239], v[152:155], a[28:31], v[224:239]
  ds_read_b64_tr_b16 v[144:145], v19 offset:12288
  ds_read_b64_tr_b16 v[146:147], v19 offset:12800
  v_mul_f32 v221, v46, v221
  v_mul_f32 v222, v46, v222
  v_mul_f32_e64 v223, v46, v223
  v_cvt_pk_bf16_f32 v216, v216, v217
  v_mfma_f32_32x32x16_bf16 v[240:255], v[156:159], a[28:31], v[240:255]
  ds_read_b64_tr_b16 v[148:149], v23 offset:12288
  ds_read_b64_tr_b16 v[150:151], v23 offset:12800
  buffer_load_dwordx4 v15, s[16:19], s73 offen offset:1024 lds
  v_cvt_pk_bf16_f32 v217, v218, v219
  v_cvt_pk_bf16_f32 v218, v220, v221
  s_waitcnt lgkmcnt(9)
  s_nop 0
  v_mfma_f32_32x32x16_bf16 v[224:239], v[128:131], a[32:35], v[224:239]
  ds_read_b64_tr_b16 v[152:153], v19 offset:14336
  ds_read_b64_tr_b16 v[154:155], v19 offset:14848
  buffer_load_dwordx4 v16, s[16:19], s73 offen offset:2048 lds
  v_cvt_pk_bf16_f32 v219, v222, v223
  v_mfma_f32_32x32x16_bf16 v[240:255], v[132:135], a[32:35], v[240:255]
  ds_read_b64_tr_b16 v[156:157], v23 offset:14336
  ds_read_b64_tr_b16 v[158:159], v23 offset:14848
  ds_write_b128 v29, v[216:219] offset:32768
  ds_read_b64_tr_b16 v[196:197], v30 offset:32768
  ds_read_b64_tr_b16 v[198:199], v31 offset:33280
  ds_read_b64_tr_b16 v[204:205], v32 offset:33792
  v_smfmac_f32_16x16x64_bf16 v[48:51], v[40:43], v[128:135], v44
  s_waitcnt lgkmcnt(12)
  s_nop 0
  v_smfmac_f32_16x16x64_bf16 v[48:51], v[40:43], v[136:143], v44
  v_mfma_f32_32x32x16_bf16 v[224:239], v[136:139], a[36:39], v[224:239]
  ds_read_b64_tr_b16 v[128:129], v20 offset:12288
  ds_read_b64_tr_b16 v[130:131], v20 offset:12800
  ds_read_b64_tr_b16 v[206:207], v33 offset:34304
  ds_read_b64_tr_b16 v[212:213], v30 offset:34816
  ds_read_b64_tr_b16 v[214:215], v31 offset:35328
  ds_read_b64_tr_b16 v[220:221], v32 offset:35840
  v_mfma_f32_32x32x16_bf16 v[240:255], v[140:143], a[36:39], v[240:255]
  ds_read_b64_tr_b16 v[132:133], v24 offset:12288
  ds_read_b64_tr_b16 v[134:135], v24 offset:12800
  buffer_load_dwordx4 v17, s[16:19], s73 offen offset:3072 lds
  ds_read_b64_tr_b16 v[222:223], v33 offset:36352
  s_waitcnt lgkmcnt(15)
  s_nop 0
  v_mfma_f32_32x32x16_bf16 v[224:239], v[144:147], a[40:43], v[224:239]
  ds_read_b64_tr_b16 v[136:137], v20 offset:14336
  ds_read_b64_tr_b16 v[138:139], v20 offset:14848
  v_mfma_f32_32x32x16_bf16 v[240:255], v[148:151], a[40:43], v[240:255]
  ds_read_b64_tr_b16 v[140:141], v24 offset:14336
  ds_read_b64_tr_b16 v[142:143], v24 offset:14848
  s_waitcnt lgkmcnt(15)
  s_nop 0
  v_mfma_f32_32x32x16_bf16 v[224:239], v[152:155], a[44:47], v[224:239]
  ds_read_b64_tr_b16 v[144:145], v21 offset:12288
  ds_read_b64_tr_b16 v[146:147], v21 offset:12800
  v_mfma_f32_32x32x16_bf16 v[240:255], v[156:159], a[44:47], v[240:255]
  s_waitcnt vmcnt(24)
  s_barrier
  ds_read_b64_tr_b16 v[148:149], v25 offset:12288
  ds_read_b64_tr_b16 v[150:151], v25 offset:12800
  s_mov_b32 m0, s38
  s_waitcnt lgkmcnt(9)
  v_mfma_f32_32x32x16_bf16 v[224:239], v[128:131], a[48:51], v[224:239]
  ds_read_b64_tr_b16 v[152:153], v21 offset:14336
  ds_read_b64_tr_b16 v[154:155], v21 offset:14848
  buffer_store_dwordx4 v[196:199], v1, s[12:15], s77 offen offset:0 sc1
  buffer_store_dwordx4 v[204:207], v1, s[12:15], s77 offen offset:1024 sc1
  buffer_store_dwordx4 v[212:215], v1, s[12:15], s77 offen offset:2048 sc1
  v_mfma_f32_32x32x16_bf16 v[240:255], v[132:135], a[48:51], v[240:255]
  ds_read_b64_tr_b16 v[156:157], v25 offset:14336
  ds_read_b64_tr_b16 v[158:159], v25 offset:14848
  buffer_load_dwordx4 v14, s[16:19], s74 offen offset:0 lds
  s_waitcnt lgkmcnt(8)
  s_nop 0
  v_mfma_f32_32x32x16_bf16 v[224:239], v[136:139], a[52:55], v[224:239]
  ds_read_b64_tr_b16 v[128:129], v18 offset:0
  ds_read_b64_tr_b16 v[130:131], v18 offset:512
  buffer_store_dwordx4 v[220:223], v1, s[12:15], s77 offen offset:3072 sc1
  v_mfma_f32_32x32x16_bf16 v[240:255], v[140:143], a[52:55], v[240:255]
  ds_read_b64_tr_b16 v[132:133], v22 offset:0
  ds_read_b64_tr_b16 v[134:135], v22 offset:512
  s_waitcnt lgkmcnt(8)
  s_nop 0
  v_mfma_f32_32x32x16_bf16 v[224:239], v[144:147], a[56:59], v[224:239]
  ds_read_b64_tr_b16 v[136:137], v18 offset:2048
  ds_read_b64_tr_b16 v[138:139], v18 offset:2560
  buffer_load_dwordx4 v15, s[16:19], s74 offen offset:1024 lds
  v_mfma_f32_32x32x16_bf16 v[240:255], v[148:151], a[56:59], v[240:255]
  ds_read_b64_tr_b16 v[140:141], v22 offset:2048
  ds_read_b64_tr_b16 v[142:143], v22 offset:2560
  s_waitcnt lgkmcnt(8)
  s_nop 0
  v_mfma_f32_32x32x16_bf16 v[224:239], v[152:155], a[60:63], v[224:239]
  ds_read_b64_tr_b16 v[144:145], v19 offset:0
  ds_read_b64_tr_b16 v[146:147], v19 offset:512
  v_mfma_f32_32x32x16_bf16 v[240:255], v[156:159], a[60:63], v[240:255]
  ds_read_b64_tr_b16 v[148:149], v23 offset:0
  ds_read_b64_tr_b16 v[150:151], v23 offset:512
  buffer_load_dwordx4 v16, s[16:19], s74 offen offset:2048 lds
  s_waitcnt lgkmcnt(8)
  s_nop 0
  v_mfma_f32_32x32x16_bf16 v[224:239], v[128:131], a[64:67], v[224:239]
  ds_read_b64_tr_b16 v[152:153], v19 offset:2048
  ds_read_b64_tr_b16 v[154:155], v19 offset:2560
  buffer_load_dwordx4 v17, s[16:19], s74 offen offset:3072 lds
  ds_read_b64_tr_b16 v[112:113], v18 offset:36864
  ds_read_b64_tr_b16 v[114:115], v18 offset:37376
  ds_read_b64_tr_b16 v[116:117], v22 offset:36864
  v_mfma_f32_32x32x16_bf16 v[240:255], v[132:135], a[64:67], v[240:255]
  ds_read_b64_tr_b16 v[156:157], v23 offset:2048
  ds_read_b64_tr_b16 v[158:159], v23 offset:2560
  ds_read_b64_tr_b16 v[118:119], v22 offset:37376
  s_add_u32 s80, s81, 96256
  v_smfmac_f32_16x16x64_bf16 v[48:51], v[40:43], v[128:135], v44
  s_waitcnt lgkmcnt(12)
  s_nop 0
  v_smfmac_f32_16x16x64_bf16 v[48:51], v[40:43], v[136:143], v44
  v_mfma_f32_32x32x16_bf16 v[224:239], v[136:139], a[68:71], v[224:239]
  ds_read_b64_tr_b16 v[128:129], v20 offset:0
  ds_read_b64_tr_b16 v[130:131], v20 offset:512
  v_mfma_f32_32x32x16_bf16 v[240:255], v[140:143], a[68:71], v[240:255]
  ds_read_b64_tr_b16 v[132:133], v24 offset:0
  ds_read_b64_tr_b16 v[134:135], v24 offset:512
  s_waitcnt lgkmcnt(12)
  s_nop 0
  v_mfma_f32_32x32x16_bf16 v[224:239], v[144:147], a[72:75], v[224:239]
  ds_read_b64_tr_b16 v[136:137], v20 offset:2048
  ds_read_b64_tr_b16 v[138:139], v20 offset:2560
  v_mfma_f32_32x32x16_bf16 v[240:255], v[148:151], a[72:75], v[240:255]
  ds_read_b64_tr_b16 v[140:141], v24 offset:2048
  ds_read_b64_tr_b16 v[142:143], v24 offset:2560
  s_waitcnt lgkmcnt(9)
  s_nop 0
  v_mfma_f32_32x32x16_bf16 v[224:239], v[152:155], a[76:79], v[224:239]
  ds_read_b64_tr_b16 v[144:145], v21 offset:0
  ds_read_b64_tr_b16 v[146:147], v21 offset:512
  v_mfma_f32_32x32x16_bf16 v[240:255], v[156:159], a[76:79], v[240:255]
  s_waitcnt vmcnt(26)
  s_barrier
  ds_read_b64_tr_b16 v[148:149], v25 offset:0
  ds_read_b64_tr_b16 v[150:151], v25 offset:512
  s_mov_b32 m0, s39
  s_waitcnt lgkmcnt(8)
  v_mfma_f32_32x32x16_bf16 v[224:239], v[128:131], a[80:83], v[224:239]
  ds_read_b64_tr_b16 v[152:153], v21 offset:2048
  ds_read_b64_tr_b16 v[154:155], v21 offset:2560
  buffer_store_dwordx4 v[112:115], v36, s[12:15], s81 offen sc1
  buffer_store_dwordx4 v[116:119], v36, s[12:15], s80 offen sc1
  v_mfma_f32_32x32x16_bf16 v[240:255], v[132:135], a[80:83], v[240:255]
  ds_read_b64_tr_b16 v[156:157], v25 offset:2048
  ds_read_b64_tr_b16 v[158:159], v25 offset:2560
  buffer_load_dwordx4 v14, s[16:19], s75 offen offset:0 lds
  s_waitcnt lgkmcnt(8)
  s_nop 0
  v_mfma_f32_32x32x16_bf16 v[224:239], v[136:139], a[84:87], v[224:239]
  ds_read_b64_tr_b16 v[128:129], v18 offset:16384
  ds_read_b64_tr_b16 v[130:131], v18 offset:16896
  v_mfma_f32_32x32x16_bf16 v[240:255], v[140:143], a[84:87], v[240:255]
  ds_read_b64_tr_b16 v[132:133], v22 offset:16384
  ds_read_b64_tr_b16 v[134:135], v22 offset:16896
  s_waitcnt lgkmcnt(8)
  s_nop 0
  v_mfma_f32_32x32x16_bf16 v[224:239], v[144:147], a[88:91], v[224:239]
  ds_read_b64_tr_b16 v[136:137], v18 offset:18432
  ds_read_b64_tr_b16 v[138:139], v18 offset:18944
  buffer_load_dwordx4 v15, s[16:19], s75 offen offset:1024 lds
  v_mfma_f32_32x32x16_bf16 v[240:255], v[148:151], a[88:91], v[240:255]
  ds_read_b64_tr_b16 v[140:141], v22 offset:18432
  ds_read_b64_tr_b16 v[142:143], v22 offset:18944
  s_waitcnt lgkmcnt(8)
  s_nop 0
  v_mfma_f32_32x32x16_bf16 v[224:239], v[152:155], a[92:95], v[224:239]
  ds_read_b64_tr_b16 v[144:145], v19 offset:16384
  ds_read_b64_tr_b16 v[146:147], v19 offset:16896
  v_mfma_f32_32x32x16_bf16 v[240:255], v[156:159], a[92:95], v[240:255]
  ds_read_b64_tr_b16 v[148:149], v23 offset:16384
  ds_read_b64_tr_b16 v[150:151], v23 offset:16896
  buffer_load_dwordx4 v16, s[16:19], s75 offen offset:2048 lds
  s_waitcnt lgkmcnt(8)
  s_nop 0
  v_mfma_f32_32x32x16_bf16 v[224:239], v[128:131], a[96:99], v[224:239]
  ds_read_b64_tr_b16 v[152:153], v19 offset:18432
  ds_read_b64_tr_b16 v[154:155], v19 offset:18944
  buffer_load_dwordx4 v17, s[16:19], s75 offen offset:3072 lds
  v_mfma_f32_32x32x16_bf16 v[240:255], v[132:135], a[96:99], v[240:255]
  ds_read_b64_tr_b16 v[156:157], v23 offset:18432
  ds_read_b64_tr_b16 v[158:159], v23 offset:18944
  v_smfmac_f32_16x16x64_bf16 v[48:51], v[40:43], v[128:135], v44
  s_waitcnt lgkmcnt(8)
  s_nop 0
  v_smfmac_f32_16x16x64_bf16 v[48:51], v[40:43], v[136:143], v44
  v_mfma_f32_32x32x16_bf16 v[224:239], v[136:139], a[100:103], v[224:239]
  ds_read_b64_tr_b16 v[128:129], v20 offset:16384
  ds_read_b64_tr_b16 v[130:131], v20 offset:16896
  v_mfma_f32_32x32x16_bf16 v[240:255], v[140:143], a[100:103], v[240:255]
  ds_read_b64_tr_b16 v[132:133], v24 offset:16384
  ds_read_b64_tr_b16 v[134:135], v24 offset:16896
  buffer_load_dword v4, v2, s[4:7], 0 offen offset:256
  s_waitcnt lgkmcnt(8)
  s_nop 0
  v_mfma_f32_32x32x16_bf16 v[224:239], v[144:147], a[104:107], v[224:239]
  ds_read_b64_tr_b16 v[136:137], v20 offset:18432
  ds_read_b64_tr_b16 v[138:139], v20 offset:18944
  v_mfma_f32_32x32x16_bf16 v[240:255], v[148:151], a[104:107], v[240:255]
  ds_read_b64_tr_b16 v[140:141], v24 offset:18432
  ds_read_b64_tr_b16 v[142:143], v24 offset:18944
  s_waitcnt lgkmcnt(8)
  s_nop 0
  v_mfma_f32_32x32x16_bf16 v[224:239], v[152:155], a[108:111], v[224:239]
  ds_read_b64_tr_b16 v[144:145], v21 offset:16384
  ds_read_b64_tr_b16 v[146:147], v21 offset:16896
  v_mfma_f32_32x32x16_bf16 v[240:255], v[156:159], a[108:111], v[240:255]
  s_waitcnt vmcnt(28)
  s_barrier
  ds_read_b64_tr_b16 v[148:149], v25 offset:16384
  ds_read_b64_tr_b16 v[150:151], v25 offset:16896
  s_waitcnt lgkmcnt(8)
  s_nop 0
  v_mfma_f32_32x32x16_bf16 v[224:239], v[128:131], a[112:115], v[224:239]
  ds_read_b64_tr_b16 v[152:153], v21 offset:18432
  ds_read_b64_tr_b16 v[154:155], v21 offset:18944
  v_mfma_f32_32x32x16_bf16 v[240:255], v[132:135], a[112:115], v[240:255]
  ds_read_b64_tr_b16 v[156:157], v25 offset:18432
  ds_read_b64_tr_b16 v[158:159], v25 offset:18944
  s_waitcnt lgkmcnt(8)
  s_nop 0
  v_mfma_f32_32x32x16_bf16 v[224:239], v[136:139], a[116:119], v[224:239]
  ds_read_b64_tr_b16 v[128:129], v18 offset:20480
  ds_read_b64_tr_b16 v[130:131], v18 offset:20992
  v_mfma_f32_32x32x16_bf16 v[240:255], v[140:143], a[116:119], v[240:255]
  ds_read_b64_tr_b16 v[132:133], v22 offset:20480
  ds_read_b64_tr_b16 v[134:135], v22 offset:20992
  s_waitcnt lgkmcnt(8)
  s_nop 0
  v_mfma_f32_32x32x16_bf16 v[224:239], v[144:147], a[120:123], v[224:239]
  ds_read_b64_tr_b16 v[136:137], v18 offset:22528
  ds_read_b64_tr_b16 v[138:139], v18 offset:23040
  v_mfma_f32_32x32x16_bf16 v[240:255], v[148:151], a[120:123], v[240:255]
  ds_read_b64_tr_b16 v[140:141], v22 offset:22528
  ds_read_b64_tr_b16 v[142:143], v22 offset:23040
  s_waitcnt lgkmcnt(8)
  s_nop 0
  v_mfma_f32_32x32x16_bf16 v[224:239], v[152:155], a[124:127], v[224:239]
  ds_read_b64_tr_b16 v[144:145], v19 offset:20480
  ds_read_b64_tr_b16 v[146:147], v19 offset:20992
  v_mfma_f32_32x32x16_bf16 v[240:255], v[156:159], a[124:127], v[240:255]
  ds_read_b64_tr_b16 v[148:149], v23 offset:20480
  ds_read_b64_tr_b16 v[150:151], v23 offset:20992
  s_waitcnt lgkmcnt(8)
  s_nop 0
  v_mfma_f32_32x32x16_bf16 v[224:239], v[128:131], a[128:131], v[224:239]
  ds_read_b64_tr_b16 v[152:153], v19 offset:22528
  ds_read_b64_tr_b16 v[154:155], v19 offset:23040
  v_mfma_f32_32x32x16_bf16 v[240:255], v[132:135], a[128:131], v[240:255]
  ds_read_b64_tr_b16 v[156:157], v23 offset:22528
  ds_read_b64_tr_b16 v[158:159], v23 offset:23040
  v_smfmac_f32_16x16x64_bf16 v[48:51], v[40:43], v[128:135], v44
  s_waitcnt lgkmcnt(8)
  s_nop 0
  v_smfmac_f32_16x16x64_bf16 v[48:51], v[40:43], v[136:143], v44
  v_mfma_f32_32x32x16_bf16 v[224:239], v[136:139], a[132:135], v[224:239]
  ds_read_b64_tr_b16 v[128:129], v20 offset:20480
  ds_read_b64_tr_b16 v[130:131], v20 offset:20992
  v_mfma_f32_32x32x16_bf16 v[240:255], v[140:143], a[132:135], v[240:255]
  ds_read_b64_tr_b16 v[132:133], v24 offset:20480
  ds_read_b64_tr_b16 v[134:135], v24 offset:20992
  v_add_f32 v78, v48, v49
  s_waitcnt lgkmcnt(8)
  v_mfma_f32_32x32x16_bf16 v[224:239], v[144:147], a[136:139], v[224:239]
  ds_read_b64_tr_b16 v[136:137], v20 offset:22528
  ds_read_b64_tr_b16 v[138:139], v20 offset:23040
  ds_write_b32 v37, v78
  v_mov_b32 v48, 0
  v_mov_b32 v49, 0
  v_mfma_f32_32x32x16_bf16 v[240:255], v[148:151], a[136:139], v[240:255]
  ds_read_b64_tr_b16 v[140:141], v24 offset:22528
  ds_read_b64_tr_b16 v[142:143], v24 offset:23040
  s_waitcnt lgkmcnt(9)
  s_nop 0
  v_mfma_f32_32x32x16_bf16 v[224:239], v[152:155], a[140:143], v[224:239]
  ds_read_b64_tr_b16 v[144:145], v21 offset:20480
  ds_read_b64_tr_b16 v[146:147], v21 offset:20992
  v_mfma_f32_32x32x16_bf16 v[240:255], v[156:159], a[140:143], v[240:255]
  s_waitcnt vmcnt(24) lgkmcnt(4)
  s_barrier
  ds_read2st64_b32 v[74:75], v38 offset1:160
  ds_read2st64_b32 v[76:77], v39 offset1:160
  ds_read_b64_tr_b16 v[148:149], v25 offset:20480
  ds_read_b64_tr_b16 v[150:151], v25 offset:20992
  v_mfma_f32_32x32x16_bf16 v[224:239], v[128:131], a[144:147], v[224:239]
  ds_read_b64_tr_b16 v[152:153], v21 offset:22528
  ds_read_b64_tr_b16 v[154:155], v21 offset:23040
  v_mfma_f32_32x32x16_bf16 v[240:255], v[132:135], a[144:147], v[240:255]
  ds_read_b64_tr_b16 v[156:157], v25 offset:22528
  ds_read_b64_tr_b16 v[158:159], v25 offset:23040
  s_waitcnt lgkmcnt(10)
  s_nop 0
  v_mfma_f32_32x32x16_bf16 v[224:239], v[136:139], a[148:151], v[224:239]
  ds_read_b64_tr_b16 v[128:129], v18 offset:4096
  ds_read_b64_tr_b16 v[130:131], v18 offset:4608
  v_mfma_f32_32x32x16_bf16 v[240:255], v[140:143], a[148:151], v[240:255]
  ds_read_b64_tr_b16 v[132:133], v22 offset:4096
  ds_read_b64_tr_b16 v[134:135], v22 offset:4608
  s_waitcnt lgkmcnt(8)
  s_nop 0
  v_mfma_f32_32x32x16_bf16 v[224:239], v[144:147], a[152:155], v[224:239]
  ds_read_b64_tr_b16 v[136:137], v18 offset:6144
  ds_read_b64_tr_b16 v[138:139], v18 offset:6656
  v_add_f32 v74, v74, v75
  v_add_f32 v76, v76, v77
  v_add_f32_e64 v74, v74, v76
  v_cvt_pk_bf16_f32 v75, v74, v74
  v_mfma_f32_32x32x16_bf16 v[240:255], v[148:151], a[152:155], v[240:255]
  ds_read_b64_tr_b16 v[140:141], v22 offset:6144
  ds_read_b64_tr_b16 v[142:143], v22 offset:6656
  v_and_b32 v75, 0xffff0000, v75
  v_sub_f32 v75, v74, v75
  v_cvt_pk_bf16_f32 v68, v74, v75
  s_waitcnt lgkmcnt(8)
  v_mfma_f32_32x32x16_bf16 v[224:239], v[152:155], a[156:159], v[224:239]
  ds_read_b64_tr_b16 v[144:145], v19 offset:4096
  ds_read_b64_tr_b16 v[146:147], v19 offset:4608
  v_cvt_pk_bf16_f32 v69, v74, v75
  v_mfma_f32_32x32x16_bf16 v[240:255], v[156:159], a[156:159], v[240:255]
  ds_read_b64_tr_b16 v[148:149], v23 offset:4096
  ds_read_b64_tr_b16 v[150:151], v23 offset:4608
  v_mfma_f32_32x32x8_bf16 v[224:239], v[68:69], v[70:71], v[224:239]
  v_mfma_f32_32x32x8_bf16 v[240:255], v[68:69], v[72:73], v[240:255]
  s_waitcnt lgkmcnt(8)
  s_nop 0
  v_mfma_f32_32x32x16_bf16 v[160:175], v[128:131], a[0:3], 0
  ds_read_b64_tr_b16 v[152:153], v19 offset:6144
  ds_read_b64_tr_b16 v[154:155], v19 offset:6656
  v_mul_f32 v224, v47, v224
  v_mul_f32 v225, v47, v225
  v_mul_f32 v226, v47, v226
  v_mul_f32 v227, v47, v227
  v_mfma_f32_32x32x16_bf16 v[176:191], v[132:135], a[0:3], 0
  ds_read_b64_tr_b16 v[156:157], v23 offset:6144
  ds_read_b64_tr_b16 v[158:159], v23 offset:6656
  v_mul_f32 v228, v47, v228
  v_mul_f32 v229, v47, v229
  v_mul_f32 v230, v47, v230
  v_mul_f32 v231, v47, v231
  v_smfmac_f32_16x16x64_bf16 v[48:51], v[40:43], v[128:135], v44
  s_waitcnt lgkmcnt(8)
  s_nop 0
  v_smfmac_f32_16x16x64_bf16 v[48:51], v[40:43], v[136:143], v44
  v_mfma_f32_32x32x16_bf16 v[160:175], v[136:139], a[4:7], v[160:175]
  ds_read_b64_tr_b16 v[128:129], v20 offset:4096
  ds_read_b64_tr_b16 v[130:131], v20 offset:4608
  v_cvt_pk_bf16_f32 v224, v224, v225
  v_cvt_pk_bf16_f32 v225, v226, v227
  v_cvt_pk_bf16_f32 v226, v228, v229
  v_cvt_pk_bf16_f32 v227, v230, v231
  v_mfma_f32_32x32x16_bf16 v[176:191], v[140:143], a[4:7], v[176:191]
  ds_read_b64_tr_b16 v[132:133], v24 offset:4096
  ds_read_b64_tr_b16 v[134:135], v24 offset:4608
  buffer_store_dwordx4 v[224:227], v1, s[12:15], s78 offen offset:0 sc1
  v_mul_f32 v232, v47, v232
  v_mul_f32_e64 v233, v47, v233
  s_waitcnt lgkmcnt(8)
  v_mfma_f32_32x32x16_bf16 v[160:175], v[144:147], a[8:11], v[160:175]
  ds_read_b64_tr_b16 v[136:137], v20 offset:6144
  ds_read_b64_tr_b16 v[138:139], v20 offset:6656
  v_mul_f32 v234, v47, v234
  v_mul_f32 v235, v47, v235
  v_mul_f32 v236, v47, v236
  v_mul_f32 v237, v47, v237
  v_mfma_f32_32x32x16_bf16 v[176:191], v[148:151], a[8:11], v[176:191]
  ds_read_b64_tr_b16 v[140:141], v24 offset:6144
  ds_read_b64_tr_b16 v[142:143], v24 offset:6656
  v_mul_f32 v238, v47, v238
  v_mul_f32_e64 v239, v47, v239
  v_cvt_pk_bf16_f32 v232, v232, v233
  s_waitcnt lgkmcnt(8)
  v_mfma_f32_32x32x16_bf16 v[160:175], v[152:155], a[12:15], v[160:175]
  ds_read_b64_tr_b16 v[144:145], v21 offset:4096
  ds_read_b64_tr_b16 v[146:147], v21 offset:4608
  v_cvt_pk_bf16_f32 v233, v234, v235
  v_cvt_pk_bf16_f32 v234, v236, v237
  v_cvt_pk_bf16_f32 v235, v238, v239
  v_mfma_f32_32x32x16_bf16 v[176:191], v[156:159], a[12:15], v[176:191]
  s_waitcnt vmcnt(21)
  s_barrier
  ds_read_b64_tr_b16 v[148:149], v25 offset:4096
  ds_read_b64_tr_b16 v[150:151], v25 offset:4608
  buffer_store_dwordx4 v[232:235], v1, s[12:15], s78 offen offset:1024 sc1
  s_waitcnt lgkmcnt(8)
  s_nop 0
  v_mfma_f32_32x32x16_bf16 v[160:175], v[128:131], a[16:19], v[160:175]
  ds_read_b64_tr_b16 v[152:153], v21 offset:6144
  ds_read_b64_tr_b16 v[154:155], v21 offset:6656
  v_mul_f32 v240, v47, v240
  v_mul_f32 v241, v47, v241
  v_mul_f32 v242, v47, v242
  v_mul_f32 v243, v47, v243
  v_mfma_f32_32x32x16_bf16 v[176:191], v[132:135], a[16:19], v[176:191]
  ds_read_b64_tr_b16 v[156:157], v25 offset:6144
  ds_read_b64_tr_b16 v[158:159], v25 offset:6656
  buffer_load_dword v4, v2, s[4:7], 0 offen offset:384
  v_mul_f32 v244, v47, v244
  v_mul_f32_e64 v245, v47, v245
  s_waitcnt lgkmcnt(8)
  v_mfma_f32_32x32x16_bf16 v[160:175], v[136:139], a[20:23], v[160:175]
  ds_read_b64_tr_b16 v[128:129], v18 offset:24576
  ds_read_b64_tr_b16 v[130:131], v18 offset:25088
  v_mul_f32 v246, v47, v246
  v_mul_f32 v247, v47, v247
  v_cvt_pk_bf16_f32 v240, v240, v241
  v_cvt_pk_bf16_f32 v241, v242, v243
  v_mfma_f32_32x32x16_bf16 v[176:191], v[140:143], a[20:23], v[176:191]
  ds_read_b64_tr_b16 v[132:133], v22 offset:24576
  ds_read_b64_tr_b16 v[134:135], v22 offset:25088
  v_cvt_pk_bf16_f32 v242, v244, v245
  v_cvt_pk_bf16_f32 v243, v246, v247
  s_waitcnt lgkmcnt(8)
  s_nop 0
  v_mfma_f32_32x32x16_bf16 v[160:175], v[144:147], a[24:27], v[160:175]
  ds_read_b64_tr_b16 v[136:137], v18 offset:26624
  ds_read_b64_tr_b16 v[138:139], v18 offset:27136
  buffer_store_dwordx4 v[240:243], v1, s[12:15], s78 offen offset:2048 sc1
  v_mul_f32 v248, v47, v248
  v_mul_f32 v249, v47, v249
  v_mul_f32_e64 v250, v47, v250
  v_mfma_f32_32x32x16_bf16 v[176:191], v[148:151], a[24:27], v[176:191]
  ds_read_b64_tr_b16 v[140:141], v22 offset:26624
  ds_read_b64_tr_b16 v[142:143], v22 offset:27136
  v_mul_f32 v251, v47, v251
  v_mul_f32 v252, v47, v252
  v_mul_f32 v253, v47, v253
  s_waitcnt lgkmcnt(8)
  v_mfma_f32_32x32x16_bf16 v[160:175], v[152:155], a[28:31], v[160:175]
  ds_read_b64_tr_b16 v[144:145], v19 offset:24576
  ds_read_b64_tr_b16 v[146:147], v19 offset:25088
  v_mul_f32 v254, v47, v254
  v_mul_f32 v255, v47, v255
  v_cvt_pk_bf16_f32 v248, v248, v249
  v_cvt_pk_bf16_f32 v249, v250, v251
  v_mfma_f32_32x32x16_bf16 v[176:191], v[156:159], a[28:31], v[176:191]
  ds_read_b64_tr_b16 v[148:149], v23 offset:24576
  ds_read_b64_tr_b16 v[150:151], v23 offset:25088
  v_cvt_pk_bf16_f32 v250, v252, v253
  v_cvt_pk_bf16_f32 v251, v254, v255
  s_waitcnt lgkmcnt(8)
  s_nop 0
  v_mfma_f32_32x32x16_bf16 v[160:175], v[128:131], a[32:35], v[160:175]
  ds_read_b64_tr_b16 v[152:153], v19 offset:26624
  ds_read_b64_tr_b16 v[154:155], v19 offset:27136
  buffer_store_dwordx4 v[248:251], v1, s[12:15], s78 offen offset:3072 sc1
  v_mfma_f32_32x32x16_bf16 v[176:191], v[132:135], a[32:35], v[176:191]
  ds_read_b64_tr_b16 v[156:157], v23 offset:26624
  ds_read_b64_tr_b16 v[158:159], v23 offset:27136
  v_smfmac_f32_16x16x64_bf16 v[48:51], v[40:43], v[128:135], v44
  s_waitcnt lgkmcnt(8)
  s_nop 0
  v_smfmac_f32_16x16x64_bf16 v[48:51], v[40:43], v[136:143], v44
  v_mfma_f32_32x32x16_bf16 v[160:175], v[136:139], a[36:39], v[160:175]
  ds_read_b64_tr_b16 v[128:129], v20 offset:24576
  ds_read_b64_tr_b16 v[130:131], v20 offset:25088
  v_mfma_f32_32x32x16_bf16 v[176:191], v[140:143], a[36:39], v[176:191]
  ds_read_b64_tr_b16 v[132:133], v24 offset:24576
  ds_read_b64_tr_b16 v[134:135], v24 offset:25088
  s_waitcnt lgkmcnt(8)
  s_nop 0
  v_mfma_f32_32x32x16_bf16 v[160:175], v[144:147], a[40:43], v[160:175]
  ds_read_b64_tr_b16 v[136:137], v20 offset:26624
  ds_read_b64_tr_b16 v[138:139], v20 offset:27136
  v_mfma_f32_32x32x16_bf16 v[176:191], v[148:151], a[40:43], v[176:191]
  ds_read_b64_tr_b16 v[140:141], v24 offset:26624
  ds_read_b64_tr_b16 v[142:143], v24 offset:27136
  s_waitcnt lgkmcnt(8)
  s_nop 0
  v_mfma_f32_32x32x16_bf16 v[160:175], v[152:155], a[44:47], v[160:175]
  ds_read_b64_tr_b16 v[144:145], v21 offset:24576
  ds_read_b64_tr_b16 v[146:147], v21 offset:25088
  v_mfma_f32_32x32x16_bf16 v[176:191], v[156:159], a[44:47], v[176:191]
  s_waitcnt vmcnt(20)
  s_barrier
  ds_read_b64_tr_b16 v[148:149], v25 offset:24576
  ds_read_b64_tr_b16 v[150:151], v25 offset:25088
  s_waitcnt lgkmcnt(8)
  s_nop 0
  v_mfma_f32_32x32x16_bf16 v[160:175], v[128:131], a[48:51], v[160:175]
  ds_read_b64_tr_b16 v[152:153], v21 offset:26624
  ds_read_b64_tr_b16 v[154:155], v21 offset:27136
  v_mfma_f32_32x32x16_bf16 v[176:191], v[132:135], a[48:51], v[176:191]
  ds_read_b64_tr_b16 v[156:157], v25 offset:26624
  ds_read_b64_tr_b16 v[158:159], v25 offset:27136
  s_waitcnt lgkmcnt(8)
  s_nop 0
  v_mfma_f32_32x32x16_bf16 v[160:175], v[136:139], a[52:55], v[160:175]
  ds_read_b64_tr_b16 v[128:129], v18 offset:28672
  ds_read_b64_tr_b16 v[130:131], v18 offset:29184
  v_mfma_f32_32x32x16_bf16 v[176:191], v[140:143], a[52:55], v[176:191]
  ds_read_b64_tr_b16 v[132:133], v22 offset:28672
  ds_read_b64_tr_b16 v[134:135], v22 offset:29184
  s_waitcnt lgkmcnt(8)
  s_nop 0
  v_mfma_f32_32x32x16_bf16 v[160:175], v[144:147], a[56:59], v[160:175]
  ds_read_b64_tr_b16 v[136:137], v18 offset:30720
  ds_read_b64_tr_b16 v[138:139], v18 offset:31232
  v_mfma_f32_32x32x16_bf16 v[176:191], v[148:151], a[56:59], v[176:191]
  ds_read_b64_tr_b16 v[140:141], v22 offset:30720
  ds_read_b64_tr_b16 v[142:143], v22 offset:31232
  s_waitcnt lgkmcnt(8)
  s_nop 0
  v_mfma_f32_32x32x16_bf16 v[160:175], v[152:155], a[60:63], v[160:175]
  ds_read_b64_tr_b16 v[144:145], v19 offset:28672
  ds_read_b64_tr_b16 v[146:147], v19 offset:29184
  v_mfma_f32_32x32x16_bf16 v[176:191], v[156:159], a[60:63], v[176:191]
  ds_read_b64_tr_b16 v[148:149], v23 offset:28672
  ds_read_b64_tr_b16 v[150:151], v23 offset:29184
  s_waitcnt lgkmcnt(8)
  s_nop 0
  v_mfma_f32_32x32x16_bf16 v[160:175], v[128:131], a[64:67], v[160:175]
  ds_read_b64_tr_b16 v[152:153], v19 offset:30720
  ds_read_b64_tr_b16 v[154:155], v19 offset:31232
  v_mfma_f32_32x32x16_bf16 v[176:191], v[132:135], a[64:67], v[176:191]
  ds_read_b64_tr_b16 v[156:157], v23 offset:30720
  ds_read_b64_tr_b16 v[158:159], v23 offset:31232
  v_smfmac_f32_16x16x64_bf16 v[48:51], v[40:43], v[128:135], v44
  s_waitcnt lgkmcnt(8)
  s_nop 0
  v_smfmac_f32_16x16x64_bf16 v[48:51], v[40:43], v[136:143], v44
  v_mfma_f32_32x32x16_bf16 v[160:175], v[136:139], a[68:71], v[160:175]
  ds_read_b64_tr_b16 v[128:129], v20 offset:28672
  ds_read_b64_tr_b16 v[130:131], v20 offset:29184
  v_mfma_f32_32x32x16_bf16 v[176:191], v[140:143], a[68:71], v[176:191]
  ds_read_b64_tr_b16 v[132:133], v24 offset:28672
  ds_read_b64_tr_b16 v[134:135], v24 offset:29184
  s_waitcnt lgkmcnt(8)
  s_nop 0
  v_mfma_f32_32x32x16_bf16 v[160:175], v[144:147], a[72:75], v[160:175]
  ds_read_b64_tr_b16 v[136:137], v20 offset:30720
  ds_read_b64_tr_b16 v[138:139], v20 offset:31232
  v_mfma_f32_32x32x16_bf16 v[176:191], v[148:151], a[72:75], v[176:191]
  ds_read_b64_tr_b16 v[140:141], v24 offset:30720
  ds_read_b64_tr_b16 v[142:143], v24 offset:31232
  s_waitcnt lgkmcnt(8)
  s_nop 0
  v_mfma_f32_32x32x16_bf16 v[160:175], v[152:155], a[76:79], v[160:175]
  ds_read_b64_tr_b16 v[144:145], v21 offset:28672
  ds_read_b64_tr_b16 v[146:147], v21 offset:29184
  v_mfma_f32_32x32x16_bf16 v[176:191], v[156:159], a[76:79], v[176:191]
  s_waitcnt vmcnt(12)
  s_barrier
  ds_read_b64_tr_b16 v[148:149], v25 offset:28672
  ds_read_b64_tr_b16 v[150:151], v25 offset:29184
  s_waitcnt lgkmcnt(8)
  s_nop 0
  v_mfma_f32_32x32x16_bf16 v[160:175], v[128:131], a[80:83], v[160:175]
  ds_read_b64_tr_b16 v[152:153], v21 offset:30720
  ds_read_b64_tr_b16 v[154:155], v21 offset:31232
  v_mfma_f32_32x32x16_bf16 v[176:191], v[132:135], a[80:83], v[176:191]
  ds_read_b64_tr_b16 v[156:157], v25 offset:30720
  ds_read_b64_tr_b16 v[158:159], v25 offset:31232
  s_waitcnt lgkmcnt(8)
  s_nop 0
  v_mfma_f32_32x32x16_bf16 v[160:175], v[136:139], a[84:87], v[160:175]
  ds_read_b64_tr_b16 v[128:129], v18 offset:8192
  ds_read_b64_tr_b16 v[130:131], v18 offset:8704
  v_mfma_f32_32x32x16_bf16 v[176:191], v[140:143], a[84:87], v[176:191]
  ds_read_b64_tr_b16 v[132:133], v22 offset:8192
  ds_read_b64_tr_b16 v[134:135], v22 offset:8704
  s_waitcnt lgkmcnt(8)
  s_nop 0
  v_mfma_f32_32x32x16_bf16 v[160:175], v[144:147], a[88:91], v[160:175]
  ds_read_b64_tr_b16 v[136:137], v18 offset:10240
  ds_read_b64_tr_b16 v[138:139], v18 offset:10752
  v_mfma_f32_32x32x16_bf16 v[176:191], v[148:151], a[88:91], v[176:191]
  ds_read_b64_tr_b16 v[140:141], v22 offset:10240
  ds_read_b64_tr_b16 v[142:143], v22 offset:10752
  s_waitcnt lgkmcnt(8)
  s_nop 0
  v_mfma_f32_32x32x16_bf16 v[160:175], v[152:155], a[92:95], v[160:175]
  ds_read_b64_tr_b16 v[144:145], v19 offset:8192
  ds_read_b64_tr_b16 v[146:147], v19 offset:8704
  v_mfma_f32_32x32x16_bf16 v[176:191], v[156:159], a[92:95], v[176:191]
  ds_read_b64_tr_b16 v[148:149], v23 offset:8192
  ds_read_b64_tr_b16 v[150:151], v23 offset:8704
  s_waitcnt lgkmcnt(8)
  s_nop 0
  v_mfma_f32_32x32x16_bf16 v[160:175], v[128:131], a[96:99], v[160:175]
  ds_read_b64_tr_b16 v[152:153], v19 offset:10240
  ds_read_b64_tr_b16 v[154:155], v19 offset:10752
  v_mfma_f32_32x32x16_bf16 v[176:191], v[132:135], a[96:99], v[176:191]
  ds_read_b64_tr_b16 v[156:157], v23 offset:10240
  ds_read_b64_tr_b16 v[158:159], v23 offset:10752
  v_smfmac_f32_16x16x64_bf16 v[48:51], v[40:43], v[128:135], v44
  s_waitcnt lgkmcnt(8)
  s_nop 0
  v_smfmac_f32_16x16x64_bf16 v[48:51], v[40:43], v[136:143], v44
  v_mfma_f32_32x32x16_bf16 v[160:175], v[136:139], a[100:103], v[160:175]
  ds_read_b64_tr_b16 v[128:129], v20 offset:8192
  ds_read_b64_tr_b16 v[130:131], v20 offset:8704
  v_mfma_f32_32x32x16_bf16 v[176:191], v[140:143], a[100:103], v[176:191]
  ds_read_b64_tr_b16 v[132:133], v24 offset:8192
  ds_read_b64_tr_b16 v[134:135], v24 offset:8704
  s_waitcnt lgkmcnt(8)
  s_nop 0
  v_mfma_f32_32x32x16_bf16 v[160:175], v[144:147], a[104:107], v[160:175]
  ds_read_b64_tr_b16 v[136:137], v20 offset:10240
  ds_read_b64_tr_b16 v[138:139], v20 offset:10752
  v_mfma_f32_32x32x16_bf16 v[176:191], v[148:151], a[104:107], v[176:191]
  ds_read_b64_tr_b16 v[140:141], v24 offset:10240
  ds_read_b64_tr_b16 v[142:143], v24 offset:10752
  s_waitcnt lgkmcnt(8)
  s_nop 0
  v_mfma_f32_32x32x16_bf16 v[160:175], v[152:155], a[108:111], v[160:175]
  ds_read_b64_tr_b16 v[144:145], v21 offset:8192
  ds_read_b64_tr_b16 v[146:147], v21 offset:8704
  v_mfma_f32_32x32x16_bf16 v[176:191], v[156:159], a[108:111], v[176:191]
  s_waitcnt vmcnt(6)
  s_barrier
  ds_read_b64_tr_b16 v[148:149], v25 offset:8192
  ds_read_b64_tr_b16 v[150:151], v25 offset:8704
  s_waitcnt lgkmcnt(8)
  s_nop 0
  v_mfma_f32_32x32x16_bf16 v[160:175], v[128:131], a[112:115], v[160:175]
  ds_read_b64_tr_b16 v[152:153], v21 offset:10240
  ds_read_b64_tr_b16 v[154:155], v21 offset:10752
  v_mfma_f32_32x32x16_bf16 v[176:191], v[132:135], a[112:115], v[176:191]
  ds_read_b64_tr_b16 v[156:157], v25 offset:10240
  ds_read_b64_tr_b16 v[158:159], v25 offset:10752
  s_waitcnt lgkmcnt(8)
  s_nop 0
  v_mfma_f32_32x32x16_bf16 v[160:175], v[136:139], a[116:119], v[160:175]
  ds_read_b64_tr_b16 v[128:129], v18 offset:12288
  ds_read_b64_tr_b16 v[130:131], v18 offset:12800
  v_mfma_f32_32x32x16_bf16 v[176:191], v[140:143], a[116:119], v[176:191]
  ds_read_b64_tr_b16 v[132:133], v22 offset:12288
  ds_read_b64_tr_b16 v[134:135], v22 offset:12800
  s_waitcnt lgkmcnt(8)
  s_nop 0
  v_mfma_f32_32x32x16_bf16 v[160:175], v[144:147], a[120:123], v[160:175]
  ds_read_b64_tr_b16 v[136:137], v18 offset:14336
  ds_read_b64_tr_b16 v[138:139], v18 offset:14848
  v_mfma_f32_32x32x16_bf16 v[176:191], v[148:151], a[120:123], v[176:191]
  ds_read_b64_tr_b16 v[140:141], v22 offset:14336
  ds_read_b64_tr_b16 v[142:143], v22 offset:14848
  s_waitcnt lgkmcnt(8)
  s_nop 0
  v_mfma_f32_32x32x16_bf16 v[160:175], v[152:155], a[124:127], v[160:175]
  ds_read_b64_tr_b16 v[144:145], v19 offset:12288
  ds_read_b64_tr_b16 v[146:147], v19 offset:12800
  v_mfma_f32_32x32x16_bf16 v[176:191], v[156:159], a[124:127], v[176:191]
  ds_read_b64_tr_b16 v[148:149], v23 offset:12288
  ds_read_b64_tr_b16 v[150:151], v23 offset:12800
  s_waitcnt lgkmcnt(8)
  s_nop 0
  v_mfma_f32_32x32x16_bf16 v[160:175], v[128:131], a[128:131], v[160:175]
  ds_read_b64_tr_b16 v[152:153], v19 offset:14336
  ds_read_b64_tr_b16 v[154:155], v19 offset:14848
  v_mfma_f32_32x32x16_bf16 v[176:191], v[132:135], a[128:131], v[176:191]
  ds_read_b64_tr_b16 v[156:157], v23 offset:14336
  ds_read_b64_tr_b16 v[158:159], v23 offset:14848
  v_smfmac_f32_16x16x64_bf16 v[48:51], v[40:43], v[128:135], v44
  s_waitcnt lgkmcnt(8)
  s_nop 0
  v_smfmac_f32_16x16x64_bf16 v[48:51], v[40:43], v[136:143], v44
  v_mfma_f32_32x32x16_bf16 v[160:175], v[136:139], a[132:135], v[160:175]
  ds_read_b64_tr_b16 v[128:129], v20 offset:12288
  ds_read_b64_tr_b16 v[130:131], v20 offset:12800
  v_mfma_f32_32x32x16_bf16 v[176:191], v[140:143], a[132:135], v[176:191]
  ds_read_b64_tr_b16 v[132:133], v24 offset:12288
  ds_read_b64_tr_b16 v[134:135], v24 offset:12800
  v_add_f32 v78, v48, v49
  s_waitcnt lgkmcnt(8)
  v_mfma_f32_32x32x16_bf16 v[160:175], v[144:147], a[136:139], v[160:175]
  ds_read_b64_tr_b16 v[136:137], v20 offset:14336
  ds_read_b64_tr_b16 v[138:139], v20 offset:14848
  ds_write_b32 v37, v78
  v_mov_b32 v48, 0
  v_mov_b32 v49, 0
  v_mfma_f32_32x32x16_bf16 v[176:191], v[148:151], a[136:139], v[176:191]
  ds_read_b64_tr_b16 v[140:141], v24 offset:14336
  ds_read_b64_tr_b16 v[142:143], v24 offset:14848
  s_waitcnt lgkmcnt(9)
  s_nop 0
  v_mfma_f32_32x32x16_bf16 v[160:175], v[152:155], a[140:143], v[160:175]
  ds_read_b64_tr_b16 v[144:145], v21 offset:12288
  ds_read_b64_tr_b16 v[146:147], v21 offset:12800
  v_mfma_f32_32x32x16_bf16 v[176:191], v[156:159], a[140:143], v[176:191]
  s_waitcnt lgkmcnt(4)
  s_barrier
  ds_read2st64_b32 v[74:75], v38 offset1:160
  ds_read2st64_b32 v[76:77], v39 offset1:160
  ds_read_b64_tr_b16 v[148:149], v25 offset:12288
  ds_read_b64_tr_b16 v[150:151], v25 offset:12800
  v_mfma_f32_32x32x16_bf16 v[160:175], v[128:131], a[144:147], v[160:175]
  ds_read_b64_tr_b16 v[152:153], v21 offset:14336
  ds_read_b64_tr_b16 v[154:155], v21 offset:14848
  v_mfma_f32_32x32x16_bf16 v[176:191], v[132:135], a[144:147], v[176:191]
  ds_read_b64_tr_b16 v[156:157], v25 offset:14336
  ds_read_b64_tr_b16 v[158:159], v25 offset:14848
  s_waitcnt lgkmcnt(10)
  s_nop 0
  v_mfma_f32_32x32x16_bf16 v[160:175], v[136:139], a[148:151], v[160:175]
  v_mfma_f32_32x32x16_bf16 v[176:191], v[140:143], a[148:151], v[176:191]
  s_waitcnt lgkmcnt(4)
  s_nop 0
  v_mfma_f32_32x32x16_bf16 v[160:175], v[144:147], a[152:155], v[160:175]
  v_add_f32 v74, v74, v75
  v_add_f32 v76, v76, v77
  v_add_f32 v74, v74, v76
  v_cvt_pk_bf16_f32 v75, v74, v74
  v_and_b32 v75, 0xffff0000, v75
  v_sub_f32 v75, v74, v75
  v_mfma_f32_32x32x16_bf16 v[176:191], v[148:151], a[152:155], v[176:191]
  v_cvt_pk_bf16_f32 v68, v74, v75
  v_cvt_pk_bf16_f32 v69, v74, v75
  s_waitcnt lgkmcnt(0)
  s_nop 0
  v_mfma_f32_32x32x16_bf16 v[160:175], v[152:155], a[156:159], v[160:175]
  v_mfma_f32_32x32x16_bf16 v[176:191], v[156:159], a[156:159], v[176:191]
  v_mfma_f32_32x32x8_bf16 v[160:175], v[68:69], v[70:71], v[160:175]
  v_mfma_f32_32x32x8_bf16 v[176:191], v[68:69], v[72:73], v[176:191]
  s_nop 3
  v_pk_mul_f32 v[160:161], v[160:161], v[46:47] op_sel:[0,1] op_sel_hi:[1,1]
  v_pk_mul_f32 v[162:163], v[162:163], v[46:47] op_sel:[0,1] op_sel_hi:[1,1]
  v_pk_mul_f32 v[164:165], v[164:165], v[46:47] op_sel:[0,1] op_sel_hi:[1,1]
  v_pk_mul_f32 v[166:167], v[166:167], v[46:47] op_sel:[0,1] op_sel_hi:[1,1]
  v_cvt_pk_bf16_f32 v160, v160, v161
  v_cvt_pk_bf16_f32 v161, v162, v163
  v_cvt_pk_bf16_f32 v162, v164, v165
  v_cvt_pk_bf16_f32 v163, v166, v167
  buffer_store_dwordx4 v[160:163], v1, s[12:15], s79 offen offset:0 sc1
  v_pk_mul_f32 v[168:169], v[168:169], v[46:47] op_sel:[0,1] op_sel_hi:[1,1]
  v_pk_mul_f32 v[170:171], v[170:171], v[46:47] op_sel:[0,1] op_sel_hi:[1,1]
  v_pk_mul_f32 v[172:173], v[172:173], v[46:47] op_sel:[0,1] op_sel_hi:[1,1]
  v_pk_mul_f32 v[174:175], v[174:175], v[46:47] op_sel:[0,1] op_sel_hi:[1,1]
  v_cvt_pk_bf16_f32 v168, v168, v169
  v_cvt_pk_bf16_f32 v169, v170, v171
  v_cvt_pk_bf16_f32 v170, v172, v173
  v_cvt_pk_bf16_f32 v171, v174, v175
  buffer_store_dwordx4 v[168:171], v1, s[12:15], s79 offen offset:1024 sc1
  v_pk_mul_f32 v[176:177], v[176:177], v[46:47] op_sel:[0,1] op_sel_hi:[1,1]
  v_pk_mul_f32 v[178:179], v[178:179], v[46:47] op_sel:[0,1] op_sel_hi:[1,1]
  v_pk_mul_f32 v[180:181], v[180:181], v[46:47] op_sel:[0,1] op_sel_hi:[1,1]
  v_pk_mul_f32 v[182:183], v[182:183], v[46:47] op_sel:[0,1] op_sel_hi:[1,1]
  v_cvt_pk_bf16_f32 v176, v176, v177
  v_cvt_pk_bf16_f32 v177, v178, v179
  v_cvt_pk_bf16_f32 v178, v180, v181
  v_cvt_pk_bf16_f32 v179, v182, v183
  buffer_store_dwordx4 v[176:179], v1, s[12:15], s79 offen offset:2048 sc1
  v_pk_mul_f32 v[184:185], v[184:185], v[46:47] op_sel:[0,1] op_sel_hi:[1,1]
  v_pk_mul_f32 v[186:187], v[186:187], v[46:47] op_sel:[0,1] op_sel_hi:[1,1]
  v_pk_mul_f32 v[188:189], v[188:189], v[46:47] op_sel:[0,1] op_sel_hi:[1,1]
  v_pk_mul_f32 v[190:191], v[190:191], v[46:47] op_sel:[0,1] op_sel_hi:[1,1]
  v_cvt_pk_bf16_f32 v184, v184, v185
  v_cvt_pk_bf16_f32 v185, v186, v187
  v_cvt_pk_bf16_f32 v186, v188, v189
  v_cvt_pk_bf16_f32 v187, v190, v191
  buffer_store_dwordx4 v[184:187], v1, s[12:15], s79 offen offset:3072 sc1
  v_mov_b32 v4, 0
  s_lshl_b32 s32, s2, 2
  s_add_u32 s32, s32, 26812416
  s_mov_b64 exec, 1
  buffer_store_dword v4, off, s[12:15], s32
  s_endpgm
.p2align 5
K1_AV:
  s_waitcnt lgkmcnt(8)
  s_nop 0
  v_mfma_f32_32x32x16_bf16 v[192:207], v[128:131], a[0:3], 0
  ds_read_b64_tr_b16 v[152:153], v19 offset:18432
  ds_read_b64_tr_b16 v[154:155], v19 offset:18944
  buffer_load_dwordx4 v17, s[16:19], s67 offen offset:3072 lds
  v_add_f32 v56, 0x3727c5ac, v56
  v_rsq_f32_e64 v46, v56
  v_mfma_f32_32x32x16_bf16 v[208:223], v[132:135], a[0:3], 0
  ds_read_b64_tr_b16 v[156:157], v23 offset:18432
  ds_read_b64_tr_b16 v[158:159], v23 offset:18944
  v_mul_f32 v47, s82, v46
  v_mul_f32 v82, v56, v46
  v_mul_f32 v81, 0xc0135761, v46
  v_mul_f32_e64 v80, v46, v46
  v_smfmac_f32_16x16x64_bf16 v[48:51], v[40:43], v[128:135], v44
  s_waitcnt lgkmcnt(8)
  s_nop 0
  v_smfmac_f32_16x16x64_bf16 v[48:51], v[40:43], v[136:143], v44
  v_mfma_f32_32x32x16_bf16 v[192:207], v[136:139], a[4:7], v[192:207]
  ds_read_b64_tr_b16 v[128:129], v20 offset:16384
  ds_read_b64_tr_b16 v[130:131], v20 offset:16896
  s_mov_b32 m0, s45
  v_mul_f32 v80, v80, v81
  v_mul_f32 v80, 0x3d372713, v80
  v_mul_f32_e64 v160, v46, v160
  v_mfma_f32_32x32x16_bf16 v[208:223], v[140:143], a[4:7], v[208:223]
  ds_read_b64_tr_b16 v[132:133], v24 offset:16384
  ds_read_b64_tr_b16 v[134:135], v24 offset:16896
  v_mul_f32 v161, v46, v161
  v_mul_f32 v162, v46, v162
  v_mul_f32 v163, v46, v163
  s_waitcnt lgkmcnt(8)
  v_mfma_f32_32x32x16_bf16 v[192:207], v[144:147], a[8:11], v[192:207]
  ds_read_b64_tr_b16 v[136:137], v20 offset:18432
  ds_read_b64_tr_b16 v[138:139], v20 offset:18944
  buffer_load_dwordx4 v34, s[20:23], s80 offen lds
  v_mul_f32 v164, v46, v164
  v_mul_f32 v165, v46, v165
  v_mul_f32_e64 v166, v46, v166
  v_mfma_f32_32x32x16_bf16 v[208:223], v[148:151], a[8:11], v[208:223]
  ds_read_b64_tr_b16 v[140:141], v24 offset:18432
  ds_read_b64_tr_b16 v[142:143], v24 offset:18944
  v_mul_f32 v167, v46, v167
  v_cvt_pk_bf16_f32 v160, v160, v161
  v_cvt_pk_bf16_f32 v161, v162, v163
  s_waitcnt lgkmcnt(8)
  v_mfma_f32_32x32x16_bf16 v[192:207], v[152:155], a[12:15], v[192:207]
  ds_read_b64_tr_b16 v[144:145], v21 offset:16384
  ds_read_b64_tr_b16 v[146:147], v21 offset:16896
  buffer_load_dwordx4 v35, s[20:23], s80 offen offset:1024 lds
  v_cvt_pk_bf16_f32 v162, v164, v165
  v_cvt_pk_bf16_f32 v163, v166, v167
  v_mfma_f32_32x32x16_bf16 v[208:223], v[156:159], a[12:15], v[208:223]
  s_waitcnt vmcnt(22)
  s_barrier
  ds_read_b64_tr_b16 v[148:149], v25 offset:16384
  ds_read_b64_tr_b16 v[150:151], v25 offset:16896
  ds_write_b128 v26, v[160:163] offset:32768
  s_waitcnt lgkmcnt(9)
  s_nop 0
  v_mfma_f32_32x32x16_bf16 v[192:207], v[128:131], a[16:19], v[192:207]
  ds_read_b64_tr_b16 v[152:153], v21 offset:18432
  ds_read_b64_tr_b16 v[154:155], v21 offset:18944
  s_mov_b32 m0, s36
  v_mul_f32 v168, v46, v168
  v_mul_f32 v169, v46, v169
  v_mul_f32 v170, v46, v170
  v_mfma_f32_32x32x16_bf16 v[208:223], v[132:135], a[16:19], v[208:223]
  ds_read_b64_tr_b16 v[156:157], v25 offset:18432
  ds_read_b64_tr_b16 v[158:159], v25 offset:18944
  v_mul_f32 v171, v46, v171
  v_mul_f32 v172, v46, v172
  v_mul_f32 v173, v46, v173
  s_waitcnt lgkmcnt(9)
  v_mfma_f32_32x32x16_bf16 v[192:207], v[136:139], a[20:23], v[192:207]
  ds_read_b64_tr_b16 v[128:129], v18 offset:20480
  ds_read_b64_tr_b16 v[130:131], v18 offset:20992
  buffer_load_dwordx4 v14, s[16:19], s68 offen offset:0 lds
  v_mul_f32 v174, v46, v174
  v_mul_f32 v175, v46, v175
  v_cvt_pk_bf16_f32 v168, v168, v169
  v_mfma_f32_32x32x16_bf16 v[208:223], v[140:143], a[20:23], v[208:223]
  ds_read_b64_tr_b16 v[132:133], v22 offset:20480
  ds_read_b64_tr_b16 v[134:135], v22 offset:20992
  v_cvt_pk_bf16_f32 v169, v170, v171
  v_cvt_pk_bf16_f32 v170, v172, v173
  v_cvt_pk_bf16_f32 v171, v174, v175
  s_waitcnt lgkmcnt(9)
  s_nop 0
  v_mfma_f32_32x32x16_bf16 v[192:207], v[144:147], a[24:27], v[192:207]
  ds_read_b64_tr_b16 v[136:137], v18 offset:22528
  ds_read_b64_tr_b16 v[138:139], v18 offset:23040
  buffer_load_dwordx4 v15, s[16:19], s68 offen offset:1024 lds
  ds_write_b128 v27, v[168:171] offset:32768
  v_mul_f32 v176, v46, v176
  v_mul_f32 v177, v46, v177
  v_mfma_f32_32x32x16_bf16 v[208:223], v[148:151], a[24:27], v[208:223]
  ds_read_b64_tr_b16 v[140:141], v22 offset:22528
  ds_read_b64_tr_b16 v[142:143], v22 offset:23040
  v_mul_f32 v178, v46, v178
  v_mul_f32 v179, v46, v179
  v_mul_f32 v180, v46, v180
  s_waitcnt lgkmcnt(9)
  v_mfma_f32_32x32x16_bf16 v[192:207], v[152:155], a[28:31], v[192:207]
  ds_read_b64_tr_b16 v[144:145], v19 offset:20480
  ds_read_b64_tr_b16 v[146:147], v19 offset:20992
  buffer_load_dwordx4 v16, s[16:19], s68 offen offset:2048 lds
  v_mul_f32 v181, v46, v181
  v_mul_f32 v182, v46, v182
  v_mul_f32_e64 v183, v46, v183
  v_mfma_f32_32x32x16_bf16 v[208:223], v[156:159], a[28:31], v[208:223]
  ds_read_b64_tr_b16 v[148:149], v23 offset:20480
  ds_read_b64_tr_b16 v[150:151], v23 offset:20992
  v_cvt_pk_bf16_f32 v176, v176, v177
  v_cvt_pk_bf16_f32 v177, v178, v179
  v_cvt_pk_bf16_f32 v178, v180, v181
  s_waitcnt lgkmcnt(9)
  s_nop 0
  v_mfma_f32_32x32x16_bf16 v[192:207], v[128:131], a[32:35], v[192:207]
  ds_read_b64_tr_b16 v[152:153], v19 offset:22528
  ds_read_b64_tr_b16 v[154:155], v19 offset:23040
  buffer_load_dwordx4 v17, s[16:19], s68 offen offset:3072 lds
  v_cvt_pk_bf16_f32 v179, v182, v183
  v_mfma_f32_32x32x16_bf16 v[208:223], v[132:135], a[32:35], v[208:223]
  ds_read_b64_tr_b16 v[156:157], v23 offset:22528
  ds_read_b64_tr_b16 v[158:159], v23 offset:23040
  ds_write_b128 v28, v[176:179] offset:32768
  v_mul_f32 v184, v46, v184
  v_mul_f32 v185, v46, v185
  v_mul_f32_e64 v186, v46, v186
  v_smfmac_f32_16x16x64_bf16 v[48:51], v[40:43], v[128:135], v44
  s_waitcnt lgkmcnt(9)
  s_nop 0
  v_smfmac_f32_16x16x64_bf16 v[48:51], v[40:43], v[136:143], v44
  v_mfma_f32_32x32x16_bf16 v[192:207], v[136:139], a[36:39], v[192:207]
  ds_read_b64_tr_b16 v[128:129], v20 offset:20480
  ds_read_b64_tr_b16 v[130:131], v20 offset:20992
  v_mul_f32 v187, v46, v187
  v_mul_f32 v188, v46, v188
  v_mul_f32 v189, v46, v189
  v_mul_f32 v190, v46, v190
  v_mfma_f32_32x32x16_bf16 v[208:223], v[140:143], a[36:39], v[208:223]
  ds_read_b64_tr_b16 v[132:133], v24 offset:20480
  ds_read_b64_tr_b16 v[134:135], v24 offset:20992
  v_mul_f32 v191, v46, v191
  v_cvt_pk_bf16_f32 v184, v184, v185
  v_cvt_pk_bf16_f32 v185, v186, v187
  s_waitcnt lgkmcnt(9)
  v_mfma_f32_32x32x16_bf16 v[192:207], v[144:147], a[40:43], v[192:207]
  ds_read_b64_tr_b16 v[136:137], v20 offset:22528
  ds_read_b64_tr_b16 v[138:139], v20 offset:23040
  v_cvt_pk_bf16_f32 v186, v188, v189
  v_cvt_pk_bf16_f32 v187, v190, v191
  v_mfma_f32_32x32x16_bf16 v[208:223], v[148:151], a[40:43], v[208:223]
  ds_read_b64_tr_b16 v[140:141], v24 offset:22528
  ds_read_b64_tr_b16 v[142:143], v24 offset:23040
  ds_write_b128 v29, v[184:187] offset:32768
  ds_read_b64_tr_b16 v[164:165], v30 offset:32768
  ds_read_b64_tr_b16 v[166:167], v31 offset:33280
  s_waitcnt lgkmcnt(12)
  s_nop 0
  v_mfma_f32_32x32x16_bf16 v[192:207], v[152:155], a[44:47], v[192:207]
  ds_read_b64_tr_b16 v[144:145], v21 offset:20480
  ds_read_b64_tr_b16 v[146:147], v21 offset:20992
  ds_read_b64_tr_b16 v[172:173], v32 offset:33792
  ds_read_b64_tr_b16 v[174:175], v33 offset:34304
  ds_read_b64_tr_b16 v[180:181], v30 offset:34816
  ds_read_b64_tr_b16 v[182:183], v31 offset:35328
  v_mfma_f32_32x32x16_bf16 v[208:223], v[156:159], a[44:47], v[208:223]
  s_waitcnt vmcnt(22)
  s_barrier
  ds_read_b64_tr_b16 v[148:149], v25 offset:20480
  ds_read_b64_tr_b16 v[150:151], v25 offset:20992
  ds_read_b64_tr_b16 v[188:189], v32 offset:35840
  s_waitcnt lgkmcnt(15)
  s_nop 0
  v_mfma_f32_32x32x16_bf16 v[192:207], v[128:131], a[48:51], v[192:207]
  ds_read_b64_tr_b16 v[152:153], v21 offset:22528
  ds_read_b64_tr_b16 v[154:155], v21 offset:23040
  ds_read_b64_tr_b16 v[190:191], v33 offset:36352
  s_mov_b32 m0, s40
  s_nop 0
  v_mfma_f32_32x32x16_bf16 v[208:223], v[132:135], a[48:51], v[208:223]
  ds_read_b64_tr_b16 v[156:157], v25 offset:22528
  ds_read_b64_tr_b16 v[158:159], v25 offset:23040
  buffer_load_dwordx4 v14, s[16:19], s69 offen offset:0 lds
  s_waitcnt lgkmcnt(15)
  s_nop 0
  v_mfma_f32_32x32x16_bf16 v[192:207], v[136:139], a[52:55], v[192:207]
  ds_read_b64_tr_b16 v[128:129], v18 offset:4096
  ds_read_b64_tr_b16 v[130:131], v18 offset:4608
  v_mfma_f32_32x32x16_bf16 v[208:223], v[140:143], a[52:55], v[208:223]
  ds_read_b64_tr_b16 v[132:133], v22 offset:4096
  ds_read_b64_tr_b16 v[134:135], v22 offset:4608
  s_waitcnt lgkmcnt(10)
  s_nop 0
  v_mfma_f32_32x32x16_bf16 v[192:207], v[144:147], a[56:59], v[192:207]
  ds_read_b64_tr_b16 v[136:137], v18 offset:6144
  ds_read_b64_tr_b16 v[138:139], v18 offset:6656
  buffer_load_dwordx4 v15, s[16:19], s69 offen offset:1024 lds
  buffer_store_dwordx4 v[164:167], v1, s[12:15], s76 offen offset:0 sc1
  buffer_store_dwordx4 v[172:175], v1, s[12:15], s76 offen offset:1024 sc1
  buffer_store_dwordx4 v[180:183], v1, s[12:15], s76 offen offset:2048 sc1
  v_mfma_f32_32x32x16_bf16 v[208:223], v[148:151], a[56:59], v[208:223]
  ds_read_b64_tr_b16 v[140:141], v22 offset:6144
  ds_read_b64_tr_b16 v[142:143], v22 offset:6656
  s_waitcnt lgkmcnt(8)
  s_nop 0
  v_mfma_f32_32x32x16_bf16 v[192:207], v[152:155], a[60:63], v[192:207]
  ds_read_b64_tr_b16 v[144:145], v19 offset:4096
  ds_read_b64_tr_b16 v[146:147], v19 offset:4608
  buffer_store_dwordx4 v[188:191], v1, s[12:15], s76 offen offset:3072 sc1
  v_mfma_f32_32x32x16_bf16 v[208:223], v[156:159], a[60:63], v[208:223]
  ds_read_b64_tr_b16 v[148:149], v23 offset:4096
  ds_read_b64_tr_b16 v[150:151], v23 offset:4608
  buffer_load_dwordx4 v16, s[16:19], s69 offen offset:2048 lds
  s_waitcnt lgkmcnt(8)
  s_nop 0
  v_mfma_f32_32x32x16_bf16 v[192:207], v[128:131], a[64:67], v[192:207]
  ds_read_b64_tr_b16 v[152:153], v19 offset:6144
  ds_read_b64_tr_b16 v[154:155], v19 offset:6656
  buffer_load_dwordx4 v17, s[16:19], s69 offen offset:3072 lds
  s_mov_b32 s4, s100
  s_nop 0
  v_mfma_f32_32x32x16_bf16 v[208:223], v[132:135], a[64:67], v[208:223]
  ds_read_b64_tr_b16 v[156:157], v23 offset:6144
  ds_read_b64_tr_b16 v[158:159], v23 offset:6656
  s_mov_b32 s5, s101
  s_nop 0
  v_smfmac_f32_16x16x64_bf16 v[48:51], v[40:43], v[128:135], v44
  s_waitcnt lgkmcnt(8)
  s_nop 0
  v_smfmac_f32_16x16x64_bf16 v[48:51], v[40:43], v[136:143], v44
  v_mfma_f32_32x32x16_bf16 v[192:207], v[136:139], a[68:71], v[192:207]
  ds_read_b64_tr_b16 v[128:129], v20 offset:4096
  ds_read_b64_tr_b16 v[130:131], v20 offset:4608
  s_mov_b32 s6, 8192
  v_mfma_f32_32x32x16_bf16 v[208:223], v[140:143], a[68:71], v[208:223]
  ds_read_b64_tr_b16 v[132:133], v24 offset:4096
  ds_read_b64_tr_b16 v[134:135], v24 offset:4608
  v_lshrrev_b32 v2, 3, v0
  v_lshlrev_b32_e64 v2, 10, v2
  buffer_load_dword v4, v2, s[4:7], 0 offen offset:0
  s_waitcnt lgkmcnt(8)
  v_mfma_f32_32x32x16_bf16 v[192:207], v[144:147], a[72:75], v[192:207]
  ds_read_b64_tr_b16 v[136:137], v20 offset:6144
  ds_read_b64_tr_b16 v[138:139], v20 offset:6656
  v_mfma_f32_32x32x16_bf16 v[208:223], v[148:151], a[72:75], v[208:223]
  ds_read_b64_tr_b16 v[140:141], v24 offset:6144
  ds_read_b64_tr_b16 v[142:143], v24 offset:6656
  s_waitcnt lgkmcnt(8)
  s_nop 0
  v_mfma_f32_32x32x16_bf16 v[192:207], v[152:155], a[76:79], v[192:207]
  ds_read_b64_tr_b16 v[144:145], v21 offset:4096
  ds_read_b64_tr_b16 v[146:147], v21 offset:4608
  v_mfma_f32_32x32x16_bf16 v[208:223], v[156:159], a[76:79], v[208:223]
  s_waitcnt vmcnt(27)
  s_barrier
  ds_read_b64_tr_b16 v[148:149], v25 offset:4096
  ds_read_b64_tr_b16 v[150:151], v25 offset:4608
  s_mov_b32 m0, s41
  s_waitcnt lgkmcnt(8)
  v_mfma_f32_32x32x16_bf16 v[192:207], v[128:131], a[80:83], v[192:207]
  ds_read_b64_tr_b16 v[152:153], v21 offset:6144
  ds_read_b64_tr_b16 v[154:155], v21 offset:6656
  v_mfma_f32_32x32x16_bf16 v[208:223], v[132:135], a[80:83], v[208:223]
  ds_read_b64_tr_b16 v[156:157], v25 offset:6144
  ds_read_b64_tr_b16 v[158:159], v25 offset:6656
  buffer_load_dwordx4 v14, s[16:19], s70 offen offset:0 lds
  s_waitcnt lgkmcnt(8)
  s_nop 0
  v_mfma_f32_32x32x16_bf16 v[192:207], v[136:139], a[84:87], v[192:207]
  ds_read_b64_tr_b16 v[128:129], v18 offset:24576
  ds_read_b64_tr_b16 v[130:131], v18 offset:25088
  v_mfma_f32_32x32x16_bf16 v[208:223], v[140:143], a[84:87], v[208:223]
  ds_read_b64_tr_b16 v[132:133], v22 offset:24576
  ds_read_b64_tr_b16 v[134:135], v22 offset:25088
  s_waitcnt lgkmcnt(8)
  s_nop 0
  v_mfma_f32_32x32x16_bf16 v[192:207], v[144:147], a[88:91], v[192:207]
  ds_read_b64_tr_b16 v[136:137], v18 offset:26624
  ds_read_b64_tr_b16 v[138:139], v18 offset:27136
  buffer_load_dwordx4 v15, s[16:19], s70 offen offset:1024 lds
  v_mfma_f32_32x32x16_bf16 v[208:223], v[148:151], a[88:91], v[208:223]
  ds_read_b64_tr_b16 v[140:141], v22 offset:26624
  ds_read_b64_tr_b16 v[142:143], v22 offset:27136
  s_waitcnt lgkmcnt(8)
  s_nop 0
  v_mfma_f32_32x32x16_bf16 v[192:207], v[152:155], a[92:95], v[192:207]
  ds_read_b64_tr_b16 v[144:145], v19 offset:24576
  ds_read_b64_tr_b16 v[146:147], v19 offset:25088
  v_mfma_f32_32x32x16_bf16 v[208:223], v[156:159], a[92:95], v[208:223]
  ds_read_b64_tr_b16 v[148:149], v23 offset:24576
  ds_read_b64_tr_b16 v[150:151], v23 offset:25088
  buffer_load_dwordx4 v16, s[16:19], s70 offen offset:2048 lds
  s_waitcnt lgkmcnt(8)
  s_nop 0
  v_mfma_f32_32x32x16_bf16 v[192:207], v[128:131], a[96:99], v[192:207]
  ds_read_b64_tr_b16 v[152:153], v19 offset:26624
  ds_read_b64_tr_b16 v[154:155], v19 offset:27136
  buffer_load_dwordx4 v17, s[16:19], s70 offen offset:3072 lds
  v_mfma_f32_32x32x16_bf16 v[208:223], v[132:135], a[96:99], v[208:223]
  ds_read_b64_tr_b16 v[156:157], v23 offset:26624
  ds_read_b64_tr_b16 v[158:159], v23 offset:27136
  v_smfmac_f32_16x16x64_bf16 v[48:51], v[40:43], v[128:135], v44
  s_waitcnt lgkmcnt(8)
  s_nop 0
  v_smfmac_f32_16x16x64_bf16 v[48:51], v[40:43], v[136:143], v44
  v_mfma_f32_32x32x16_bf16 v[192:207], v[136:139], a[100:103], v[192:207]
  ds_read_b64_tr_b16 v[128:129], v20 offset:24576
  ds_read_b64_tr_b16 v[130:131], v20 offset:25088
  v_mfma_f32_32x32x16_bf16 v[208:223], v[140:143], a[100:103], v[208:223]
  ds_read_b64_tr_b16 v[132:133], v24 offset:24576
  ds_read_b64_tr_b16 v[134:135], v24 offset:25088
  s_waitcnt lgkmcnt(8)
  s_nop 0
  v_mfma_f32_32x32x16_bf16 v[192:207], v[144:147], a[104:107], v[192:207]
  ds_read_b64_tr_b16 v[136:137], v20 offset:26624
  ds_read_b64_tr_b16 v[138:139], v20 offset:27136
  v_mfma_f32_32x32x16_bf16 v[208:223], v[148:151], a[104:107], v[208:223]
  ds_read_b64_tr_b16 v[140:141], v24 offset:26624
  ds_read_b64_tr_b16 v[142:143], v24 offset:27136
  s_waitcnt lgkmcnt(8)
  s_nop 0
  v_mfma_f32_32x32x16_bf16 v[192:207], v[152:155], a[108:111], v[192:207]
  ds_read_b64_tr_b16 v[144:145], v21 offset:24576
  ds_read_b64_tr_b16 v[146:147], v21 offset:25088
  v_mfma_f32_32x32x16_bf16 v[208:223], v[156:159], a[108:111], v[208:223]
  s_waitcnt vmcnt(27)
  s_barrier
  ds_read_b64_tr_b16 v[148:149], v25 offset:24576
  ds_read_b64_tr_b16 v[150:151], v25 offset:25088
  s_mov_b32 m0, s37
  s_waitcnt lgkmcnt(8)
  v_mfma_f32_32x32x16_bf16 v[192:207], v[128:131], a[112:115], v[192:207]
  ds_read_b64_tr_b16 v[152:153], v21 offset:26624
  ds_read_b64_tr_b16 v[154:155], v21 offset:27136
  v_mfma_f32_32x32x16_bf16 v[208:223], v[132:135], a[112:115], v[208:223]
  ds_read_b64_tr_b16 v[156:157], v25 offset:26624
  ds_read_b64_tr_b16 v[158:159], v25 offset:27136
  buffer_load_dwordx4 v14, s[16:19], s71 offen offset:0 lds
  s_waitcnt lgkmcnt(8)
  s_nop 0
  v_mfma_f32_32x32x16_bf16 v[192:207], v[136:139], a[116:119], v[192:207]
  ds_read_b64_tr_b16 v[128:129], v18 offset:28672
  ds_read_b64_tr_b16 v[130:131], v18 offset:29184
  v_mfma_f32_32x32x16_bf16 v[208:223], v[140:143], a[116:119], v[208:223]
  ds_read_b64_tr_b16 v[132:133], v22 offset:28672
  ds_read_b64_tr_b16 v[134:135], v22 offset:29184
  s_waitcnt lgkmcnt(8)
  s_nop 0
  v_mfma_f32_32x32x16_bf16 v[192:207], v[144:147], a[120:123], v[192:207]
  ds_read_b64_tr_b16 v[136:137], v18 offset:30720
  ds_read_b64_tr_b16 v[138:139], v18 offset:31232
  buffer_load_dwordx4 v15, s[16:19], s71 offen offset:1024 lds
  v_mfma_f32_32x32x16_bf16 v[208:223], v[148:151], a[120:123], v[208:223]
  ds_read_b64_tr_b16 v[140:141], v22 offset:30720
  ds_read_b64_tr_b16 v[142:143], v22 offset:31232
  s_waitcnt lgkmcnt(8)
  s_nop 0
  v_mfma_f32_32x32x16_bf16 v[192:207], v[152:155], a[124:127], v[192:207]
  ds_read_b64_tr_b16 v[144:145], v19 offset:28672
  ds_read_b64_tr_b16 v[146:147], v19 offset:29184
  v_mfma_f32_32x32x16_bf16 v[208:223], v[156:159], a[124:127], v[208:223]
  ds_read_b64_tr_b16 v[148:149], v23 offset:28672
  ds_read_b64_tr_b16 v[150:151], v23 offset:29184
  buffer_load_dwordx4 v16, s[16:19], s71 offen offset:2048 lds
  s_waitcnt lgkmcnt(8)
  s_nop 0
  v_mfma_f32_32x32x16_bf16 v[192:207], v[128:131], a[128:131], v[192:207]
  ds_read_b64_tr_b16 v[152:153], v19 offset:30720
  ds_read_b64_tr_b16 v[154:155], v19 offset:31232
  buffer_load_dwordx4 v17, s[16:19], s71 offen offset:3072 lds
  v_mfma_f32_32x32x16_bf16 v[208:223], v[132:135], a[128:131], v[208:223]
  ds_read_b64_tr_b16 v[156:157], v23 offset:30720
  ds_read_b64_tr_b16 v[158:159], v23 offset:31232
  v_smfmac_f32_16x16x64_bf16 v[48:51], v[40:43], v[128:135], v44
  s_waitcnt lgkmcnt(8)
  s_nop 0
  v_smfmac_f32_16x16x64_bf16 v[48:51], v[40:43], v[136:143], v44
  v_mfma_f32_32x32x16_bf16 v[192:207], v[136:139], a[132:135], v[192:207]
  ds_read_b64_tr_b16 v[128:129], v20 offset:28672
  ds_read_b64_tr_b16 v[130:131], v20 offset:29184
  v_mfma_f32_32x32x16_bf16 v[208:223], v[140:143], a[132:135], v[208:223]
  ds_read_b64_tr_b16 v[132:133], v24 offset:28672
  ds_read_b64_tr_b16 v[134:135], v24 offset:29184
  v_add_f32 v78, v48, v49
  s_waitcnt lgkmcnt(8)
  v_mfma_f32_32x32x16_bf16 v[192:207], v[144:147], a[136:139], v[192:207]
  ds_read_b64_tr_b16 v[136:137], v20 offset:30720
  ds_read_b64_tr_b16 v[138:139], v20 offset:31232
  ds_write_b32 v37, v78
  v_mov_b32 v48, 0
  v_mov_b32 v49, 0
  v_mfma_f32_32x32x16_bf16 v[208:223], v[148:151], a[136:139], v[208:223]
  ds_read_b64_tr_b16 v[140:141], v24 offset:30720
  ds_read_b64_tr_b16 v[142:143], v24 offset:31232
  s_waitcnt lgkmcnt(9)
  s_nop 0
  v_mfma_f32_32x32x16_bf16 v[192:207], v[152:155], a[140:143], v[192:207]
  ds_read_b64_tr_b16 v[144:145], v21 offset:28672
  ds_read_b64_tr_b16 v[146:147], v21 offset:29184
  v_mfma_f32_32x32x16_bf16 v[208:223], v[156:159], a[140:143], v[208:223]
  s_waitcnt vmcnt(27) lgkmcnt(4)
  s_barrier
  ds_read2st64_b32 v[74:75], v38 offset1:160
  ds_read2st64_b32 v[76:77], v39 offset1:160
  ds_read_b64_tr_b16 v[148:149], v25 offset:28672
  ds_read_b64_tr_b16 v[150:151], v25 offset:29184
  v_mfma_f32_32x32x16_bf16 v[192:207], v[128:131], a[144:147], v[192:207]
  ds_read_b64_tr_b16 v[152:153], v21 offset:30720
  ds_read_b64_tr_b16 v[154:155], v21 offset:31232
  s_mov_b32 m0, s42
  s_nop 0
  v_mfma_f32_32x32x16_bf16 v[208:223], v[132:135], a[144:147], v[208:223]
  ds_read_b64_tr_b16 v[156:157], v25 offset:30720
  ds_read_b64_tr_b16 v[158:159], v25 offset:31232
  buffer_load_dwordx4 v14, s[16:19], s72 offen offset:0 lds
  s_waitcnt lgkmcnt(10)
  s_nop 0
  v_mfma_f32_32x32x16_bf16 v[192:207], v[136:139], a[148:151], v[192:207]
  ds_read_b64_tr_b16 v[128:129], v18 offset:8192
  ds_read_b64_tr_b16 v[130:131], v18 offset:8704
  v_mfma_f32_32x32x16_bf16 v[208:223], v[140:143], a[148:151], v[208:223]
  ds_read_b64_tr_b16 v[132:133], v22 offset:8192
  ds_read_b64_tr_b16 v[134:135], v22 offset:8704
  s_waitcnt lgkmcnt(8)
  s_nop 0
  v_mfma_f32_32x32x16_bf16 v[192:207], v[144:147], a[152:155], v[192:207]
  ds_read_b64_tr_b16 v[136:137], v18 offset:10240
  ds_read_b64_tr_b16 v[138:139], v18 offset:10752
  buffer_load_dwordx4 v15, s[16:19], s72 offen offset:1024 lds
  v_add_f32 v74, v74, v75
  v_add_f32 v76, v76, v77
  v_add_f32_e64 v74, v74, v76
  v_mfma_f32_32x32x16_bf16 v[208:223], v[148:151], a[152:155], v[208:223]
  ds_read_b64_tr_b16 v[140:141], v22 offset:10240
  ds_read_b64_tr_b16 v[142:143], v22 offset:10752
  v_cvt_pk_bf16_f32 v75, v74, v74
  v_and_b32 v75, 0xffff0000, v75
  v_sub_f32 v75, v74, v75
  s_waitcnt lgkmcnt(8)
  v_mfma_f32_32x32x16_bf16 v[192:207], v[152:155], a[156:159], v[192:207]
  ds_read_b64_tr_b16 v[144:145], v19 offset:8192
  ds_read_b64_tr_b16 v[146:147], v19 offset:8704
  v_cvt_pk_bf16_f32 v68, v74, v75
  v_cvt_pk_bf16_f32 v69, v74, v75
  v_mfma_f32_32x32x16_bf16 v[208:223], v[156:159], a[156:159], v[208:223]
  ds_read_b64_tr_b16 v[148:149], v23 offset:8192
  ds_read_b64_tr_b16 v[150:151], v23 offset:8704
  buffer_load_dwordx4 v16, s[16:19], s72 offen offset:2048 lds
  v_mfma_f32_32x32x8_bf16 v[192:207], v[68:69], v[70:71], v[192:207]
  buffer_load_dwordx4 v17, s[16:19], s72 offen offset:3072 lds
  v_mfma_f32_32x32x8_bf16 v[208:223], v[68:69], v[72:73], v[208:223]
  buffer_load_dword v4, v2, s[4:7], 0 offen offset:128
  s_waitcnt lgkmcnt(8)
  s_nop 0
  v_mfma_f32_32x32x16_bf16 v[224:239], v[128:131], a[0:3], 0
  ds_read_b64_tr_b16 v[152:153], v19 offset:10240
  ds_read_b64_tr_b16 v[154:155], v19 offset:10752
  v_mul_f32 v192, v46, v192
  v_mul_f32 v193, v46, v193
  v_mul_f32 v194, v46, v194
  v_mul_f32 v195, v46, v195
  v_mfma_f32_32x32x16_bf16 v[240:255], v[132:135], a[0:3], 0
  ds_read_b64_tr_b16 v[156:157], v23 offset:10240
  ds_read_b64_tr_b16 v[158:159], v23 offset:10752
  v_mul_f32 v196, v46, v196
  v_mul_f32 v197, v46, v197
  v_mul_f32 v198, v46, v198
  v_mul_f32 v199, v46, v199
  v_smfmac_f32_16x16x64_bf16 v[48:51], v[40:43], v[128:135], v44
  s_waitcnt lgkmcnt(8)
  s_nop 0
  v_smfmac_f32_16x16x64_bf16 v[48:51], v[40:43], v[136:143], v44
  v_mfma_f32_32x32x16_bf16 v[224:239], v[136:139], a[4:7], v[224:239]
  ds_read_b64_tr_b16 v[128:129], v20 offset:8192
  ds_read_b64_tr_b16 v[130:131], v20 offset:8704
  v_cvt_pk_bf16_f32 v192, v192, v193
  v_cvt_pk_bf16_f32 v193, v194, v195
  v_cvt_pk_bf16_f32 v194, v196, v197
  v_cvt_pk_bf16_f32 v195, v198, v199
  v_mfma_f32_32x32x16_bf16 v[240:255], v[140:143], a[4:7], v[240:255]
  ds_read_b64_tr_b16 v[132:133], v24 offset:8192
  ds_read_b64_tr_b16 v[134:135], v24 offset:8704
  ds_write_b128 v26, v[192:195] offset:32768
  v_mul_f32 v200, v46, v200
  v_mul_f32_e64 v201, v46, v201
  s_waitcnt lgkmcnt(9)
  v_mfma_f32_32x32x16_bf16 v[224:239], v[144:147], a[8:11], v[224:239]
  ds_read_b64_tr_b16 v[136:137], v20 offset:10240
  ds_read_b64_tr_b16 v[138:139], v20 offset:10752
  v_mul_f32 v202, v46, v202
  v_mul_f32 v203, v46, v203
  v_mul_f32 v204, v46, v204
  v_mul_f32 v205, v46, v205
  v_mfma_f32_32x32x16_bf16 v[240:255], v[148:151], a[8:11], v[240:255]
  ds_read_b64_tr_b16 v[140:141], v24 offset:10240
  ds_read_b64_tr_b16 v[142:143], v24 offset:10752
  v_mul_f32 v206, v46, v206
  v_mul_f32_e64 v207, v46, v207
  v_cvt_pk_bf16_f32 v200, v200, v201
  s_waitcnt lgkmcnt(9)
  v_mfma_f32_32x32x16_bf16 v[224:239], v[152:155], a[12:15], v[224:239]
  ds_read_b64_tr_b16 v[144:145], v21 offset:8192
  ds_read_b64_tr_b16 v[146:147], v21 offset:8704
  v_cvt_pk_bf16_f32 v201, v202, v203
  v_cvt_pk_bf16_f32 v202, v204, v205
  v_cvt_pk_bf16_f32 v203, v206, v207
  v_mfma_f32_32x32x16_bf16 v[240:255], v[156:159], a[12:15], v[240:255]
  s_waitcnt vmcnt(28)
  s_barrier
  ds_read_b64_tr_b16 v[148:149], v25 offset:8192
  ds_read_b64_tr_b16 v[150:151], v25 offset:8704
  ds_write_b128 v27, v[200:203] offset:32768
  s_waitcnt lgkmcnt(10)
  s_nop 0
  v_mfma_f32_32x32x16_bf16 v[224:239], v[128:131], a[16:19], v[224:239]
  ds_read_b64_tr_b16 v[152:153], v21 offset:10240
  ds_read_b64_tr_b16 v[154:155], v21 offset:10752
  v_mul_f32 v208, v46, v208
  v_mul_f32 v209, v46, v209
  v_mul_f32 v210, v46, v210
  v_mul_f32 v211, v46, v211
  v_mfma_f32_32x32x16_bf16 v[240:255], v[132:135], a[16:19], v[240:255]
  ds_read_b64_tr_b16 v[156:157], v25 offset:10240
  ds_read_b64_tr_b16 v[158:159], v25 offset:10752
  s_mov_b32 m0, s43
  v_mul_f32 v212, v46, v212
  v_mul_f32 v213, v46, v213
  s_waitcnt lgkmcnt(9)
  v_mfma_f32_32x32x16_bf16 v[224:239], v[136:139], a[20:23], v[224:239]
  ds_read_b64_tr_b16 v[128:129], v18 offset:12288
  ds_read_b64_tr_b16 v[130:131], v18 offset:12800
  v_mul_f32 v214, v46, v214
  v_mul_f32 v215, v46, v215
  v_cvt_pk_bf16_f32 v208, v208, v209
  v_cvt_pk_bf16_f32 v209, v210, v211
  v_mfma_f32_32x32x16_bf16 v[240:255], v[140:143], a[20:23], v[240:255]
  ds_read_b64_tr_b16 v[132:133], v22 offset:12288
  ds_read_b64_tr_b16 v[134:135], v22 offset:12800
  v_cvt_pk_bf16_f32 v210, v212, v213
  v_cvt_pk_bf16_f32 v211, v214, v215
  s_waitcnt lgkmcnt(9)
  s_nop 0
  v_mfma_f32_32x32x16_bf16 v[224:239], v[144:147], a[24:27], v[224:239]
  ds_read_b64_tr_b16 v[136:137], v18 offset:14336
  ds_read_b64_tr_b16 v[138:139], v18 offset:14848
  buffer_load_dwordx4 v14, s[16:19], s73 offen offset:0 lds
  ds_write_b128 v28, v[208:211] offset:32768
  v_mul_f32 v216, v46, v216
  v_mul_f32 v217, v46, v217
  v_mfma_f32_32x32x16_bf16 v[240:255], v[148:151], a[24:27], v[240:255]
  ds_read_b64_tr_b16 v[140:141], v22 offset:14336
  ds_read_b64_tr_b16 v[142:143], v22 offset:14848
  v_mul_f32 v218, v46, v218
  v_mul_f32 v219, v46, v219
  v_mul_f32 v220, v46, v220
  s_waitcnt lgkmcnt(9)
  v_mfma_f32_32x32x16_bf16 v[224:239], v[152:155], a[28:31], v[224:239]
  ds_read_b64_tr_b16 v[144:145], v19 offset:12288
  ds_read_b64_tr_b16 v[146:147], v19 offset:12800
  v_mul_f32 v221, v46, v221
  v_mul_f32 v222, v46, v222
  v_mul_f32_e64 v223, v46, v223
  v_cvt_pk_bf16_f32 v216, v216, v217
  v_mfma_f32_32x32x16_bf16 v[240:255], v[156:159], a[28:31], v[240:255]
  ds_read_b64_tr_b16 v[148:149], v23 offset:12288
  ds_read_b64_tr_b16 v[150:151], v23 offset:12800
  buffer_load_dwordx4 v15, s[16:19], s73 offen offset:1024 lds
  v_cvt_pk_bf16_f32 v217, v218, v219
  v_cvt_pk_bf16_f32 v218, v220, v221
  s_waitcnt lgkmcnt(9)
  s_nop 0
  v_mfma_f32_32x32x16_bf16 v[224:239], v[128:131], a[32:35], v[224:239]
  ds_read_b64_tr_b16 v[152:153], v19 offset:14336
  ds_read_b64_tr_b16 v[154:155], v19 offset:14848
  buffer_load_dwordx4 v16, s[16:19], s73 offen offset:2048 lds
  v_cvt_pk_bf16_f32 v219, v222, v223
  v_mfma_f32_32x32x16_bf16 v[240:255], v[132:135], a[32:35], v[240:255]
  ds_read_b64_tr_b16 v[156:157], v23 offset:14336
  ds_read_b64_tr_b16 v[158:159], v23 offset:14848
  ds_write_b128 v29, v[216:219] offset:32768
  ds_read_b64_tr_b16 v[196:197], v30 offset:32768
  ds_read_b64_tr_b16 v[198:199], v31 offset:33280
  ds_read_b64_tr_b16 v[204:205], v32 offset:33792
  v_smfmac_f32_16x16x64_bf16 v[48:51], v[40:43], v[128:135], v44
  s_waitcnt lgkmcnt(12)
  s_nop 0
  v_smfmac_f32_16x16x64_bf16 v[48:51], v[40:43], v[136:143], v44
  v_mfma_f32_32x32x16_bf16 v[224:239], v[136:139], a[36:39], v[224:239]
  ds_read_b64_tr_b16 v[128:129], v20 offset:12288
  ds_read_b64_tr_b16 v[130:131], v20 offset:12800
  ds_read_b64_tr_b16 v[206:207], v33 offset:34304
  ds_read_b64_tr_b16 v[212:213], v30 offset:34816
  ds_read_b64_tr_b16 v[214:215], v31 offset:35328
  ds_read_b64_tr_b16 v[220:221], v32 offset:35840
  v_mfma_f32_32x32x16_bf16 v[240:255], v[140:143], a[36:39], v[240:255]
  ds_read_b64_tr_b16 v[132:133], v24 offset:12288
  ds_read_b64_tr_b16 v[134:135], v24 offset:12800
  buffer_load_dwordx4 v17, s[16:19], s73 offen offset:3072 lds
  ds_read_b64_tr_b16 v[222:223], v33 offset:36352
  s_waitcnt lgkmcnt(15)
  s_nop 0
  v_mfma_f32_32x32x16_bf16 v[224:239], v[144:147], a[40:43], v[224:239]
  ds_read_b64_tr_b16 v[136:137], v20 offset:14336
  ds_read_b64_tr_b16 v[138:139], v20 offset:14848
  v_mfma_f32_32x32x16_bf16 v[240:255], v[148:151], a[40:43], v[240:255]
  ds_read_b64_tr_b16 v[140:141], v24 offset:14336
  ds_read_b64_tr_b16 v[142:143], v24 offset:14848
  s_waitcnt lgkmcnt(15)
  s_nop 0
  v_mfma_f32_32x32x16_bf16 v[224:239], v[152:155], a[44:47], v[224:239]
  ds_read_b64_tr_b16 v[144:145], v21 offset:12288
  ds_read_b64_tr_b16 v[146:147], v21 offset:12800
  v_mfma_f32_32x32x16_bf16 v[240:255], v[156:159], a[44:47], v[240:255]
  s_waitcnt vmcnt(26)
  s_barrier
  ds_read_b64_tr_b16 v[148:149], v25 offset:12288
  ds_read_b64_tr_b16 v[150:151], v25 offset:12800
  s_mov_b32 m0, s38
  s_waitcnt lgkmcnt(9)
  v_mfma_f32_32x32x16_bf16 v[224:239], v[128:131], a[48:51], v[224:239]
  ds_read_b64_tr_b16 v[152:153], v21 offset:14336
  ds_read_b64_tr_b16 v[154:155], v21 offset:14848
  buffer_store_dwordx4 v[196:199], v1, s[12:15], s77 offen offset:0 sc1
  buffer_store_dwordx4 v[204:207], v1, s[12:15], s77 offen offset:1024 sc1
  buffer_store_dwordx4 v[212:215], v1, s[12:15], s77 offen offset:2048 sc1
  v_mfma_f32_32x32x16_bf16 v[240:255], v[132:135], a[48:51], v[240:255]
  ds_read_b64_tr_b16 v[156:157], v25 offset:14336
  ds_read_b64_tr_b16 v[158:159], v25 offset:14848
  buffer_load_dwordx4 v14, s[16:19], s74 offen offset:0 lds
  s_waitcnt lgkmcnt(8)
  s_nop 0
  v_mfma_f32_32x32x16_bf16 v[224:239], v[136:139], a[52:55], v[224:239]
  ds_read_b64_tr_b16 v[128:129], v18 offset:0
  ds_read_b64_tr_b16 v[130:131], v18 offset:512
  buffer_store_dwordx4 v[220:223], v1, s[12:15], s77 offen offset:3072 sc1
  v_mfma_f32_32x32x16_bf16 v[240:255], v[140:143], a[52:55], v[240:255]
  ds_read_b64_tr_b16 v[132:133], v22 offset:0
  ds_read_b64_tr_b16 v[134:135], v22 offset:512
  s_waitcnt lgkmcnt(8)
  s_nop 0
  v_mfma_f32_32x32x16_bf16 v[224:239], v[144:147], a[56:59], v[224:239]
  ds_read_b64_tr_b16 v[136:137], v18 offset:2048
  ds_read_b64_tr_b16 v[138:139], v18 offset:2560
  buffer_load_dwordx4 v15, s[16:19], s74 offen offset:1024 lds
  v_mfma_f32_32x32x16_bf16 v[240:255], v[148:151], a[56:59], v[240:255]
  ds_read_b64_tr_b16 v[140:141], v22 offset:2048
  ds_read_b64_tr_b16 v[142:143], v22 offset:2560
  s_waitcnt lgkmcnt(8)
  s_nop 0
  v_mfma_f32_32x32x16_bf16 v[224:239], v[152:155], a[60:63], v[224:239]
  ds_read_b64_tr_b16 v[144:145], v19 offset:0
  ds_read_b64_tr_b16 v[146:147], v19 offset:512
  v_mfma_f32_32x32x16_bf16 v[240:255], v[156:159], a[60:63], v[240:255]
  ds_read_b64_tr_b16 v[148:149], v23 offset:0
  ds_read_b64_tr_b16 v[150:151], v23 offset:512
  buffer_load_dwordx4 v16, s[16:19], s74 offen offset:2048 lds
  s_waitcnt lgkmcnt(8)
  s_nop 0
  v_mfma_f32_32x32x16_bf16 v[224:239], v[128:131], a[64:67], v[224:239]
  ds_read_b64_tr_b16 v[152:153], v19 offset:2048
  ds_read_b64_tr_b16 v[154:155], v19 offset:2560
  buffer_load_dwordx4 v17, s[16:19], s74 offen offset:3072 lds
  ds_read_b64_tr_b16 v[112:113], v18 offset:36864
  ds_read_b64_tr_b16 v[114:115], v18 offset:37376
  ds_read_b64_tr_b16 v[116:117], v22 offset:36864
  v_mfma_f32_32x32x16_bf16 v[240:255], v[132:135], a[64:67], v[240:255]
  ds_read_b64_tr_b16 v[156:157], v23 offset:2048
  ds_read_b64_tr_b16 v[158:159], v23 offset:2560
  ds_read_b64_tr_b16 v[118:119], v22 offset:37376
  s_add_u32 s80, s81, 96256
  v_smfmac_f32_16x16x64_bf16 v[48:51], v[40:43], v[128:135], v44
  s_waitcnt lgkmcnt(12)
  s_nop 0
  v_smfmac_f32_16x16x64_bf16 v[48:51], v[40:43], v[136:143], v44
  v_mfma_f32_32x32x16_bf16 v[224:239], v[136:139], a[68:71], v[224:239]
  ds_read_b64_tr_b16 v[128:129], v20 offset:0
  ds_read_b64_tr_b16 v[130:131], v20 offset:512
  v_mfma_f32_32x32x16_bf16 v[240:255], v[140:143], a[68:71], v[240:255]
  ds_read_b64_tr_b16 v[132:133], v24 offset:0
  ds_read_b64_tr_b16 v[134:135], v24 offset:512
  s_waitcnt lgkmcnt(12)
  s_nop 0
  v_mfma_f32_32x32x16_bf16 v[224:239], v[144:147], a[72:75], v[224:239]
  ds_read_b64_tr_b16 v[136:137], v20 offset:2048
  ds_read_b64_tr_b16 v[138:139], v20 offset:2560
  v_mfma_f32_32x32x16_bf16 v[240:255], v[148:151], a[72:75], v[240:255]
  ds_read_b64_tr_b16 v[140:141], v24 offset:2048
  ds_read_b64_tr_b16 v[142:143], v24 offset:2560
  s_waitcnt lgkmcnt(9)
  s_nop 0
  v_mfma_f32_32x32x16_bf16 v[224:239], v[152:155], a[76:79], v[224:239]
  ds_read_b64_tr_b16 v[144:145], v21 offset:0
  ds_read_b64_tr_b16 v[146:147], v21 offset:512
  v_mfma_f32_32x32x16_bf16 v[240:255], v[156:159], a[76:79], v[240:255]
  s_waitcnt vmcnt(26)
  s_barrier
  ds_read_b64_tr_b16 v[148:149], v25 offset:0
  ds_read_b64_tr_b16 v[150:151], v25 offset:512
  s_mov_b32 m0, s39
  s_waitcnt lgkmcnt(8)
  v_mfma_f32_32x32x16_bf16 v[224:239], v[128:131], a[80:83], v[224:239]
  ds_read_b64_tr_b16 v[152:153], v21 offset:2048
  ds_read_b64_tr_b16 v[154:155], v21 offset:2560
  buffer_store_dwordx4 v[112:115], v36, s[12:15], s81 offen sc1
  buffer_store_dwordx4 v[116:119], v36, s[12:15], s80 offen sc1
  v_mfma_f32_32x32x16_bf16 v[240:255], v[132:135], a[80:83], v[240:255]
  ds_read_b64_tr_b16 v[156:157], v25 offset:2048
  ds_read_b64_tr_b16 v[158:159], v25 offset:2560
  buffer_load_dwordx4 v14, s[16:19], s75 offen offset:0 lds
  s_waitcnt lgkmcnt(8)
  s_nop 0
  v_mfma_f32_32x32x16_bf16 v[224:239], v[136:139], a[84:87], v[224:239]
  ds_read_b64_tr_b16 v[128:129], v18 offset:16384
  ds_read_b64_tr_b16 v[130:131], v18 offset:16896
  v_mfma_f32_32x32x16_bf16 v[240:255], v[140:143], a[84:87], v[240:255]
  ds_read_b64_tr_b16 v[132:133], v22 offset:16384
  ds_read_b64_tr_b16 v[134:135], v22 offset:16896
  s_waitcnt lgkmcnt(8)
  s_nop 0
  v_mfma_f32_32x32x16_bf16 v[224:239], v[144:147], a[88:91], v[224:239]
  ds_read_b64_tr_b16 v[136:137], v18 offset:18432
  ds_read_b64_tr_b16 v[138:139], v18 offset:18944
  buffer_load_dwordx4 v15, s[16:19], s75 offen offset:1024 lds
  v_mfma_f32_32x32x16_bf16 v[240:255], v[148:151], a[88:91], v[240:255]
  ds_read_b64_tr_b16 v[140:141], v22 offset:18432
  ds_read_b64_tr_b16 v[142:143], v22 offset:18944
  s_waitcnt lgkmcnt(8)
  s_nop 0
  v_mfma_f32_32x32x16_bf16 v[224:239], v[152:155], a[92:95], v[224:239]
  ds_read_b64_tr_b16 v[144:145], v19 offset:16384
  ds_read_b64_tr_b16 v[146:147], v19 offset:16896
  v_mfma_f32_32x32x16_bf16 v[240:255], v[156:159], a[92:95], v[240:255]
  ds_read_b64_tr_b16 v[148:149], v23 offset:16384
  ds_read_b64_tr_b16 v[150:151], v23 offset:16896
  buffer_load_dwordx4 v16, s[16:19], s75 offen offset:2048 lds
  s_waitcnt lgkmcnt(8)
  s_nop 0
  v_mfma_f32_32x32x16_bf16 v[224:239], v[128:131], a[96:99], v[224:239]
  ds_read_b64_tr_b16 v[152:153], v19 offset:18432
  ds_read_b64_tr_b16 v[154:155], v19 offset:18944
  buffer_load_dwordx4 v17, s[16:19], s75 offen offset:3072 lds
  v_mfma_f32_32x32x16_bf16 v[240:255], v[132:135], a[96:99], v[240:255]
  ds_read_b64_tr_b16 v[156:157], v23 offset:18432
  ds_read_b64_tr_b16 v[158:159], v23 offset:18944
  v_smfmac_f32_16x16x64_bf16 v[48:51], v[40:43], v[128:135], v44
  s_waitcnt lgkmcnt(8)
  s_nop 0
  v_smfmac_f32_16x16x64_bf16 v[48:51], v[40:43], v[136:143], v44
  v_mfma_f32_32x32x16_bf16 v[224:239], v[136:139], a[100:103], v[224:239]
  ds_read_b64_tr_b16 v[128:129], v20 offset:16384
  ds_read_b64_tr_b16 v[130:131], v20 offset:16896
  v_mfma_f32_32x32x16_bf16 v[240:255], v[140:143], a[100:103], v[240:255]
  ds_read_b64_tr_b16 v[132:133], v24 offset:16384
  ds_read_b64_tr_b16 v[134:135], v24 offset:16896
  buffer_load_dword v4, v2, s[4:7], 0 offen offset:256
  s_waitcnt lgkmcnt(8)
  s_nop 0
  v_mfma_f32_32x32x16_bf16 v[224:239], v[144:147], a[104:107], v[224:239]
  ds_read_b64_tr_b16 v[136:137], v20 offset:18432
  ds_read_b64_tr_b16 v[138:139], v20 offset:18944
  v_mfma_f32_32x32x16_bf16 v[240:255], v[148:151], a[104:107], v[240:255]
  ds_read_b64_tr_b16 v[140:141], v24 offset:18432
  ds_read_b64_tr_b16 v[142:143], v24 offset:18944
  s_waitcnt lgkmcnt(8)
  s_nop 0
  v_mfma_f32_32x32x16_bf16 v[224:239], v[152:155], a[108:111], v[224:239]
  ds_read_b64_tr_b16 v[144:145], v21 offset:16384
  ds_read_b64_tr_b16 v[146:147], v21 offset:16896
  v_mfma_f32_32x32x16_bf16 v[240:255], v[156:159], a[108:111], v[240:255]
  s_waitcnt vmcnt(28)
  s_barrier
  ds_read_b64_tr_b16 v[148:149], v25 offset:16384
  ds_read_b64_tr_b16 v[150:151], v25 offset:16896
  s_waitcnt lgkmcnt(8)
  s_nop 0
  v_mfma_f32_32x32x16_bf16 v[224:239], v[128:131], a[112:115], v[224:239]
  ds_read_b64_tr_b16 v[152:153], v21 offset:18432
  ds_read_b64_tr_b16 v[154:155], v21 offset:18944
  v_mfma_f32_32x32x16_bf16 v[240:255], v[132:135], a[112:115], v[240:255]
  ds_read_b64_tr_b16 v[156:157], v25 offset:18432
  ds_read_b64_tr_b16 v[158:159], v25 offset:18944
  s_waitcnt lgkmcnt(8)
  s_nop 0
  v_mfma_f32_32x32x16_bf16 v[224:239], v[136:139], a[116:119], v[224:239]
  ds_read_b64_tr_b16 v[128:129], v18 offset:20480
  ds_read_b64_tr_b16 v[130:131], v18 offset:20992
  v_mfma_f32_32x32x16_bf16 v[240:255], v[140:143], a[116:119], v[240:255]
  ds_read_b64_tr_b16 v[132:133], v22 offset:20480
  ds_read_b64_tr_b16 v[134:135], v22 offset:20992
  s_waitcnt lgkmcnt(8)
  s_nop 0
  v_mfma_f32_32x32x16_bf16 v[224:239], v[144:147], a[120:123], v[224:239]
  ds_read_b64_tr_b16 v[136:137], v18 offset:22528
  ds_read_b64_tr_b16 v[138:139], v18 offset:23040
  v_mfma_f32_32x32x16_bf16 v[240:255], v[148:151], a[120:123], v[240:255]
  ds_read_b64_tr_b16 v[140:141], v22 offset:22528
  ds_read_b64_tr_b16 v[142:143], v22 offset:23040
  s_waitcnt lgkmcnt(8)
  s_nop 0
  v_mfma_f32_32x32x16_bf16 v[224:239], v[152:155], a[124:127], v[224:239]
  ds_read_b64_tr_b16 v[144:145], v19 offset:20480
  ds_read_b64_tr_b16 v[146:147], v19 offset:20992
  v_mfma_f32_32x32x16_bf16 v[240:255], v[156:159], a[124:127], v[240:255]
  ds_read_b64_tr_b16 v[148:149], v23 offset:20480
  ds_read_b64_tr_b16 v[150:151], v23 offset:20992
  s_waitcnt lgkmcnt(8)
  s_nop 0
  v_mfma_f32_32x32x16_bf16 v[224:239], v[128:131], a[128:131], v[224:239]
  ds_read_b64_tr_b16 v[152:153], v19 offset:22528
  ds_read_b64_tr_b16 v[154:155], v19 offset:23040
  v_mfma_f32_32x32x16_bf16 v[240:255], v[132:135], a[128:131], v[240:255]
  ds_read_b64_tr_b16 v[156:157], v23 offset:22528
  ds_read_b64_tr_b16 v[158:159], v23 offset:23040
  v_smfmac_f32_16x16x64_bf16 v[48:51], v[40:43], v[128:135], v44
  s_waitcnt lgkmcnt(8)
  s_nop 0
  v_smfmac_f32_16x16x64_bf16 v[48:51], v[40:43], v[136:143], v44
  v_mfma_f32_32x32x16_bf16 v[224:239], v[136:139], a[132:135], v[224:239]
  ds_read_b64_tr_b16 v[128:129], v20 offset:20480
  ds_read_b64_tr_b16 v[130:131], v20 offset:20992
  v_mfma_f32_32x32x16_bf16 v[240:255], v[140:143], a[132:135], v[240:255]
  ds_read_b64_tr_b16 v[132:133], v24 offset:20480
  ds_read_b64_tr_b16 v[134:135], v24 offset:20992
  v_add_f32 v78, v48, v49
  s_waitcnt lgkmcnt(8)
  v_mfma_f32_32x32x16_bf16 v[224:239], v[144:147], a[136:139], v[224:239]
  ds_read_b64_tr_b16 v[136:137], v20 offset:22528
  ds_read_b64_tr_b16 v[138:139], v20 offset:23040
  ds_write_b32 v37, v78
  v_mov_b32 v48, 0
  v_mov_b32 v49, 0
  v_mfma_f32_32x32x16_bf16 v[240:255], v[148:151], a[136:139], v[240:255]
  ds_read_b64_tr_b16 v[140:141], v24 offset:22528
  ds_read_b64_tr_b16 v[142:143], v24 offset:23040
  s_waitcnt lgkmcnt(9)
  s_nop 0
  v_mfma_f32_32x32x16_bf16 v[224:239], v[152:155], a[140:143], v[224:239]
  ds_read_b64_tr_b16 v[144:145], v21 offset:20480
  ds_read_b64_tr_b16 v[146:147], v21 offset:20992
  v_mfma_f32_32x32x16_bf16 v[240:255], v[156:159], a[140:143], v[240:255]
  s_waitcnt vmcnt(24) lgkmcnt(4)
  s_barrier
  ds_read2st64_b32 v[74:75], v38 offset1:160
  ds_read2st64_b32 v[76:77], v39 offset1:160
  ds_read_b64_tr_b16 v[148:149], v25 offset:20480
  ds_read_b64_tr_b16 v[150:151], v25 offset:20992
  v_mfma_f32_32x32x16_bf16 v[224:239], v[128:131], a[144:147], v[224:239]
  ds_read_b64_tr_b16 v[152:153], v21 offset:22528
  ds_read_b64_tr_b16 v[154:155], v21 offset:23040
  v_mfma_f32_32x32x16_bf16 v[240:255], v[132:135], a[144:147], v[240:255]
  ds_read_b64_tr_b16 v[156:157], v25 offset:22528
  ds_read_b64_tr_b16 v[158:159], v25 offset:23040
  s_waitcnt lgkmcnt(10)
  s_nop 0
  v_mfma_f32_32x32x16_bf16 v[224:239], v[136:139], a[148:151], v[224:239]
  ds_read_b64_tr_b16 v[128:129], v18 offset:4096
  ds_read_b64_tr_b16 v[130:131], v18 offset:4608
  v_mfma_f32_32x32x16_bf16 v[240:255], v[140:143], a[148:151], v[240:255]
  ds_read_b64_tr_b16 v[132:133], v22 offset:4096
  ds_read_b64_tr_b16 v[134:135], v22 offset:4608
  s_waitcnt lgkmcnt(8)
  s_nop 0
  v_mfma_f32_32x32x16_bf16 v[224:239], v[144:147], a[152:155], v[224:239]
  ds_read_b64_tr_b16 v[136:137], v18 offset:6144
  ds_read_b64_tr_b16 v[138:139], v18 offset:6656
  v_add_f32 v74, v74, v75
  v_add_f32 v76, v76, v77
  v_add_f32_e64 v74, v74, v76
  v_cvt_pk_bf16_f32 v75, v74, v74
  v_mfma_f32_32x32x16_bf16 v[240:255], v[148:151], a[152:155], v[240:255]
  ds_read_b64_tr_b16 v[140:141], v22 offset:6144
  ds_read_b64_tr_b16 v[142:143], v22 offset:6656
  v_and_b32 v75, 0xffff0000, v75
  v_sub_f32 v75, v74, v75
  v_cvt_pk_bf16_f32 v68, v74, v75
  s_waitcnt lgkmcnt(8)
  v_mfma_f32_32x32x16_bf16 v[224:239], v[152:155], a[156:159], v[224:239]
  ds_read_b64_tr_b16 v[144:145], v19 offset:4096
  ds_read_b64_tr_b16 v[146:147], v19 offset:4608
  v_cvt_pk_bf16_f32 v69, v74, v75
  v_mfma_f32_32x32x16_bf16 v[240:255], v[156:159], a[156:159], v[240:255]
  ds_read_b64_tr_b16 v[148:149], v23 offset:4096
  ds_read_b64_tr_b16 v[150:151], v23 offset:4608
  v_mfma_f32_32x32x8_bf16 v[224:239], v[68:69], v[70:71], v[224:239]
  v_mfma_f32_32x32x8_bf16 v[240:255], v[68:69], v[72:73], v[240:255]
  s_waitcnt lgkmcnt(8)
  s_nop 0
  v_mfma_f32_32x32x16_bf16 v[160:175], v[128:131], a[0:3], 0
  ds_read_b64_tr_b16 v[152:153], v19 offset:6144
  ds_read_b64_tr_b16 v[154:155], v19 offset:6656
  v_mul_f32 v224, v47, v224
  v_mul_f32 v225, v47, v225
  v_mul_f32 v226, v47, v226
  v_mul_f32 v227, v47, v227
  v_mfma_f32_32x32x16_bf16 v[176:191], v[132:135], a[0:3], 0
  ds_read_b64_tr_b16 v[156:157], v23 offset:6144
  ds_read_b64_tr_b16 v[158:159], v23 offset:6656
  v_mul_f32 v228, v47, v228
  v_mul_f32 v229, v47, v229
  v_mul_f32 v230, v47, v230
  v_mul_f32 v231, v47, v231
  v_smfmac_f32_16x16x64_bf16 v[48:51], v[40:43], v[128:135], v44
  s_waitcnt lgkmcnt(8)
  s_nop 0
  v_smfmac_f32_16x16x64_bf16 v[48:51], v[40:43], v[136:143], v44
  v_mfma_f32_32x32x16_bf16 v[160:175], v[136:139], a[4:7], v[160:175]
  ds_read_b64_tr_b16 v[128:129], v20 offset:4096
  ds_read_b64_tr_b16 v[130:131], v20 offset:4608
  v_cvt_pk_bf16_f32 v224, v224, v225
  v_cvt_pk_bf16_f32 v225, v226, v227
  v_cvt_pk_bf16_f32 v226, v228, v229
  v_cvt_pk_bf16_f32 v227, v230, v231
  v_mfma_f32_32x32x16_bf16 v[176:191], v[140:143], a[4:7], v[176:191]
  ds_read_b64_tr_b16 v[132:133], v24 offset:4096
  ds_read_b64_tr_b16 v[134:135], v24 offset:4608
  buffer_store_dwordx4 v[224:227], v1, s[12:15], s78 offen offset:0 sc1
  v_mul_f32 v232, v47, v232
  v_mul_f32_e64 v233, v47, v233
  s_waitcnt lgkmcnt(8)
  v_mfma_f32_32x32x16_bf16 v[160:175], v[144:147], a[8:11], v[160:175]
  ds_read_b64_tr_b16 v[136:137], v20 offset:6144
  ds_read_b64_tr_b16 v[138:139], v20 offset:6656
  v_mul_f32 v234, v47, v234
  v_mul_f32 v235, v47, v235
  v_mul_f32 v236, v47, v236
  v_mul_f32 v237, v47, v237
  v_mfma_f32_32x32x16_bf16 v[176:191], v[148:151], a[8:11], v[176:191]
  ds_read_b64_tr_b16 v[140:141], v24 offset:6144
  ds_read_b64_tr_b16 v[142:143], v24 offset:6656
  v_mul_f32 v238, v47, v238
  v_mul_f32_e64 v239, v47, v239
  v_cvt_pk_bf16_f32 v232, v232, v233
  s_waitcnt lgkmcnt(8)
  v_mfma_f32_32x32x16_bf16 v[160:175], v[152:155], a[12:15], v[160:175]
  ds_read_b64_tr_b16 v[144:145], v21 offset:4096
  ds_read_b64_tr_b16 v[146:147], v21 offset:4608
  v_cvt_pk_bf16_f32 v233, v234, v235
  v_cvt_pk_bf16_f32 v234, v236, v237
  v_cvt_pk_bf16_f32 v235, v238, v239
  v_mfma_f32_32x32x16_bf16 v[176:191], v[156:159], a[12:15], v[176:191]
  s_waitcnt vmcnt(21)
  s_barrier
  ds_read_b64_tr_b16 v[148:149], v25 offset:4096
  ds_read_b64_tr_b16 v[150:151], v25 offset:4608
  buffer_store_dwordx4 v[232:235], v1, s[12:15], s78 offen offset:1024 sc1
  s_waitcnt lgkmcnt(8)
  s_nop 0
  v_mfma_f32_32x32x16_bf16 v[160:175], v[128:131], a[16:19], v[160:175]
  ds_read_b64_tr_b16 v[152:153], v21 offset:6144
  ds_read_b64_tr_b16 v[154:155], v21 offset:6656
  v_mul_f32 v240, v47, v240
  v_mul_f32 v241, v47, v241
  v_mul_f32 v242, v47, v242
  v_mul_f32 v243, v47, v243
  v_mfma_f32_32x32x16_bf16 v[176:191], v[132:135], a[16:19], v[176:191]
  ds_read_b64_tr_b16 v[156:157], v25 offset:6144
  ds_read_b64_tr_b16 v[158:159], v25 offset:6656
  buffer_load_dword v4, v2, s[4:7], 0 offen offset:384
  v_mul_f32 v244, v47, v244
  v_mul_f32_e64 v245, v47, v245
  s_waitcnt lgkmcnt(8)
  v_mfma_f32_32x32x16_bf16 v[160:175], v[136:139], a[20:23], v[160:175]
  ds_read_b64_tr_b16 v[128:129], v18 offset:24576
  ds_read_b64_tr_b16 v[130:131], v18 offset:25088
  v_mul_f32 v246, v47, v246
  v_mul_f32 v247, v47, v247
  v_cvt_pk_bf16_f32 v240, v240, v241
  v_cvt_pk_bf16_f32 v241, v242, v243
  v_mfma_f32_32x32x16_bf16 v[176:191], v[140:143], a[20:23], v[176:191]
  ds_read_b64_tr_b16 v[132:133], v22 offset:24576
  ds_read_b64_tr_b16 v[134:135], v22 offset:25088
  v_cvt_pk_bf16_f32 v242, v244, v245
  v_cvt_pk_bf16_f32 v243, v246, v247
  s_waitcnt lgkmcnt(8)
  s_nop 0
  v_mfma_f32_32x32x16_bf16 v[160:175], v[144:147], a[24:27], v[160:175]
  ds_read_b64_tr_b16 v[136:137], v18 offset:26624
  ds_read_b64_tr_b16 v[138:139], v18 offset:27136
  buffer_store_dwordx4 v[240:243], v1, s[12:15], s78 offen offset:2048 sc1
  v_mul_f32 v248, v47, v248
  v_mul_f32 v249, v47, v249
  v_mul_f32_e64 v250, v47, v250
  v_mfma_f32_32x32x16_bf16 v[176:191], v[148:151], a[24:27], v[176:191]
  ds_read_b64_tr_b16 v[140:141], v22 offset:26624
  ds_read_b64_tr_b16 v[142:143], v22 offset:27136
  v_mul_f32 v251, v47, v251
  v_mul_f32 v252, v47, v252
  v_mul_f32 v253, v47, v253
  s_waitcnt lgkmcnt(8)
  v_mfma_f32_32x32x16_bf16 v[160:175], v[152:155], a[28:31], v[160:175]
  ds_read_b64_tr_b16 v[144:145], v19 offset:24576
  ds_read_b64_tr_b16 v[146:147], v19 offset:25088
  v_mul_f32 v254, v47, v254
  v_mul_f32 v255, v47, v255
  v_cvt_pk_bf16_f32 v248, v248, v249
  v_cvt_pk_bf16_f32 v249, v250, v251
  v_mfma_f32_32x32x16_bf16 v[176:191], v[156:159], a[28:31], v[176:191]
  ds_read_b64_tr_b16 v[148:149], v23 offset:24576
  ds_read_b64_tr_b16 v[150:151], v23 offset:25088
  v_cvt_pk_bf16_f32 v250, v252, v253
  v_cvt_pk_bf16_f32 v251, v254, v255
  s_waitcnt lgkmcnt(8)
  s_nop 0
  v_mfma_f32_32x32x16_bf16 v[160:175], v[128:131], a[32:35], v[160:175]
  ds_read_b64_tr_b16 v[152:153], v19 offset:26624
  ds_read_b64_tr_b16 v[154:155], v19 offset:27136
  buffer_store_dwordx4 v[248:251], v1, s[12:15], s78 offen offset:3072 sc1
  v_mfma_f32_32x32x16_bf16 v[176:191], v[132:135], a[32:35], v[176:191]
  ds_read_b64_tr_b16 v[156:157], v23 offset:26624
  ds_read_b64_tr_b16 v[158:159], v23 offset:27136
  v_smfmac_f32_16x16x64_bf16 v[48:51], v[40:43], v[128:135], v44
  s_waitcnt lgkmcnt(8)
  s_nop 0
  v_smfmac_f32_16x16x64_bf16 v[48:51], v[40:43], v[136:143], v44
  v_mfma_f32_32x32x16_bf16 v[160:175], v[136:139], a[36:39], v[160:175]
  ds_read_b64_tr_b16 v[128:129], v20 offset:24576
  ds_read_b64_tr_b16 v[130:131], v20 offset:25088
  v_mfma_f32_32x32x16_bf16 v[176:191], v[140:143], a[36:39], v[176:191]
  ds_read_b64_tr_b16 v[132:133], v24 offset:24576
  ds_read_b64_tr_b16 v[134:135], v24 offset:25088
  s_waitcnt lgkmcnt(8)
  s_nop 0
  v_mfma_f32_32x32x16_bf16 v[160:175], v[144:147], a[40:43], v[160:175]
  ds_read_b64_tr_b16 v[136:137], v20 offset:26624
  ds_read_b64_tr_b16 v[138:139], v20 offset:27136
  v_mfma_f32_32x32x16_bf16 v[176:191], v[148:151], a[40:43], v[176:191]
  ds_read_b64_tr_b16 v[140:141], v24 offset:26624
  ds_read_b64_tr_b16 v[142:143], v24 offset:27136
  s_waitcnt lgkmcnt(8)
  s_nop 0
  v_mfma_f32_32x32x16_bf16 v[160:175], v[152:155], a[44:47], v[160:175]
  ds_read_b64_tr_b16 v[144:145], v21 offset:24576
  ds_read_b64_tr_b16 v[146:147], v21 offset:25088
  v_mfma_f32_32x32x16_bf16 v[176:191], v[156:159], a[44:47], v[176:191]
  s_waitcnt vmcnt(20)
  s_barrier
  ds_read_b64_tr_b16 v[148:149], v25 offset:24576
  ds_read_b64_tr_b16 v[150:151], v25 offset:25088
  s_waitcnt lgkmcnt(8)
  s_nop 0
  v_mfma_f32_32x32x16_bf16 v[160:175], v[128:131], a[48:51], v[160:175]
  ds_read_b64_tr_b16 v[152:153], v21 offset:26624
  ds_read_b64_tr_b16 v[154:155], v21 offset:27136
  v_mfma_f32_32x32x16_bf16 v[176:191], v[132:135], a[48:51], v[176:191]
  ds_read_b64_tr_b16 v[156:157], v25 offset:26624
  ds_read_b64_tr_b16 v[158:159], v25 offset:27136
  s_waitcnt lgkmcnt(8)
  s_nop 0
  v_mfma_f32_32x32x16_bf16 v[160:175], v[136:139], a[52:55], v[160:175]
  ds_read_b64_tr_b16 v[128:129], v18 offset:28672
  ds_read_b64_tr_b16 v[130:131], v18 offset:29184
  v_mfma_f32_32x32x16_bf16 v[176:191], v[140:143], a[52:55], v[176:191]
  ds_read_b64_tr_b16 v[132:133], v22 offset:28672
  ds_read_b64_tr_b16 v[134:135], v22 offset:29184
  s_waitcnt lgkmcnt(8)
  s_nop 0
  v_mfma_f32_32x32x16_bf16 v[160:175], v[144:147], a[56:59], v[160:175]
  ds_read_b64_tr_b16 v[136:137], v18 offset:30720
  ds_read_b64_tr_b16 v[138:139], v18 offset:31232
  v_mfma_f32_32x32x16_bf16 v[176:191], v[148:151], a[56:59], v[176:191]
  ds_read_b64_tr_b16 v[140:141], v22 offset:30720
  ds_read_b64_tr_b16 v[142:143], v22 offset:31232
  s_waitcnt lgkmcnt(8)
  s_nop 0
  v_mfma_f32_32x32x16_bf16 v[160:175], v[152:155], a[60:63], v[160:175]
  ds_read_b64_tr_b16 v[144:145], v19 offset:28672
  ds_read_b64_tr_b16 v[146:147], v19 offset:29184
  v_mfma_f32_32x32x16_bf16 v[176:191], v[156:159], a[60:63], v[176:191]
  ds_read_b64_tr_b16 v[148:149], v23 offset:28672
  ds_read_b64_tr_b16 v[150:151], v23 offset:29184
  s_waitcnt lgkmcnt(8)
  s_nop 0
  v_mfma_f32_32x32x16_bf16 v[160:175], v[128:131], a[64:67], v[160:175]
  ds_read_b64_tr_b16 v[152:153], v19 offset:30720
  ds_read_b64_tr_b16 v[154:155], v19 offset:31232
  v_mfma_f32_32x32x16_bf16 v[176:191], v[132:135], a[64:67], v[176:191]
  ds_read_b64_tr_b16 v[156:157], v23 offset:30720
  ds_read_b64_tr_b16 v[158:159], v23 offset:31232
  v_smfmac_f32_16x16x64_bf16 v[48:51], v[40:43], v[128:135], v44
  s_waitcnt lgkmcnt(8)
  s_nop 0
  v_smfmac_f32_16x16x64_bf16 v[48:51], v[40:43], v[136:143], v44
  v_mfma_f32_32x32x16_bf16 v[160:175], v[136:139], a[68:71], v[160:175]
  ds_read_b64_tr_b16 v[128:129], v20 offset:28672
  ds_read_b64_tr_b16 v[130:131], v20 offset:29184
  v_mfma_f32_32x32x16_bf16 v[176:191], v[140:143], a[68:71], v[176:191]
  ds_read_b64_tr_b16 v[132:133], v24 offset:28672
  ds_read_b64_tr_b16 v[134:135], v24 offset:29184
  s_waitcnt lgkmcnt(8)
  s_nop 0
  v_mfma_f32_32x32x16_bf16 v[160:175], v[144:147], a[72:75], v[160:175]
  ds_read_b64_tr_b16 v[136:137], v20 offset:30720
  ds_read_b64_tr_b16 v[138:139], v20 offset:31232
  v_mfma_f32_32x32x16_bf16 v[176:191], v[148:151], a[72:75], v[176:191]
  ds_read_b64_tr_b16 v[140:141], v24 offset:30720
  ds_read_b64_tr_b16 v[142:143], v24 offset:31232
  s_waitcnt lgkmcnt(8)
  s_nop 0
  v_mfma_f32_32x32x16_bf16 v[160:175], v[152:155], a[76:79], v[160:175]
  ds_read_b64_tr_b16 v[144:145], v21 offset:28672
  ds_read_b64_tr_b16 v[146:147], v21 offset:29184
  v_mfma_f32_32x32x16_bf16 v[176:191], v[156:159], a[76:79], v[176:191]
  s_waitcnt vmcnt(12)
  s_barrier
  ds_read_b64_tr_b16 v[148:149], v25 offset:28672
  ds_read_b64_tr_b16 v[150:151], v25 offset:29184
  s_waitcnt lgkmcnt(8)
  s_nop 0
  v_mfma_f32_32x32x16_bf16 v[160:175], v[128:131], a[80:83], v[160:175]
  ds_read_b64_tr_b16 v[152:153], v21 offset:30720
  ds_read_b64_tr_b16 v[154:155], v21 offset:31232
  v_mfma_f32_32x32x16_bf16 v[176:191], v[132:135], a[80:83], v[176:191]
  ds_read_b64_tr_b16 v[156:157], v25 offset:30720
  ds_read_b64_tr_b16 v[158:159], v25 offset:31232
  s_waitcnt lgkmcnt(8)
  s_nop 0
  v_mfma_f32_32x32x16_bf16 v[160:175], v[136:139], a[84:87], v[160:175]
  ds_read_b64_tr_b16 v[128:129], v18 offset:8192
  ds_read_b64_tr_b16 v[130:131], v18 offset:8704
  v_mfma_f32_32x32x16_bf16 v[176:191], v[140:143], a[84:87], v[176:191]
  ds_read_b64_tr_b16 v[132:133], v22 offset:8192
  ds_read_b64_tr_b16 v[134:135], v22 offset:8704
  s_waitcnt lgkmcnt(8)
  s_nop 0
  v_mfma_f32_32x32x16_bf16 v[160:175], v[144:147], a[88:91], v[160:175]
  ds_read_b64_tr_b16 v[136:137], v18 offset:10240
  ds_read_b64_tr_b16 v[138:139], v18 offset:10752
  v_mfma_f32_32x32x16_bf16 v[176:191], v[148:151], a[88:91], v[176:191]
  ds_read_b64_tr_b16 v[140:141], v22 offset:10240
  ds_read_b64_tr_b16 v[142:143], v22 offset:10752
  s_waitcnt lgkmcnt(8)
  s_nop 0
  v_mfma_f32_32x32x16_bf16 v[160:175], v[152:155], a[92:95], v[160:175]
  ds_read_b64_tr_b16 v[144:145], v19 offset:8192
  ds_read_b64_tr_b16 v[146:147], v19 offset:8704
  v_mfma_f32_32x32x16_bf16 v[176:191], v[156:159], a[92:95], v[176:191]
  ds_read_b64_tr_b16 v[148:149], v23 offset:8192
  ds_read_b64_tr_b16 v[150:151], v23 offset:8704
  s_waitcnt lgkmcnt(8)
  s_nop 0
  v_mfma_f32_32x32x16_bf16 v[160:175], v[128:131], a[96:99], v[160:175]
  ds_read_b64_tr_b16 v[152:153], v19 offset:10240
  ds_read_b64_tr_b16 v[154:155], v19 offset:10752
  v_mfma_f32_32x32x16_bf16 v[176:191], v[132:135], a[96:99], v[176:191]
  ds_read_b64_tr_b16 v[156:157], v23 offset:10240
  ds_read_b64_tr_b16 v[158:159], v23 offset:10752
  v_smfmac_f32_16x16x64_bf16 v[48:51], v[40:43], v[128:135], v44
  s_waitcnt lgkmcnt(8)
  s_nop 0
  v_smfmac_f32_16x16x64_bf16 v[48:51], v[40:43], v[136:143], v44
  v_mfma_f32_32x32x16_bf16 v[160:175], v[136:139], a[100:103], v[160:175]
  ds_read_b64_tr_b16 v[128:129], v20 offset:8192
  ds_read_b64_tr_b16 v[130:131], v20 offset:8704
  v_mfma_f32_32x32x16_bf16 v[176:191], v[140:143], a[100:103], v[176:191]
  ds_read_b64_tr_b16 v[132:133], v24 offset:8192
  ds_read_b64_tr_b16 v[134:135], v24 offset:8704
  s_waitcnt lgkmcnt(8)
  s_nop 0
  v_mfma_f32_32x32x16_bf16 v[160:175], v[144:147], a[104:107], v[160:175]
  ds_read_b64_tr_b16 v[136:137], v20 offset:10240
  ds_read_b64_tr_b16 v[138:139], v20 offset:10752
  v_mfma_f32_32x32x16_bf16 v[176:191], v[148:151], a[104:107], v[176:191]
  ds_read_b64_tr_b16 v[140:141], v24 offset:10240
  ds_read_b64_tr_b16 v[142:143], v24 offset:10752
  s_waitcnt lgkmcnt(8)
  s_nop 0
  v_mfma_f32_32x32x16_bf16 v[160:175], v[152:155], a[108:111], v[160:175]
  ds_read_b64_tr_b16 v[144:145], v21 offset:8192
  ds_read_b64_tr_b16 v[146:147], v21 offset:8704
  v_mfma_f32_32x32x16_bf16 v[176:191], v[156:159], a[108:111], v[176:191]
  s_waitcnt vmcnt(6)
  s_barrier
  ds_read_b64_tr_b16 v[148:149], v25 offset:8192
  ds_read_b64_tr_b16 v[150:151], v25 offset:8704
  s_waitcnt lgkmcnt(8)
  s_nop 0
  v_mfma_f32_32x32x16_bf16 v[160:175], v[128:131], a[112:115], v[160:175]
  ds_read_b64_tr_b16 v[152:153], v21 offset:10240
  ds_read_b64_tr_b16 v[154:155], v21 offset:10752
  v_mfma_f32_32x32x16_bf16 v[176:191], v[132:135], a[112:115], v[176:191]
  ds_read_b64_tr_b16 v[156:157], v25 offset:10240
  ds_read_b64_tr_b16 v[158:159], v25 offset:10752
  s_waitcnt lgkmcnt(8)
  s_nop 0
  v_mfma_f32_32x32x16_bf16 v[160:175], v[136:139], a[116:119], v[160:175]
  ds_read_b64_tr_b16 v[128:129], v18 offset:12288
  ds_read_b64_tr_b16 v[130:131], v18 offset:12800
  v_mfma_f32_32x32x16_bf16 v[176:191], v[140:143], a[116:119], v[176:191]
  ds_read_b64_tr_b16 v[132:133], v22 offset:12288
  ds_read_b64_tr_b16 v[134:135], v22 offset:12800
  s_waitcnt lgkmcnt(8)
  s_nop 0
  v_mfma_f32_32x32x16_bf16 v[160:175], v[144:147], a[120:123], v[160:175]
  ds_read_b64_tr_b16 v[136:137], v18 offset:14336
  ds_read_b64_tr_b16 v[138:139], v18 offset:14848
  v_mfma_f32_32x32x16_bf16 v[176:191], v[148:151], a[120:123], v[176:191]
  ds_read_b64_tr_b16 v[140:141], v22 offset:14336
  ds_read_b64_tr_b16 v[142:143], v22 offset:14848
  s_waitcnt lgkmcnt(8)
  s_nop 0
  v_mfma_f32_32x32x16_bf16 v[160:175], v[152:155], a[124:127], v[160:175]
  ds_read_b64_tr_b16 v[144:145], v19 offset:12288
  ds_read_b64_tr_b16 v[146:147], v19 offset:12800
  v_mfma_f32_32x32x16_bf16 v[176:191], v[156:159], a[124:127], v[176:191]
  ds_read_b64_tr_b16 v[148:149], v23 offset:12288
  ds_read_b64_tr_b16 v[150:151], v23 offset:12800
  s_waitcnt lgkmcnt(8)
  s_nop 0
  v_mfma_f32_32x32x16_bf16 v[160:175], v[128:131], a[128:131], v[160:175]
  ds_read_b64_tr_b16 v[152:153], v19 offset:14336
  ds_read_b64_tr_b16 v[154:155], v19 offset:14848
  v_mfma_f32_32x32x16_bf16 v[176:191], v[132:135], a[128:131], v[176:191]
  ds_read_b64_tr_b16 v[156:157], v23 offset:14336
  ds_read_b64_tr_b16 v[158:159], v23 offset:14848
  v_smfmac_f32_16x16x64_bf16 v[48:51], v[40:43], v[128:135], v44
  s_waitcnt lgkmcnt(8)
  s_nop 0
  v_smfmac_f32_16x16x64_bf16 v[48:51], v[40:43], v[136:143], v44
  v_mfma_f32_32x32x16_bf16 v[160:175], v[136:139], a[132:135], v[160:175]
  ds_read_b64_tr_b16 v[128:129], v20 offset:12288
  ds_read_b64_tr_b16 v[130:131], v20 offset:12800
  v_mfma_f32_32x32x16_bf16 v[176:191], v[140:143], a[132:135], v[176:191]
  ds_read_b64_tr_b16 v[132:133], v24 offset:12288
  ds_read_b64_tr_b16 v[134:135], v24 offset:12800
  v_add_f32 v78, v48, v49
  s_waitcnt lgkmcnt(8)
  v_mfma_f32_32x32x16_bf16 v[160:175], v[144:147], a[136:139], v[160:175]
  ds_read_b64_tr_b16 v[136:137], v20 offset:14336
  ds_read_b64_tr_b16 v[138:139], v20 offset:14848
  ds_write_b32 v37, v78
  v_mov_b32 v48, 0
  v_mov_b32 v49, 0
  v_mfma_f32_32x32x16_bf16 v[176:191], v[148:151], a[136:139], v[176:191]
  ds_read_b64_tr_b16 v[140:141], v24 offset:14336
  ds_read_b64_tr_b16 v[142:143], v24 offset:14848
  s_waitcnt lgkmcnt(9)
  s_nop 0
  v_mfma_f32_32x32x16_bf16 v[160:175], v[152:155], a[140:143], v[160:175]
  ds_read_b64_tr_b16 v[144:145], v21 offset:12288
  ds_read_b64_tr_b16 v[146:147], v21 offset:12800
  v_mfma_f32_32x32x16_bf16 v[176:191], v[156:159], a[140:143], v[176:191]
  s_waitcnt lgkmcnt(4)
  s_barrier
  ds_read2st64_b32 v[74:75], v38 offset1:160
  ds_read2st64_b32 v[76:77], v39 offset1:160
  ds_read_b64_tr_b16 v[148:149], v25 offset:12288
  ds_read_b64_tr_b16 v[150:151], v25 offset:12800
  v_mfma_f32_32x32x16_bf16 v[160:175], v[128:131], a[144:147], v[160:175]
  ds_read_b64_tr_b16 v[152:153], v21 offset:14336
  ds_read_b64_tr_b16 v[154:155], v21 offset:14848
  v_mfma_f32_32x32x16_bf16 v[176:191], v[132:135], a[144:147], v[176:191]
  ds_read_b64_tr_b16 v[156:157], v25 offset:14336
  ds_read_b64_tr_b16 v[158:159], v25 offset:14848
  s_waitcnt lgkmcnt(10)
  s_nop 0
  v_mfma_f32_32x32x16_bf16 v[160:175], v[136:139], a[148:151], v[160:175]
  v_mfma_f32_32x32x16_bf16 v[176:191], v[140:143], a[148:151], v[176:191]
  s_waitcnt lgkmcnt(4)
  s_nop 0
  v_mfma_f32_32x32x16_bf16 v[160:175], v[144:147], a[152:155], v[160:175]
  v_add_f32 v74, v74, v75
  v_add_f32 v76, v76, v77
  v_add_f32 v74, v74, v76
  v_cvt_pk_bf16_f32 v75, v74, v74
  v_and_b32 v75, 0xffff0000, v75
  v_sub_f32 v75, v74, v75
  v_mfma_f32_32x32x16_bf16 v[176:191], v[148:151], a[152:155], v[176:191]
  v_cvt_pk_bf16_f32 v68, v74, v75
  v_cvt_pk_bf16_f32 v69, v74, v75
  s_waitcnt lgkmcnt(0)
  s_nop 0
  v_mfma_f32_32x32x16_bf16 v[160:175], v[152:155], a[156:159], v[160:175]
  v_mfma_f32_32x32x16_bf16 v[176:191], v[156:159], a[156:159], v[176:191]
  v_mfma_f32_32x32x8_bf16 v[160:175], v[68:69], v[70:71], v[160:175]
  v_mfma_f32_32x32x8_bf16 v[176:191], v[68:69], v[72:73], v[176:191]
  s_nop 3
  v_pk_mul_f32 v[160:161], v[160:161], v[46:47] op_sel:[0,1] op_sel_hi:[1,1]
  v_pk_mul_f32 v[162:163], v[162:163], v[46:47] op_sel:[0,1] op_sel_hi:[1,1]
  v_pk_mul_f32 v[164:165], v[164:165], v[46:47] op_sel:[0,1] op_sel_hi:[1,1]
  v_pk_mul_f32 v[166:167], v[166:167], v[46:47] op_sel:[0,1] op_sel_hi:[1,1]
  v_cvt_pk_bf16_f32 v160, v160, v161
  v_cvt_pk_bf16_f32 v161, v162, v163
  v_cvt_pk_bf16_f32 v162, v164, v165
  v_cvt_pk_bf16_f32 v163, v166, v167
  buffer_store_dwordx4 v[160:163], v1, s[12:15], s79 offen offset:0 sc1
  v_pk_mul_f32 v[168:169], v[168:169], v[46:47] op_sel:[0,1] op_sel_hi:[1,1]
  v_pk_mul_f32 v[170:171], v[170:171], v[46:47] op_sel:[0,1] op_sel_hi:[1,1]
  v_pk_mul_f32 v[172:173], v[172:173], v[46:47] op_sel:[0,1] op_sel_hi:[1,1]
  v_pk_mul_f32 v[174:175], v[174:175], v[46:47] op_sel:[0,1] op_sel_hi:[1,1]
  v_cvt_pk_bf16_f32 v168, v168, v169
  v_cvt_pk_bf16_f32 v169, v170, v171
  v_cvt_pk_bf16_f32 v170, v172, v173
  v_cvt_pk_bf16_f32 v171, v174, v175
  buffer_store_dwordx4 v[168:171], v1, s[12:15], s79 offen offset:1024 sc1
  v_pk_mul_f32 v[176:177], v[176:177], v[46:47] op_sel:[0,1] op_sel_hi:[1,1]
  v_pk_mul_f32 v[178:179], v[178:179], v[46:47] op_sel:[0,1] op_sel_hi:[1,1]
  v_pk_mul_f32 v[180:181], v[180:181], v[46:47] op_sel:[0,1] op_sel_hi:[1,1]
  v_pk_mul_f32 v[182:183], v[182:183], v[46:47] op_sel:[0,1] op_sel_hi:[1,1]
  v_cvt_pk_bf16_f32 v176, v176, v177
  v_cvt_pk_bf16_f32 v177, v178, v179
  v_cvt_pk_bf16_f32 v178, v180, v181
  v_cvt_pk_bf16_f32 v179, v182, v183
  buffer_store_dwordx4 v[176:179], v1, s[12:15], s79 offen offset:2048 sc1
  v_pk_mul_f32 v[184:185], v[184:185], v[46:47] op_sel:[0,1] op_sel_hi:[1,1]
  v_pk_mul_f32 v[186:187], v[186:187], v[46:47] op_sel:[0,1] op_sel_hi:[1,1]
  v_pk_mul_f32 v[188:189], v[188:189], v[46:47] op_sel:[0,1] op_sel_hi:[1,1]
  v_pk_mul_f32 v[190:191], v[190:191], v[46:47] op_sel:[0,1] op_sel_hi:[1,1]
  v_cvt_pk_bf16_f32 v184, v184, v185
  v_cvt_pk_bf16_f32 v185, v186, v187
  v_cvt_pk_bf16_f32 v186, v188, v189
  v_cvt_pk_bf16_f32 v187, v190, v191
  buffer_store_dwordx4 v[184:187], v1, s[12:15], s79 offen offset:3072 sc1
  v_mov_b32 v4, 0
  s_lshl_b32 s32, s2, 2
  s_add_u32 s32, s32, 26812416
  s_mov_b64 exec, 1
  buffer_store_dword v4, off, s[12:15], s32
  s_endpgm
.p2align 5
K1_C:
  s_waitcnt lgkmcnt(8)
  s_nop 0
  v_mfma_f32_32x32x16_bf16 v[192:207], v[128:131], a[0:3], 0
  ds_read_b64_tr_b16 v[152:153], v19 offset:18432
  ds_read_b64_tr_b16 v[154:155], v19 offset:18944
  buffer_load_dwordx4 v17, s[16:19], s67 offen offset:3072 lds
  v_add_f32 v56, 0x3727c5ac, v56
  v_rsq_f32_e64 v46, v56
  v_mfma_f32_32x32x16_bf16 v[208:223], v[132:135], a[0:3], 0
  ds_read_b64_tr_b16 v[156:157], v23 offset:18432
  ds_read_b64_tr_b16 v[158:159], v23 offset:18944
  v_mul_f32 v47, s82, v46
  v_mul_f32 v82, v56, v46
  v_mul_f32 v81, 0xc0135761, v46
  v_mul_f32_e64 v80, v46, v46
  v_smfmac_f32_16x16x64_bf16 v[48:51], v[40:43], v[128:135], v44
  s_waitcnt lgkmcnt(8)
  s_nop 0
  v_smfmac_f32_16x16x64_bf16 v[48:51], v[40:43], v[136:143], v44
  v_mfma_f32_32x32x16_bf16 v[192:207], v[136:139], a[4:7], v[192:207]
  ds_read_b64_tr_b16 v[128:129], v20 offset:16384
  ds_read_b64_tr_b16 v[130:131], v20 offset:16896
  s_mov_b32 m0, s45
  v_mul_f32 v80, v80, v81
  v_mul_f32 v80, 0x3d372713, v80
  v_mul_f32_e64 v84, v160, v160
  v_mfma_f32_32x32x16_bf16 v[208:223], v[140:143], a[4:7], v[208:223]
  ds_read_b64_tr_b16 v[132:133], v24 offset:16384
  ds_read_b64_tr_b16 v[134:135], v24 offset:16896
  v_mul_f32 v85, v161, v161
  v_fma_f32 v84, v84, v80, v81
  v_fma_f32 v85, v85, v80, v81
  s_waitcnt lgkmcnt(8)
  v_mfma_f32_32x32x16_bf16 v[192:207], v[144:147], a[8:11], v[192:207]
  ds_read_b64_tr_b16 v[136:137], v20 offset:18432
  ds_read_b64_tr_b16 v[138:139], v20 offset:18944
  buffer_load_dwordx4 v34, s[20:23], s80 offen lds
  v_mul_f32 v84, v84, v160
  v_mul_f32 v85, v85, v161
  v_mfma_f32_32x32x16_bf16 v[208:223], v[148:151], a[8:11], v[208:223]
  ds_read_b64_tr_b16 v[140:141], v24 offset:18432
  ds_read_b64_tr_b16 v[142:143], v24 offset:18944
  v_exp_f32 v84, v84
  s_waitcnt lgkmcnt(8)
  v_mfma_f32_32x32x16_bf16 v[192:207], v[152:155], a[12:15], v[192:207]
  ds_read_b64_tr_b16 v[144:145], v21 offset:16384
  ds_read_b64_tr_b16 v[146:147], v21 offset:16896
  buffer_load_dwordx4 v35, s[20:23], s80 offen offset:1024 lds
  v_exp_f32_e64 v85, v85
  v_fma_f32 v84, v84, v82, v82
  v_mfma_f32_32x32x16_bf16 v[208:223], v[156:159], a[12:15], v[208:223]
  s_waitcnt vmcnt(22)
  s_barrier
  ds_read_b64_tr_b16 v[148:149], v25 offset:16384
  ds_read_b64_tr_b16 v[150:151], v25 offset:16896
  v_fma_f32 v85, v85, v82, v82
  s_waitcnt lgkmcnt(8)
  s_nop 0
  v_mfma_f32_32x32x16_bf16 v[192:207], v[128:131], a[16:19], v[192:207]
  ds_read_b64_tr_b16 v[152:153], v21 offset:18432
  ds_read_b64_tr_b16 v[154:155], v21 offset:18944
  s_mov_b32 m0, s36
  v_rcp_f32 v84, v84
  v_mfma_f32_32x32x16_bf16 v[208:223], v[132:135], a[16:19], v[208:223]
  ds_read_b64_tr_b16 v[156:157], v25 offset:18432
  ds_read_b64_tr_b16 v[158:159], v25 offset:18944
  v_rcp_f32 v85, v85
  v_mul_f32_e64 v160, v160, v84
  s_waitcnt lgkmcnt(8)
  v_mfma_f32_32x32x16_bf16 v[192:207], v[136:139], a[20:23], v[192:207]
  ds_read_b64_tr_b16 v[128:129], v18 offset:20480
  ds_read_b64_tr_b16 v[130:131], v18 offset:20992
  buffer_load_dwordx4 v14, s[16:19], s68 offen offset:0 lds
  v_mul_f32 v161, v161, v85
  v_mul_f32 v86, v162, v162
  v_mul_f32_e64 v87, v163, v163
  v_mfma_f32_32x32x16_bf16 v[208:223], v[140:143], a[20:23], v[208:223]
  ds_read_b64_tr_b16 v[132:133], v22 offset:20480
  ds_read_b64_tr_b16 v[134:135], v22 offset:20992
  v_fma_f32 v86, v86, v80, v81
  v_fma_f32 v87, v87, v80, v81
  v_mul_f32 v86, v86, v162
  s_waitcnt lgkmcnt(8)
  v_mfma_f32_32x32x16_bf16 v[192:207], v[144:147], a[24:27], v[192:207]
  ds_read_b64_tr_b16 v[136:137], v18 offset:22528
  ds_read_b64_tr_b16 v[138:139], v18 offset:23040
  buffer_load_dwordx4 v15, s[16:19], s68 offen offset:1024 lds
  v_mul_f32 v87, v87, v163
  v_exp_f32 v86, v86
  v_mfma_f32_32x32x16_bf16 v[208:223], v[148:151], a[24:27], v[208:223]
  ds_read_b64_tr_b16 v[140:141], v22 offset:22528
  ds_read_b64_tr_b16 v[142:143], v22 offset:23040
  v_exp_f32 v87, v87
  v_fma_f32 v86, v86, v82, v82
  s_waitcnt lgkmcnt(8)
  v_mfma_f32_32x32x16_bf16 v[192:207], v[152:155], a[28:31], v[192:207]
  ds_read_b64_tr_b16 v[144:145], v19 offset:20480
  ds_read_b64_tr_b16 v[146:147], v19 offset:20992
  buffer_load_dwordx4 v16, s[16:19], s68 offen offset:2048 lds
  v_fma_f32 v87, v87, v82, v82
  v_rcp_f32_e64 v86, v86
  v_mfma_f32_32x32x16_bf16 v[208:223], v[156:159], a[28:31], v[208:223]
  ds_read_b64_tr_b16 v[148:149], v23 offset:20480
  ds_read_b64_tr_b16 v[150:151], v23 offset:20992
  v_rcp_f32 v87, v87
  v_mul_f32_e64 v162, v162, v86
  s_waitcnt lgkmcnt(8)
  v_mfma_f32_32x32x16_bf16 v[192:207], v[128:131], a[32:35], v[192:207]
  ds_read_b64_tr_b16 v[152:153], v19 offset:22528
  ds_read_b64_tr_b16 v[154:155], v19 offset:23040
  buffer_load_dwordx4 v17, s[16:19], s68 offen offset:3072 lds
  v_mul_f32 v163, v163, v87
  v_mul_f32 v84, v164, v164
  v_mul_f32_e64 v85, v165, v165
  v_mfma_f32_32x32x16_bf16 v[208:223], v[132:135], a[32:35], v[208:223]
  ds_read_b64_tr_b16 v[156:157], v23 offset:22528
  ds_read_b64_tr_b16 v[158:159], v23 offset:23040
  v_fma_f32 v84, v84, v80, v81
  v_fma_f32 v85, v85, v80, v81
  v_mul_f32 v84, v84, v164
  v_mul_f32 v85, v85, v165
  v_smfmac_f32_16x16x64_bf16 v[48:51], v[40:43], v[128:135], v44
  s_waitcnt lgkmcnt(8)
  s_nop 0
  v_smfmac_f32_16x16x64_bf16 v[48:51], v[40:43], v[136:143], v44
  v_mfma_f32_32x32x16_bf16 v[192:207], v[136:139], a[36:39], v[192:207]
  ds_read_b64_tr_b16 v[128:129], v20 offset:20480
  ds_read_b64_tr_b16 v[130:131], v20 offset:20992
  v_exp_f32 v84, v84
  v_exp_f32 v85, v85
  v_mfma_f32_32x32x16_bf16 v[208:223], v[140:143], a[36:39], v[208:223]
  ds_read_b64_tr_b16 v[132:133], v24 offset:20480
  ds_read_b64_tr_b16 v[134:135], v24 offset:20992
  s_mov_b32 s4, s100
  s_mov_b32 s5, s101
  s_mov_b32 s6, 8192
  s_waitcnt lgkmcnt(8)
  s_nop 0
  v_mfma_f32_32x32x16_bf16 v[192:207], v[144:147], a[40:43], v[192:207]
  ds_read_b64_tr_b16 v[136:137], v20 offset:22528
  ds_read_b64_tr_b16 v[138:139], v20 offset:23040
  v_fma_f32 v84, v84, v82, v82
  v_fma_f32 v85, v85, v82, v82
  v_rcp_f32_e64 v84, v84
  v_mfma_f32_32x32x16_bf16 v[208:223], v[148:151], a[40:43], v[208:223]
  ds_read_b64_tr_b16 v[140:141], v24 offset:22528
  ds_read_b64_tr_b16 v[142:143], v24 offset:23040
  v_rcp_f32 v85, v85
  v_mul_f32_e64 v164, v164, v84
  s_waitcnt lgkmcnt(8)
  v_mfma_f32_32x32x16_bf16 v[192:207], v[152:155], a[44:47], v[192:207]
  ds_read_b64_tr_b16 v[144:145], v21 offset:20480
  ds_read_b64_tr_b16 v[146:147], v21 offset:20992
  v_lshrrev_b32 v2, 3, v0
  v_lshlrev_b32 v2, 10, v2
  buffer_load_dword v4, v2, s[4:7], 0 offen offset:0
  v_mul_f32_e64 v165, v165, v85
  v_mfma_f32_32x32x16_bf16 v[208:223], v[156:159], a[44:47], v[208:223]
  s_waitcnt vmcnt(23)
  s_barrier
  ds_read_b64_tr_b16 v[148:149], v25 offset:20480
  ds_read_b64_tr_b16 v[150:151], v25 offset:20992
  v_mul_f32 v86, v166, v166
  s_waitcnt lgkmcnt(8)
  v_mfma_f32_32x32x16_bf16 v[192:207], v[128:131], a[48:51], v[192:207]
  ds_read_b64_tr_b16 v[152:153], v21 offset:22528
  ds_read_b64_tr_b16 v[154:155], v21 offset:23040
  v_mul_f32 v87, v167, v167
  v_fma_f32 v86, v86, v80, v81
  v_fma_f32 v87, v87, v80, v81
  v_mul_f32 v86, v86, v166
  v_mfma_f32_32x32x16_bf16 v[208:223], v[132:135], a[48:51], v[208:223]
  ds_read_b64_tr_b16 v[156:157], v25 offset:22528
  ds_read_b64_tr_b16 v[158:159], v25 offset:23040
  s_mov_b32 m0, s40
  v_mul_f32_e64 v87, v87, v167
  s_waitcnt lgkmcnt(8)
  v_mfma_f32_32x32x16_bf16 v[192:207], v[136:139], a[52:55], v[192:207]
  ds_read_b64_tr_b16 v[128:129], v18 offset:4096
  ds_read_b64_tr_b16 v[130:131], v18 offset:4608
  v_exp_f32 v86, v86
  v_exp_f32 v87, v87
  v_mfma_f32_32x32x16_bf16 v[208:223], v[140:143], a[52:55], v[208:223]
  ds_read_b64_tr_b16 v[132:133], v22 offset:4096
  ds_read_b64_tr_b16 v[134:135], v22 offset:4608
  v_fma_f32 v86, v86, v82, v82
  v_fma_f32 v87, v87, v82, v82
  s_waitcnt lgkmcnt(8)
  s_nop 0
  v_mfma_f32_32x32x16_bf16 v[192:207], v[144:147], a[56:59], v[192:207]
  ds_read_b64_tr_b16 v[136:137], v18 offset:6144
  ds_read_b64_tr_b16 v[138:139], v18 offset:6656
  buffer_load_dwordx4 v14, s[16:19], s69 offen offset:0 lds
  v_rcp_f32_e64 v86, v86
  v_mfma_f32_32x32x16_bf16 v[208:223], v[148:151], a[56:59], v[208:223]
  ds_read_b64_tr_b16 v[140:141], v22 offset:6144
  ds_read_b64_tr_b16 v[142:143], v22 offset:6656
  v_rcp_f32 v87, v87
  v_mul_f32_e64 v166, v166, v86
  s_waitcnt lgkmcnt(8)
  v_mfma_f32_32x32x16_bf16 v[192:207], v[152:155], a[60:63], v[192:207]
  ds_read_b64_tr_b16 v[144:145], v19 offset:4096
  ds_read_b64_tr_b16 v[146:147], v19 offset:4608
  v_mul_f32 v167, v167, v87
  v_mul_f32 v84, v168, v168
  v_mul_f32_e64 v85, v169, v169
  v_fma_f32 v84, v84, v80, v81
  v_mfma_f32_32x32x16_bf16 v[208:223], v[156:159], a[60:63], v[208:223]
  ds_read_b64_tr_b16 v[148:149], v23 offset:4096
  ds_read_b64_tr_b16 v[150:151], v23 offset:4608
  buffer_load_dwordx4 v15, s[16:19], s69 offen offset:1024 lds
  v_fma_f32 v85, v85, v80, v81
  v_mul_f32 v84, v84, v168
  s_waitcnt lgkmcnt(8)
  v_mfma_f32_32x32x16_bf16 v[192:207], v[128:131], a[64:67], v[192:207]
  ds_read_b64_tr_b16 v[152:153], v19 offset:6144
  ds_read_b64_tr_b16 v[154:155], v19 offset:6656
  buffer_load_dwordx4 v16, s[16:19], s69 offen offset:2048 lds
  v_mul_f32 v85, v85, v169
  v_exp_f32 v84, v84
  v_mfma_f32_32x32x16_bf16 v[208:223], v[132:135], a[64:67], v[208:223]
  ds_read_b64_tr_b16 v[156:157], v23 offset:6144
  ds_read_b64_tr_b16 v[158:159], v23 offset:6656
  v_exp_f32_e64 v85, v85
  v_fma_f32 v84, v84, v82, v82
  v_fma_f32 v85, v85, v82, v82
  v_smfmac_f32_16x16x64_bf16 v[48:51], v[40:43], v[128:135], v44
  s_waitcnt lgkmcnt(8)
  s_nop 0
  v_smfmac_f32_16x16x64_bf16 v[48:51], v[40:43], v[136:143], v44
  v_mfma_f32_32x32x16_bf16 v[192:207], v[136:139], a[68:71], v[192:207]
  ds_read_b64_tr_b16 v[128:129], v20 offset:4096
  ds_read_b64_tr_b16 v[130:131], v20 offset:4608
  v_rcp_f32 v84, v84
  v_rcp_f32 v85, v85
  v_mfma_f32_32x32x16_bf16 v[208:223], v[140:143], a[68:71], v[208:223]
  ds_read_b64_tr_b16 v[132:133], v24 offset:4096
  ds_read_b64_tr_b16 v[134:135], v24 offset:4608
  buffer_load_dwordx4 v17, s[16:19], s69 offen offset:3072 lds
  v_mul_f32 v168, v168, v84
  v_mul_f32_e64 v169, v169, v85
  s_waitcnt lgkmcnt(8)
  v_mfma_f32_32x32x16_bf16 v[192:207], v[144:147], a[72:75], v[192:207]
  ds_read_b64_tr_b16 v[136:137], v20 offset:6144
  ds_read_b64_tr_b16 v[138:139], v20 offset:6656
  v_mul_f32 v86, v170, v170
  v_mul_f32 v87, v171, v171
  v_fma_f32 v86, v86, v80, v81
  v_fma_f32 v87, v87, v80, v81
  v_mfma_f32_32x32x16_bf16 v[208:223], v[148:151], a[72:75], v[208:223]
  ds_read_b64_tr_b16 v[140:141], v24 offset:6144
  ds_read_b64_tr_b16 v[142:143], v24 offset:6656
  v_mul_f32 v86, v86, v170
  v_mul_f32_e64 v87, v87, v171
  s_waitcnt lgkmcnt(8)
  v_mfma_f32_32x32x16_bf16 v[192:207], v[152:155], a[76:79], v[192:207]
  ds_read_b64_tr_b16 v[144:145], v21 offset:4096
  ds_read_b64_tr_b16 v[146:147], v21 offset:4608
  buffer_load_dword v4, v2, s[4:7], 0 offen offset:128
  v_exp_f32_e64 v86, v86
  v_mfma_f32_32x32x16_bf16 v[208:223], v[156:159], a[76:79], v[208:223]
  s_waitcnt vmcnt(24)
  s_barrier
  ds_read_b64_tr_b16 v[148:149], v25 offset:4096
  ds_read_b64_tr_b16 v[150:151], v25 offset:4608
  s_mov_b32 m0, s41
  s_waitcnt lgkmcnt(8)
  v_mfma_f32_32x32x16_bf16 v[192:207], v[128:131], a[80:83], v[192:207]
  ds_read_b64_tr_b16 v[152:153], v21 offset:6144
  ds_read_b64_tr_b16 v[154:155], v21 offset:6656
  v_exp_f32_e64 v87, v87
  v_fma_f32 v86, v86, v82, v82
  v_fma_f32 v87, v87, v82, v82
  v_mfma_f32_32x32x16_bf16 v[208:223], v[132:135], a[80:83], v[208:223]
  ds_read_b64_tr_b16 v[156:157], v25 offset:6144
  ds_read_b64_tr_b16 v[158:159], v25 offset:6656
  buffer_load_dwordx4 v14, s[16:19], s70 offen offset:0 lds
  v_rcp_f32 v86, v86
  s_waitcnt lgkmcnt(8)
  v_mfma_f32_32x32x16_bf16 v[192:207], v[136:139], a[84:87], v[192:207]
  ds_read_b64_tr_b16 v[128:129], v18 offset:24576
  ds_read_b64_tr_b16 v[130:131], v18 offset:25088
  v_rcp_f32 v87, v87
  v_mul_f32 v170, v170, v86
  v_mul_f32_e64 v171, v171, v87
  v_mfma_f32_32x32x16_bf16 v[208:223], v[140:143], a[84:87], v[208:223]
  ds_read_b64_tr_b16 v[132:133], v22 offset:24576
  ds_read_b64_tr_b16 v[134:135], v22 offset:25088
  v_mul_f32 v84, v172, v172
  v_mul_f32_e64 v85, v173, v173
  v_fma_f32 v84, v84, v80, v81
  s_waitcnt lgkmcnt(8)
  v_mfma_f32_32x32x16_bf16 v[192:207], v[144:147], a[88:91], v[192:207]
  ds_read_b64_tr_b16 v[136:137], v18 offset:26624
  ds_read_b64_tr_b16 v[138:139], v18 offset:27136
  buffer_load_dwordx4 v15, s[16:19], s70 offen offset:1024 lds
  v_fma_f32 v85, v85, v80, v81
  v_mul_f32 v84, v84, v172
  v_mul_f32 v85, v85, v173
  v_mfma_f32_32x32x16_bf16 v[208:223], v[148:151], a[88:91], v[208:223]
  ds_read_b64_tr_b16 v[140:141], v22 offset:26624
  ds_read_b64_tr_b16 v[142:143], v22 offset:27136
  v_exp_f32 v84, v84
  s_waitcnt lgkmcnt(8)
  v_mfma_f32_32x32x16_bf16 v[192:207], v[152:155], a[92:95], v[192:207]
  ds_read_b64_tr_b16 v[144:145], v19 offset:24576
  ds_read_b64_tr_b16 v[146:147], v19 offset:25088
  v_exp_f32_e64 v85, v85
  v_fma_f32 v84, v84, v82, v82
  v_fma_f32 v85, v85, v82, v82
  v_mfma_f32_32x32x16_bf16 v[208:223], v[156:159], a[92:95], v[208:223]
  ds_read_b64_tr_b16 v[148:149], v23 offset:24576
  ds_read_b64_tr_b16 v[150:151], v23 offset:25088
  buffer_load_dwordx4 v16, s[16:19], s70 offen offset:2048 lds
  v_rcp_f32 v84, v84
  s_waitcnt lgkmcnt(8)
  v_mfma_f32_32x32x16_bf16 v[192:207], v[128:131], a[96:99], v[192:207]
  ds_read_b64_tr_b16 v[152:153], v19 offset:26624
  ds_read_b64_tr_b16 v[154:155], v19 offset:27136
  buffer_load_dwordx4 v17, s[16:19], s70 offen offset:3072 lds
  v_rcp_f32 v85, v85
  v_mul_f32 v172, v172, v84
  v_mfma_f32_32x32x16_bf16 v[208:223], v[132:135], a[96:99], v[208:223]
  ds_read_b64_tr_b16 v[156:157], v23 offset:26624
  ds_read_b64_tr_b16 v[158:159], v23 offset:27136
  v_mul_f32 v173, v173, v85
  v_mul_f32 v86, v174, v174
  v_mul_f32_e64 v87, v175, v175
  v_fma_f32 v86, v86, v80, v81
  v_smfmac_f32_16x16x64_bf16 v[48:51], v[40:43], v[128:135], v44
  s_waitcnt lgkmcnt(8)
  s_nop 0
  v_smfmac_f32_16x16x64_bf16 v[48:51], v[40:43], v[136:143], v44
  v_mfma_f32_32x32x16_bf16 v[192:207], v[136:139], a[100:103], v[192:207]
  ds_read_b64_tr_b16 v[128:129], v20 offset:24576
  ds_read_b64_tr_b16 v[130:131], v20 offset:25088
  v_fma_f32 v87, v87, v80, v81
  v_mul_f32 v86, v86, v174
  v_mul_f32 v87, v87, v175
  v_mfma_f32_32x32x16_bf16 v[208:223], v[140:143], a[100:103], v[208:223]
  ds_read_b64_tr_b16 v[132:133], v24 offset:24576
  ds_read_b64_tr_b16 v[134:135], v24 offset:25088
  buffer_load_dword v4, v2, s[4:7], 0 offen offset:256
  v_exp_f32 v86, v86
  s_waitcnt lgkmcnt(8)
  v_mfma_f32_32x32x16_bf16 v[192:207], v[144:147], a[104:107], v[192:207]
  ds_read_b64_tr_b16 v[136:137], v20 offset:26624
  ds_read_b64_tr_b16 v[138:139], v20 offset:27136
  v_exp_f32_e64 v87, v87
  v_fma_f32 v86, v86, v82, v82
  v_fma_f32 v87, v87, v82, v82
  v_mfma_f32_32x32x16_bf16 v[208:223], v[148:151], a[104:107], v[208:223]
  ds_read_b64_tr_b16 v[140:141], v24 offset:26624
  ds_read_b64_tr_b16 v[142:143], v24 offset:27136
  v_rcp_f32 v86, v86
  s_waitcnt lgkmcnt(8)
  v_mfma_f32_32x32x16_bf16 v[192:207], v[152:155], a[108:111], v[192:207]
  ds_read_b64_tr_b16 v[144:145], v21 offset:24576
  ds_read_b64_tr_b16 v[146:147], v21 offset:25088
  v_rcp_f32 v87, v87
  v_mul_f32 v174, v174, v86
  v_mul_f32_e64 v175, v175, v87
  v_mfma_f32_32x32x16_bf16 v[208:223], v[156:159], a[108:111], v[208:223]
  s_waitcnt vmcnt(25)
  s_barrier
  ds_read_b64_tr_b16 v[148:149], v25 offset:24576
  ds_read_b64_tr_b16 v[150:151], v25 offset:25088
  v_mul_f32 v84, v176, v176
  s_waitcnt lgkmcnt(8)
  v_mfma_f32_32x32x16_bf16 v[192:207], v[128:131], a[112:115], v[192:207]
  ds_read_b64_tr_b16 v[152:153], v21 offset:26624
  ds_read_b64_tr_b16 v[154:155], v21 offset:27136
  v_mul_f32 v85, v177, v177
  v_fma_f32 v84, v84, v80, v81
  v_fma_f32 v85, v85, v80, v81
  v_mul_f32 v84, v84, v176
  v_mfma_f32_32x32x16_bf16 v[208:223], v[132:135], a[112:115], v[208:223]
  ds_read_b64_tr_b16 v[156:157], v25 offset:26624
  ds_read_b64_tr_b16 v[158:159], v25 offset:27136
  buffer_load_dword v4, v2, s[4:7], 0 offen offset:384
  v_mul_f32 v85, v85, v177
  s_waitcnt lgkmcnt(8)
  v_mfma_f32_32x32x16_bf16 v[192:207], v[136:139], a[116:119], v[192:207]
  ds_read_b64_tr_b16 v[128:129], v18 offset:28672
  ds_read_b64_tr_b16 v[130:131], v18 offset:29184
  v_exp_f32 v84, v84
  v_exp_f32 v85, v85
  v_mfma_f32_32x32x16_bf16 v[208:223], v[140:143], a[116:119], v[208:223]
  ds_read_b64_tr_b16 v[132:133], v22 offset:28672
  ds_read_b64_tr_b16 v[134:135], v22 offset:29184
  v_fma_f32 v84, v84, v82, v82
  v_fma_f32 v85, v85, v82, v82
  s_waitcnt lgkmcnt(8)
  s_nop 0
  v_mfma_f32_32x32x16_bf16 v[192:207], v[144:147], a[120:123], v[192:207]
  ds_read_b64_tr_b16 v[136:137], v18 offset:30720
  ds_read_b64_tr_b16 v[138:139], v18 offset:31232
  v_rcp_f32 v84, v84
  v_rcp_f32 v85, v85
  v_mfma_f32_32x32x16_bf16 v[208:223], v[148:151], a[120:123], v[208:223]
  ds_read_b64_tr_b16 v[140:141], v22 offset:30720
  ds_read_b64_tr_b16 v[142:143], v22 offset:31232
  v_mul_f32 v176, v176, v84
  v_mul_f32 v177, v177, v85
  v_mul_f32 v86, v178, v178
  s_waitcnt lgkmcnt(8)
  v_mfma_f32_32x32x16_bf16 v[192:207], v[152:155], a[124:127], v[192:207]
  ds_read_b64_tr_b16 v[144:145], v19 offset:28672
  ds_read_b64_tr_b16 v[146:147], v19 offset:29184
  v_mul_f32 v87, v179, v179
  v_fma_f32 v86, v86, v80, v81
  v_fma_f32 v87, v87, v80, v81
  v_mul_f32 v86, v86, v178
  v_mfma_f32_32x32x16_bf16 v[208:223], v[156:159], a[124:127], v[208:223]
  ds_read_b64_tr_b16 v[148:149], v23 offset:28672
  ds_read_b64_tr_b16 v[150:151], v23 offset:29184
  v_mul_f32 v87, v87, v179
  v_exp_f32_e64 v86, v86
  s_waitcnt lgkmcnt(8)
  v_mfma_f32_32x32x16_bf16 v[192:207], v[128:131], a[128:131], v[192:207]
  ds_read_b64_tr_b16 v[152:153], v19 offset:30720
  ds_read_b64_tr_b16 v[154:155], v19 offset:31232
  v_exp_f32_e64 v87, v87
  v_fma_f32 v86, v86, v82, v82
  v_fma_f32 v87, v87, v82, v82
  v_mfma_f32_32x32x16_bf16 v[208:223], v[132:135], a[128:131], v[208:223]
  ds_read_b64_tr_b16 v[156:157], v23 offset:30720
  ds_read_b64_tr_b16 v[158:159], v23 offset:31232
  v_rcp_f32 v86, v86
  v_rcp_f32 v87, v87
  v_smfmac_f32_16x16x64_bf16 v[48:51], v[40:43], v[128:135], v44
  s_waitcnt lgkmcnt(8)
  s_nop 0
  v_smfmac_f32_16x16x64_bf16 v[48:51], v[40:43], v[136:143], v44
  v_mfma_f32_32x32x16_bf16 v[192:207], v[136:139], a[132:135], v[192:207]
  ds_read_b64_tr_b16 v[128:129], v20 offset:28672
  ds_read_b64_tr_b16 v[130:131], v20 offset:29184
  v_mul_f32 v178, v178, v86
  v_mul_f32 v179, v179, v87
  v_add_f32 v78, v48, v49
  v_mul_f32 v84, v180, v180
  v_mfma_f32_32x32x16_bf16 v[208:223], v[140:143], a[132:135], v[208:223]
  ds_read_b64_tr_b16 v[132:133], v24 offset:28672
  ds_read_b64_tr_b16 v[134:135], v24 offset:29184
  ds_write_b32 v37, v78
  v_mov_b32 v48, 0
  v_mov_b32_e64 v49, 0
  s_waitcnt lgkmcnt(9)
  v_mfma_f32_32x32x16_bf16 v[192:207], v[144:147], a[136:139], v[192:207]
  ds_read_b64_tr_b16 v[136:137], v20 offset:30720
  ds_read_b64_tr_b16 v[138:139], v20 offset:31232
  v_mul_f32 v85, v181, v181
  v_fma_f32 v84, v84, v80, v81
  v_fma_f32 v85, v85, v80, v81
  v_mul_f32 v84, v84, v180
  v_mfma_f32_32x32x16_bf16 v[208:223], v[148:151], a[136:139], v[208:223]
  ds_read_b64_tr_b16 v[140:141], v24 offset:30720
  ds_read_b64_tr_b16 v[142:143], v24 offset:31232
  v_mul_f32 v85, v85, v181
  v_exp_f32_e64 v84, v84
  s_waitcnt lgkmcnt(9)
  v_mfma_f32_32x32x16_bf16 v[192:207], v[152:155], a[140:143], v[192:207]
  ds_read_b64_tr_b16 v[144:145], v21 offset:28672
  ds_read_b64_tr_b16 v[146:147], v21 offset:29184
  v_exp_f32_e64 v85, v85
  v_fma_f32 v84, v84, v82, v82
  v_fma_f32 v85, v85, v82, v82
  v_mfma_f32_32x32x16_bf16 v[208:223], v[156:159], a[140:143], v[208:223]
  s_waitcnt vmcnt(22) lgkmcnt(6)
  s_barrier
  ds_read2st64_b32 v[74:75], v38 offset1:160
  ds_read2st64_b32 v[76:77], v39 offset1:160
  ds_read_b64_tr_b16 v[148:149], v25 offset:28672
  ds_read_b64_tr_b16 v[150:151], v25 offset:29184
  v_mfma_f32_32x32x16_bf16 v[192:207], v[128:131], a[144:147], v[192:207]
  ds_read_b64_tr_b16 v[152:153], v21 offset:30720
  ds_read_b64_tr_b16 v[154:155], v21 offset:31232
  v_rcp_f32 v84, v84
  v_rcp_f32 v85, v85
  v_mfma_f32_32x32x16_bf16 v[208:223], v[132:135], a[144:147], v[208:223]
  ds_read_b64_tr_b16 v[156:157], v25 offset:30720
  ds_read_b64_tr_b16 v[158:159], v25 offset:31232
  v_mul_f32 v180, v180, v84
  v_mul_f32 v181, v181, v85
  v_mul_f32 v86, v182, v182
  s_waitcnt lgkmcnt(10)
  v_mfma_f32_32x32x16_bf16 v[192:207], v[136:139], a[148:151], v[192:207]
  ds_read_b64_tr_b16 v[128:129], v18 offset:8192
  ds_read_b64_tr_b16 v[130:131], v18 offset:8704
  v_mul_f32 v87, v183, v183
  v_fma_f32 v86, v86, v80, v81
  v_fma_f32 v87, v87, v80, v81
  v_mul_f32 v86, v86, v182
  v_mfma_f32_32x32x16_bf16 v[208:223], v[140:143], a[148:151], v[208:223]
  ds_read_b64_tr_b16 v[132:133], v22 offset:8192
  ds_read_b64_tr_b16 v[134:135], v22 offset:8704
  v_mul_f32 v87, v87, v183
  v_exp_f32_e64 v86, v86
  s_waitcnt lgkmcnt(8)
  v_mfma_f32_32x32x16_bf16 v[192:207], v[144:147], a[152:155], v[192:207]
  ds_read_b64_tr_b16 v[136:137], v18 offset:10240
  ds_read_b64_tr_b16 v[138:139], v18 offset:10752
  v_add_f32 v74, v74, v75
  v_add_f32 v76, v76, v77
  v_add_f32_e64 v74, v74, v76
  v_cvt_pk_bf16_f32 v75, v74, v74
  v_mfma_f32_32x32x16_bf16 v[208:223], v[148:151], a[152:155], v[208:223]
  ds_read_b64_tr_b16 v[140:141], v22 offset:10240
  ds_read_b64_tr_b16 v[142:143], v22 offset:10752
  v_and_b32 v75, 0xffff0000, v75
  v_sub_f32 v75, v74, v75
  v_cvt_pk_bf16_f32 v68, v74, v75
  s_waitcnt lgkmcnt(8)
  v_mfma_f32_32x32x16_bf16 v[192:207], v[152:155], a[156:159], v[192:207]
  ds_read_b64_tr_b16 v[144:145], v19 offset:8192
  ds_read_b64_tr_b16 v[146:147], v19 offset:8704
  v_cvt_pk_bf16_f32 v69, v74, v75
  v_exp_f32_e64 v87, v87
  v_fma_f32 v86, v86, v82, v82
  v_mfma_f32_32x32x16_bf16 v[208:223], v[156:159], a[156:159], v[208:223]
  ds_read_b64_tr_b16 v[148:149], v23 offset:8192
  ds_read_b64_tr_b16 v[150:151], v23 offset:8704
  v_fma_f32 v87, v87, v82, v82
  v_rcp_f32_e64 v86, v86
  v_mfma_f32_32x32x8_bf16 v[192:207], v[68:69], v[70:71], v[192:207]
  v_rcp_f32 v87, v87
  v_mul_f32 v182, v182, v86
  v_mul_f32_e64 v183, v183, v87
  v_mfma_f32_32x32x8_bf16 v[208:223], v[68:69], v[72:73], v[208:223]
  v_pk_mul_f32 v[102:103], v[160:161], v[160:161]
  v_pk_add_f32 v[100:101], v[160:161], v[162:163]
  v_pk_fma_f32 v[102:103], v[162:163], v[162:163], v[102:103]
  v_pk_add_f32 v[100:101], v[100:101], v[164:165]
  v_pk_fma_f32 v[102:103], v[164:165], v[164:165], v[102:103]
  v_pk_add_f32 v[100:101], v[100:101], v[166:167]
  v_pk_fma_f32 v[102:103], v[166:167], v[166:167], v[102:103]
  v_pk_add_f32 v[100:101], v[100:101], v[168:169]
  v_pk_fma_f32 v[102:103], v[168:169], v[168:169], v[102:103]
  v_pk_add_f32 v[100:101], v[100:101], v[170:171]
  v_pk_fma_f32 v[102:103], v[170:171], v[170:171], v[102:103]
  v_pk_add_f32 v[100:101], v[100:101], v[172:173]
  v_pk_fma_f32 v[102:103], v[172:173], v[172:173], v[102:103]
  v_pk_add_f32 v[100:101], v[100:101], v[174:175]
  v_pk_fma_f32 v[102:103], v[174:175], v[174:175], v[102:103]
  v_pk_mul_f32 v[106:107], v[176:177], v[176:177]
  v_pk_add_f32 v[104:105], v[176:177], v[178:179]
  v_pk_fma_f32 v[106:107], v[178:179], v[178:179], v[106:107]
  v_pk_add_f32 v[104:105], v[104:105], v[180:181]
  v_pk_fma_f32 v[106:107], v[180:181], v[180:181], v[106:107]
  v_pk_add_f32 v[104:105], v[104:105], v[182:183]
  v_pk_fma_f32 v[106:107], v[182:183], v[182:183], v[106:107]
  v_pk_mul_f32 v[84:85], v[184:185], v[184:185]
  v_pk_mul_f32 v[86:87], v[186:187], v[186:187]
  v_pk_mul_f32 v[88:89], v[188:189], v[188:189]
  v_pk_mul_f32 v[90:91], v[190:191], v[190:191]
  v_pk_fma_f32 v[84:85], v[84:85], v[80:81], v[80:81] op_sel:[0,0,1] op_sel_hi:[1,0,1]
  v_pk_fma_f32 v[86:87], v[86:87], v[80:81], v[80:81] op_sel:[0,0,1] op_sel_hi:[1,0,1]
  v_pk_fma_f32 v[88:89], v[88:89], v[80:81], v[80:81] op_sel:[0,0,1] op_sel_hi:[1,0,1]
  v_pk_fma_f32 v[90:91], v[90:91], v[80:81], v[80:81] op_sel:[0,0,1] op_sel_hi:[1,0,1]
  v_pk_mul_f32 v[84:85], v[84:85], v[184:185]
  v_pk_mul_f32 v[86:87], v[86:87], v[186:187]
  v_pk_mul_f32 v[88:89], v[88:89], v[188:189]
  v_pk_mul_f32 v[90:91], v[90:91], v[190:191]
  v_exp_f32 v84, v84
  v_exp_f32 v85, v85
  v_exp_f32 v86, v86
  v_exp_f32 v87, v87
  v_exp_f32 v88, v88
  v_exp_f32 v89, v89
  v_exp_f32 v90, v90
  v_exp_f32 v91, v91
  v_pk_fma_f32 v[84:85], v[84:85], v[82:83], v[82:83] op_sel_hi:[1,0,0]
  v_pk_fma_f32 v[86:87], v[86:87], v[82:83], v[82:83] op_sel_hi:[1,0,0]
  v_pk_fma_f32 v[88:89], v[88:89], v[82:83], v[82:83] op_sel_hi:[1,0,0]
  v_pk_fma_f32 v[90:91], v[90:91], v[82:83], v[82:83] op_sel_hi:[1,0,0]
  v_rcp_f32 v84, v84
  v_rcp_f32 v85, v85
  v_rcp_f32 v86, v86
  v_rcp_f32 v87, v87
  v_rcp_f32 v88, v88
  v_rcp_f32 v89, v89
  v_rcp_f32 v90, v90
  v_rcp_f32 v91, v91
  v_pk_mul_f32 v[184:185], v[184:185], v[84:85]
  v_pk_mul_f32 v[186:187], v[186:187], v[86:87]
  v_pk_mul_f32 v[188:189], v[188:189], v[88:89]
  v_pk_mul_f32 v[190:191], v[190:191], v[90:91]
  v_pk_add_f32 v[104:105], v[104:105], v[184:185]
  v_pk_fma_f32 v[106:107], v[184:185], v[184:185], v[106:107]
  v_pk_add_f32 v[104:105], v[104:105], v[186:187]
  v_pk_fma_f32 v[106:107], v[186:187], v[186:187], v[106:107]
  v_pk_add_f32 v[104:105], v[104:105], v[188:189]
  v_pk_fma_f32 v[106:107], v[188:189], v[188:189], v[106:107]
  v_pk_add_f32 v[104:105], v[104:105], v[190:191]
  v_pk_fma_f32 v[106:107], v[190:191], v[190:191], v[106:107]
  v_pk_mul_f32 v[84:85], v[192:193], v[192:193]
  v_pk_mul_f32 v[86:87], v[194:195], v[194:195]
  v_pk_mul_f32 v[88:89], v[196:197], v[196:197]
  v_pk_mul_f32 v[90:91], v[198:199], v[198:199]
  v_pk_fma_f32 v[84:85], v[84:85], v[80:81], v[80:81] op_sel:[0,0,1] op_sel_hi:[1,0,1]
  v_pk_fma_f32 v[86:87], v[86:87], v[80:81], v[80:81] op_sel:[0,0,1] op_sel_hi:[1,0,1]
  v_pk_fma_f32 v[88:89], v[88:89], v[80:81], v[80:81] op_sel:[0,0,1] op_sel_hi:[1,0,1]
  v_pk_fma_f32 v[90:91], v[90:91], v[80:81], v[80:81] op_sel:[0,0,1] op_sel_hi:[1,0,1]
  v_pk_mul_f32 v[84:85], v[84:85], v[192:193]
  v_pk_mul_f32 v[86:87], v[86:87], v[194:195]
  v_pk_mul_f32 v[88:89], v[88:89], v[196:197]
  v_pk_mul_f32 v[90:91], v[90:91], v[198:199]
  v_exp_f32 v84, v84
  v_exp_f32 v85, v85
  v_exp_f32 v86, v86
  v_exp_f32 v87, v87
  v_exp_f32 v88, v88
  v_exp_f32 v89, v89
  v_exp_f32 v90, v90
  v_exp_f32 v91, v91
  v_pk_fma_f32 v[84:85], v[84:85], v[82:83], v[82:83] op_sel_hi:[1,0,0]
  v_pk_fma_f32 v[86:87], v[86:87], v[82:83], v[82:83] op_sel_hi:[1,0,0]
  v_pk_fma_f32 v[88:89], v[88:89], v[82:83], v[82:83] op_sel_hi:[1,0,0]
  v_pk_fma_f32 v[90:91], v[90:91], v[82:83], v[82:83] op_sel_hi:[1,0,0]
  v_rcp_f32 v84, v84
  v_rcp_f32 v85, v85
  v_rcp_f32 v86, v86
  v_rcp_f32 v87, v87
  v_rcp_f32 v88, v88
  v_rcp_f32 v89, v89
  v_rcp_f32 v90, v90
  v_rcp_f32 v91, v91
  v_pk_mul_f32 v[192:193], v[192:193], v[84:85]
  v_pk_mul_f32 v[194:195], v[194:195], v[86:87]
  v_pk_mul_f32 v[196:197], v[196:197], v[88:89]
  v_pk_mul_f32 v[198:199], v[198:199], v[90:91]
  v_pk_add_f32 v[104:105], v[104:105], v[192:193]
  v_pk_fma_f32 v[106:107], v[192:193], v[192:193], v[106:107]
  v_pk_add_f32 v[104:105], v[104:105], v[194:195]
  v_pk_fma_f32 v[106:107], v[194:195], v[194:195], v[106:107]
  v_pk_add_f32 v[104:105], v[104:105], v[196:197]
  v_pk_fma_f32 v[106:107], v[196:197], v[196:197], v[106:107]
  v_pk_add_f32 v[104:105], v[104:105], v[198:199]
  v_pk_fma_f32 v[106:107], v[198:199], v[198:199], v[106:107]
  v_pk_mul_f32 v[84:85], v[200:201], v[200:201]
  v_pk_mul_f32 v[86:87], v[202:203], v[202:203]
  v_pk_mul_f32 v[88:89], v[204:205], v[204:205]
  v_pk_mul_f32 v[90:91], v[206:207], v[206:207]
  v_pk_fma_f32 v[84:85], v[84:85], v[80:81], v[80:81] op_sel:[0,0,1] op_sel_hi:[1,0,1]
  v_pk_fma_f32 v[86:87], v[86:87], v[80:81], v[80:81] op_sel:[0,0,1] op_sel_hi:[1,0,1]
  v_pk_fma_f32 v[88:89], v[88:89], v[80:81], v[80:81] op_sel:[0,0,1] op_sel_hi:[1,0,1]
  v_pk_fma_f32 v[90:91], v[90:91], v[80:81], v[80:81] op_sel:[0,0,1] op_sel_hi:[1,0,1]
  v_pk_mul_f32 v[84:85], v[84:85], v[200:201]
  v_pk_mul_f32 v[86:87], v[86:87], v[202:203]
  v_pk_mul_f32 v[88:89], v[88:89], v[204:205]
  v_pk_mul_f32 v[90:91], v[90:91], v[206:207]
  v_exp_f32 v84, v84
  v_exp_f32 v85, v85
  v_exp_f32 v86, v86
  v_exp_f32 v87, v87
  v_exp_f32 v88, v88
  v_exp_f32 v89, v89
  v_exp_f32 v90, v90
  v_exp_f32 v91, v91
  v_pk_fma_f32 v[84:85], v[84:85], v[82:83], v[82:83] op_sel_hi:[1,0,0]
  v_pk_fma_f32 v[86:87], v[86:87], v[82:83], v[82:83] op_sel_hi:[1,0,0]
  v_pk_fma_f32 v[88:89], v[88:89], v[82:83], v[82:83] op_sel_hi:[1,0,0]
  v_pk_fma_f32 v[90:91], v[90:91], v[82:83], v[82:83] op_sel_hi:[1,0,0]
  v_rcp_f32 v84, v84
  v_rcp_f32 v85, v85
  v_rcp_f32 v86, v86
  v_rcp_f32 v87, v87
  v_rcp_f32 v88, v88
  v_rcp_f32 v89, v89
  v_rcp_f32 v90, v90
  v_rcp_f32 v91, v91
  v_pk_mul_f32 v[200:201], v[200:201], v[84:85]
  v_pk_mul_f32 v[202:203], v[202:203], v[86:87]
  v_pk_mul_f32 v[204:205], v[204:205], v[88:89]
  v_pk_mul_f32 v[206:207], v[206:207], v[90:91]
  v_pk_add_f32 v[104:105], v[104:105], v[200:201]
  v_pk_fma_f32 v[106:107], v[200:201], v[200:201], v[106:107]
  v_pk_add_f32 v[104:105], v[104:105], v[202:203]
  v_pk_fma_f32 v[106:107], v[202:203], v[202:203], v[106:107]
  v_pk_add_f32 v[104:105], v[104:105], v[204:205]
  v_pk_fma_f32 v[106:107], v[204:205], v[204:205], v[106:107]
  v_pk_add_f32 v[104:105], v[104:105], v[206:207]
  v_pk_fma_f32 v[106:107], v[206:207], v[206:207], v[106:107]
  v_pk_mul_f32 v[84:85], v[208:209], v[208:209]
  v_pk_mul_f32 v[86:87], v[210:211], v[210:211]
  v_pk_mul_f32 v[88:89], v[212:213], v[212:213]
  v_pk_mul_f32 v[90:91], v[214:215], v[214:215]
  v_pk_fma_f32 v[84:85], v[84:85], v[80:81], v[80:81] op_sel:[0,0,1] op_sel_hi:[1,0,1]
  v_pk_fma_f32 v[86:87], v[86:87], v[80:81], v[80:81] op_sel:[0,0,1] op_sel_hi:[1,0,1]
  v_pk_fma_f32 v[88:89], v[88:89], v[80:81], v[80:81] op_sel:[0,0,1] op_sel_hi:[1,0,1]
  v_pk_fma_f32 v[90:91], v[90:91], v[80:81], v[80:81] op_sel:[0,0,1] op_sel_hi:[1,0,1]
  v_pk_mul_f32 v[84:85], v[84:85], v[208:209]
  v_pk_mul_f32 v[86:87], v[86:87], v[210:211]
  v_pk_mul_f32 v[88:89], v[88:89], v[212:213]
  v_pk_mul_f32 v[90:91], v[90:91], v[214:215]
  v_exp_f32 v84, v84
  v_exp_f32 v85, v85
  v_exp_f32 v86, v86
  v_exp_f32 v87, v87
  v_exp_f32 v88, v88
  v_exp_f32 v89, v89
  v_exp_f32 v90, v90
  v_exp_f32 v91, v91
  v_pk_fma_f32 v[84:85], v[84:85], v[82:83], v[82:83] op_sel_hi:[1,0,0]
  v_pk_fma_f32 v[86:87], v[86:87], v[82:83], v[82:83] op_sel_hi:[1,0,0]
  v_pk_fma_f32 v[88:89], v[88:89], v[82:83], v[82:83] op_sel_hi:[1,0,0]
  v_pk_fma_f32 v[90:91], v[90:91], v[82:83], v[82:83] op_sel_hi:[1,0,0]
  v_rcp_f32 v84, v84
  v_rcp_f32 v85, v85
  v_rcp_f32 v86, v86
  v_rcp_f32 v87, v87
  v_rcp_f32 v88, v88
  v_rcp_f32 v89, v89
  v_rcp_f32 v90, v90
  v_rcp_f32 v91, v91
  v_pk_mul_f32 v[208:209], v[208:209], v[84:85]
  v_pk_mul_f32 v[210:211], v[210:211], v[86:87]
  v_pk_mul_f32 v[212:213], v[212:213], v[88:89]
  v_pk_mul_f32 v[214:215], v[214:215], v[90:91]
  v_pk_add_f32 v[104:105], v[104:105], v[208:209]
  v_pk_fma_f32 v[106:107], v[208:209], v[208:209], v[106:107]
  v_pk_add_f32 v[104:105], v[104:105], v[210:211]
  v_pk_fma_f32 v[106:107], v[210:211], v[210:211], v[106:107]
  v_pk_add_f32 v[104:105], v[104:105], v[212:213]
  v_pk_fma_f32 v[106:107], v[212:213], v[212:213], v[106:107]
  v_pk_add_f32 v[104:105], v[104:105], v[214:215]
  v_pk_fma_f32 v[106:107], v[214:215], v[214:215], v[106:107]
  v_pk_mul_f32 v[84:85], v[216:217], v[216:217]
  v_pk_mul_f32 v[86:87], v[218:219], v[218:219]
  v_pk_mul_f32 v[88:89], v[220:221], v[220:221]
  v_pk_mul_f32 v[90:91], v[222:223], v[222:223]
  v_pk_fma_f32 v[84:85], v[84:85], v[80:81], v[80:81] op_sel:[0,0,1] op_sel_hi:[1,0,1]
  v_pk_fma_f32 v[86:87], v[86:87], v[80:81], v[80:81] op_sel:[0,0,1] op_sel_hi:[1,0,1]
  v_pk_fma_f32 v[88:89], v[88:89], v[80:81], v[80:81] op_sel:[0,0,1] op_sel_hi:[1,0,1]
  v_pk_fma_f32 v[90:91], v[90:91], v[80:81], v[80:81] op_sel:[0,0,1] op_sel_hi:[1,0,1]
  v_pk_mul_f32 v[84:85], v[84:85], v[216:217]
  v_pk_mul_f32 v[86:87], v[86:87], v[218:219]
  v_pk_mul_f32 v[88:89], v[88:89], v[220:221]
  v_pk_mul_f32 v[90:91], v[90:91], v[222:223]
  v_exp_f32 v84, v84
  v_exp_f32 v85, v85
  v_exp_f32 v86, v86
  v_exp_f32 v87, v87
  v_exp_f32 v88, v88
  v_exp_f32 v89, v89
  v_exp_f32 v90, v90
  v_exp_f32 v91, v91
  v_pk_fma_f32 v[84:85], v[84:85], v[82:83], v[82:83] op_sel_hi:[1,0,0]
  v_pk_fma_f32 v[86:87], v[86:87], v[82:83], v[82:83] op_sel_hi:[1,0,0]
  v_pk_fma_f32 v[88:89], v[88:89], v[82:83], v[82:83] op_sel_hi:[1,0,0]
  v_pk_fma_f32 v[90:91], v[90:91], v[82:83], v[82:83] op_sel_hi:[1,0,0]
  v_rcp_f32 v84, v84
  v_rcp_f32 v85, v85
  v_rcp_f32 v86, v86
  v_rcp_f32 v87, v87
  v_rcp_f32 v88, v88
  v_rcp_f32 v89, v89
  v_rcp_f32 v90, v90
  v_rcp_f32 v91, v91
  v_pk_mul_f32 v[216:217], v[216:217], v[84:85]
  v_pk_mul_f32 v[218:219], v[218:219], v[86:87]
  v_pk_mul_f32 v[220:221], v[220:221], v[88:89]
  v_pk_mul_f32 v[222:223], v[222:223], v[90:91]
  v_pk_add_f32 v[104:105], v[104:105], v[216:217]
  v_pk_fma_f32 v[106:107], v[216:217], v[216:217], v[106:107]
  v_pk_add_f32 v[104:105], v[104:105], v[218:219]
  v_pk_fma_f32 v[106:107], v[218:219], v[218:219], v[106:107]
  v_pk_add_f32 v[104:105], v[104:105], v[220:221]
  v_pk_fma_f32 v[106:107], v[220:221], v[220:221], v[106:107]
  v_pk_add_f32 v[104:105], v[104:105], v[222:223]
  v_pk_fma_f32 v[106:107], v[222:223], v[222:223], v[106:107]
  v_add_f32 v100, v100, v101
  v_add_f32 v102, v102, v103
  v_add_f32 v104, v104, v105
  v_add_f32 v105, v106, v107
  v_fmac_f32 v104, s83, v100
  v_fmac_f32 v105, s83, v102
  v_mov_b32 v106, v104
  v_mov_b32 v107, v105
  s_lshl_b32 s32, s30, 10
  s_add_u32 s32, s32, s93
  v_permlane32_swap_b32 v104, v106
  v_permlane32_swap_b32 v105, v107
  s_add_u32 s33, s93, 4096
  s_add_u32 s34, s92, 262144
  v_pk_add_f32 v[104:105], v[104:105], v[106:107]
  buffer_store_dwordx2 v[104:105], v120, s[12:15], s32 offen sc1
  s_cmp_lg_u32 s30, 0
  s_cbranch_scc1 K1_C1
  v_cvt_pk_bf16_f32 v84, v160, v161
  v_cvt_pk_bf16_f32 v85, v162, v163
  v_cvt_pk_bf16_f32 v86, v164, v165
  v_cvt_pk_bf16_f32 v87, v166, v167
  buffer_store_dwordx4 v[84:87], v1, s[12:15], s76 offen offset:0 sc1
  v_cvt_pk_bf16_f32 v88, v168, v169
  v_cvt_pk_bf16_f32 v89, v170, v171
  v_cvt_pk_bf16_f32 v90, v172, v173
  v_cvt_pk_bf16_f32 v91, v174, v175
  buffer_store_dwordx4 v[88:91], v1, s[12:15], s76 offen offset:1024 sc1
  s_nop 1
K1_C1:
  s_waitcnt lgkmcnt(8)
  v_mfma_f32_32x32x16_bf16 v[224:239], v[128:131], a[0:3], 0
  ds_read_b64_tr_b16 v[152:153], v19 offset:10240
  ds_read_b64_tr_b16 v[154:155], v19 offset:10752
  v_mfma_f32_32x32x16_bf16 v[240:255], v[132:135], a[0:3], 0
  ds_read_b64_tr_b16 v[156:157], v23 offset:10240
  ds_read_b64_tr_b16 v[158:159], v23 offset:10752
  v_smfmac_f32_16x16x64_bf16 v[48:51], v[40:43], v[128:135], v44
  s_waitcnt lgkmcnt(8)
  s_nop 0
  v_smfmac_f32_16x16x64_bf16 v[48:51], v[40:43], v[136:143], v44
  v_mfma_f32_32x32x16_bf16 v[224:239], v[136:139], a[4:7], v[224:239]
  ds_read_b64_tr_b16 v[128:129], v20 offset:8192
  ds_read_b64_tr_b16 v[130:131], v20 offset:8704
  v_mfma_f32_32x32x16_bf16 v[240:255], v[140:143], a[4:7], v[240:255]
  ds_read_b64_tr_b16 v[132:133], v24 offset:8192
  ds_read_b64_tr_b16 v[134:135], v24 offset:8704
  s_waitcnt lgkmcnt(8)
  s_nop 0
  v_mfma_f32_32x32x16_bf16 v[224:239], v[144:147], a[8:11], v[224:239]
  ds_read_b64_tr_b16 v[136:137], v20 offset:10240
  ds_read_b64_tr_b16 v[138:139], v20 offset:10752
  v_mfma_f32_32x32x16_bf16 v[240:255], v[148:151], a[8:11], v[240:255]
  ds_read_b64_tr_b16 v[140:141], v24 offset:10240
  ds_read_b64_tr_b16 v[142:143], v24 offset:10752
  s_waitcnt lgkmcnt(8)
  s_nop 0
  v_mfma_f32_32x32x16_bf16 v[224:239], v[152:155], a[12:15], v[224:239]
  ds_read_b64_tr_b16 v[144:145], v21 offset:8192
  ds_read_b64_tr_b16 v[146:147], v21 offset:8704
  v_mfma_f32_32x32x16_bf16 v[240:255], v[156:159], a[12:15], v[240:255]
  s_waitcnt vmcnt(19)
  s_barrier
  ds_read_b64_tr_b16 v[148:149], v25 offset:8192
  ds_read_b64_tr_b16 v[150:151], v25 offset:8704
  s_waitcnt lgkmcnt(8)
  s_nop 0
  v_mfma_f32_32x32x16_bf16 v[224:239], v[128:131], a[16:19], v[224:239]
  ds_read_b64_tr_b16 v[152:153], v21 offset:10240
  ds_read_b64_tr_b16 v[154:155], v21 offset:10752
  v_mfma_f32_32x32x16_bf16 v[240:255], v[132:135], a[16:19], v[240:255]
  ds_read_b64_tr_b16 v[156:157], v25 offset:10240
  ds_read_b64_tr_b16 v[158:159], v25 offset:10752
  s_waitcnt lgkmcnt(8)
  s_nop 0
  v_mfma_f32_32x32x16_bf16 v[224:239], v[136:139], a[20:23], v[224:239]
  ds_read_b64_tr_b16 v[128:129], v18 offset:12288
  ds_read_b64_tr_b16 v[130:131], v18 offset:12800
  v_mfma_f32_32x32x16_bf16 v[240:255], v[140:143], a[20:23], v[240:255]
  ds_read_b64_tr_b16 v[132:133], v22 offset:12288
  ds_read_b64_tr_b16 v[134:135], v22 offset:12800
  s_waitcnt lgkmcnt(8)
  s_nop 0
  v_mfma_f32_32x32x16_bf16 v[224:239], v[144:147], a[24:27], v[224:239]
  ds_read_b64_tr_b16 v[136:137], v18 offset:14336
  ds_read_b64_tr_b16 v[138:139], v18 offset:14848
  v_mfma_f32_32x32x16_bf16 v[240:255], v[148:151], a[24:27], v[240:255]
  ds_read_b64_tr_b16 v[140:141], v22 offset:14336
  ds_read_b64_tr_b16 v[142:143], v22 offset:14848
  s_waitcnt lgkmcnt(8)
  s_nop 0
  v_mfma_f32_32x32x16_bf16 v[224:239], v[152:155], a[28:31], v[224:239]
  ds_read_b64_tr_b16 v[144:145], v19 offset:12288
  ds_read_b64_tr_b16 v[146:147], v19 offset:12800
  v_mfma_f32_32x32x16_bf16 v[240:255], v[156:159], a[28:31], v[240:255]
  ds_read_b64_tr_b16 v[148:149], v23 offset:12288
  ds_read_b64_tr_b16 v[150:151], v23 offset:12800
  s_waitcnt lgkmcnt(8)
  s_nop 0
  v_mfma_f32_32x32x16_bf16 v[224:239], v[128:131], a[32:35], v[224:239]
  ds_read_b64_tr_b16 v[152:153], v19 offset:14336
  ds_read_b64_tr_b16 v[154:155], v19 offset:14848
  v_mfma_f32_32x32x16_bf16 v[240:255], v[132:135], a[32:35], v[240:255]
  ds_read_b64_tr_b16 v[156:157], v23 offset:14336
  ds_read_b64_tr_b16 v[158:159], v23 offset:14848
  v_smfmac_f32_16x16x64_bf16 v[48:51], v[40:43], v[128:135], v44
  s_waitcnt lgkmcnt(8)
  s_nop 0
  v_smfmac_f32_16x16x64_bf16 v[48:51], v[40:43], v[136:143], v44
  v_mfma_f32_32x32x16_bf16 v[224:239], v[136:139], a[36:39], v[224:239]
  ds_read_b64_tr_b16 v[128:129], v20 offset:12288
  ds_read_b64_tr_b16 v[130:131], v20 offset:12800
  v_mfma_f32_32x32x16_bf16 v[240:255], v[140:143], a[36:39], v[240:255]
  ds_read_b64_tr_b16 v[132:133], v24 offset:12288
  ds_read_b64_tr_b16 v[134:135], v24 offset:12800
  s_waitcnt lgkmcnt(8)
  s_nop 0
  v_mfma_f32_32x32x16_bf16 v[224:239], v[144:147], a[40:43], v[224:239]
  ds_read_b64_tr_b16 v[136:137], v20 offset:14336
  ds_read_b64_tr_b16 v[138:139], v20 offset:14848
  v_mfma_f32_32x32x16_bf16 v[240:255], v[148:151], a[40:43], v[240:255]
  ds_read_b64_tr_b16 v[140:141], v24 offset:14336
  ds_read_b64_tr_b16 v[142:143], v24 offset:14848
  s_waitcnt lgkmcnt(8)
  s_nop 0
  v_mfma_f32_32x32x16_bf16 v[224:239], v[152:155], a[44:47], v[224:239]
  ds_read_b64_tr_b16 v[144:145], v21 offset:12288
  ds_read_b64_tr_b16 v[146:147], v21 offset:12800
  v_mfma_f32_32x32x16_bf16 v[240:255], v[156:159], a[44:47], v[240:255]
  s_waitcnt vmcnt(13)
  s_barrier
  ds_read_b64_tr_b16 v[148:149], v25 offset:12288
  ds_read_b64_tr_b16 v[150:151], v25 offset:12800
  s_waitcnt lgkmcnt(8)
  s_nop 0
  v_mfma_f32_32x32x16_bf16 v[224:239], v[128:131], a[48:51], v[224:239]
  ds_read_b64_tr_b16 v[152:153], v21 offset:14336
  ds_read_b64_tr_b16 v[154:155], v21 offset:14848
  v_mfma_f32_32x32x16_bf16 v[240:255], v[132:135], a[48:51], v[240:255]
  ds_read_b64_tr_b16 v[156:157], v25 offset:14336
  ds_read_b64_tr_b16 v[158:159], v25 offset:14848
  s_waitcnt lgkmcnt(8)
  s_nop 0
  v_mfma_f32_32x32x16_bf16 v[224:239], v[136:139], a[52:55], v[224:239]
  ds_read_b64_tr_b16 v[128:129], v18 offset:0
  ds_read_b64_tr_b16 v[130:131], v18 offset:512
  v_mfma_f32_32x32x16_bf16 v[240:255], v[140:143], a[52:55], v[240:255]
  ds_read_b64_tr_b16 v[132:133], v22 offset:0
  ds_read_b64_tr_b16 v[134:135], v22 offset:512
  s_waitcnt lgkmcnt(8)
  s_nop 0
  v_mfma_f32_32x32x16_bf16 v[224:239], v[144:147], a[56:59], v[224:239]
  ds_read_b64_tr_b16 v[136:137], v18 offset:2048
  ds_read_b64_tr_b16 v[138:139], v18 offset:2560
  v_mfma_f32_32x32x16_bf16 v[240:255], v[148:151], a[56:59], v[240:255]
  ds_read_b64_tr_b16 v[140:141], v22 offset:2048
  ds_read_b64_tr_b16 v[142:143], v22 offset:2560
  s_waitcnt lgkmcnt(8)
  s_nop 0
  v_mfma_f32_32x32x16_bf16 v[224:239], v[152:155], a[60:63], v[224:239]
  ds_read_b64_tr_b16 v[144:145], v19 offset:0
  ds_read_b64_tr_b16 v[146:147], v19 offset:512
  v_mfma_f32_32x32x16_bf16 v[240:255], v[156:159], a[60:63], v[240:255]
  ds_read_b64_tr_b16 v[148:149], v23 offset:0
  ds_read_b64_tr_b16 v[150:151], v23 offset:512
  s_waitcnt lgkmcnt(8)
  s_nop 0
  v_mfma_f32_32x32x16_bf16 v[224:239], v[128:131], a[64:67], v[224:239]
  ds_read_b64_tr_b16 v[152:153], v19 offset:2048
  ds_read_b64_tr_b16 v[154:155], v19 offset:2560
  ds_read_b64_tr_b16 v[112:113], v18 offset:36864
  ds_read_b64_tr_b16 v[114:115], v18 offset:37376
  ds_read_b64_tr_b16 v[116:117], v22 offset:36864
  ds_read_b64_tr_b16 v[118:119], v22 offset:37376
  v_mfma_f32_32x32x16_bf16 v[240:255], v[132:135], a[64:67], v[240:255]
  ds_read_b64_tr_b16 v[156:157], v23 offset:2048
  ds_read_b64_tr_b16 v[158:159], v23 offset:2560
  s_add_u32 s80, s81, 96256
  v_smfmac_f32_16x16x64_bf16 v[48:51], v[40:43], v[128:135], v44
  s_waitcnt lgkmcnt(12)
  s_nop 0
  v_smfmac_f32_16x16x64_bf16 v[48:51], v[40:43], v[136:143], v44
  v_mfma_f32_32x32x16_bf16 v[224:239], v[136:139], a[68:71], v[224:239]
  ds_read_b64_tr_b16 v[128:129], v20 offset:0
  ds_read_b64_tr_b16 v[130:131], v20 offset:512
  s_waitcnt vmcnt(0)
  buffer_atomic_add v83, v121, s[24:27], s29 offen sc1
  s_nop 0
  v_mfma_f32_32x32x16_bf16 v[240:255], v[140:143], a[68:71], v[240:255]
  ds_read_b64_tr_b16 v[132:133], v24 offset:0
  ds_read_b64_tr_b16 v[134:135], v24 offset:512
  s_waitcnt lgkmcnt(12)
  s_nop 0
  v_mfma_f32_32x32x16_bf16 v[224:239], v[144:147], a[72:75], v[224:239]
  ds_read_b64_tr_b16 v[136:137], v20 offset:2048
  ds_read_b64_tr_b16 v[138:139], v20 offset:2560
  v_mfma_f32_32x32x16_bf16 v[240:255], v[148:151], a[72:75], v[240:255]
  ds_read_b64_tr_b16 v[140:141], v24 offset:2048
  ds_read_b64_tr_b16 v[142:143], v24 offset:2560
  s_waitcnt lgkmcnt(8)
  s_nop 0
  v_mfma_f32_32x32x16_bf16 v[224:239], v[152:155], a[76:79], v[224:239]
  ds_read_b64_tr_b16 v[144:145], v21 offset:0
  ds_read_b64_tr_b16 v[146:147], v21 offset:512
  buffer_store_dwordx4 v[112:115], v36, s[12:15], s81 offen sc1
  buffer_store_dwordx4 v[116:119], v36, s[12:15], s80 offen sc1
  v_mfma_f32_32x32x16_bf16 v[240:255], v[156:159], a[76:79], v[240:255]
  s_barrier
  ds_read_b64_tr_b16 v[148:149], v25 offset:0
  ds_read_b64_tr_b16 v[150:151], v25 offset:512
  s_waitcnt lgkmcnt(8)
  v_mfma_f32_32x32x16_bf16 v[224:239], v[128:131], a[80:83], v[224:239]
  ds_read_b64_tr_b16 v[152:153], v21 offset:2048
  ds_read_b64_tr_b16 v[154:155], v21 offset:2560
  v_mfma_f32_32x32x16_bf16 v[240:255], v[132:135], a[80:83], v[240:255]
  ds_read_b64_tr_b16 v[156:157], v25 offset:2048
  ds_read_b64_tr_b16 v[158:159], v25 offset:2560
  s_waitcnt lgkmcnt(8)
  s_nop 0
  v_mfma_f32_32x32x16_bf16 v[224:239], v[136:139], a[84:87], v[224:239]
  ds_read_b64_tr_b16 v[128:129], v18 offset:16384
  ds_read_b64_tr_b16 v[130:131], v18 offset:16896
  v_mfma_f32_32x32x16_bf16 v[240:255], v[140:143], a[84:87], v[240:255]
  ds_read_b64_tr_b16 v[132:133], v22 offset:16384
  ds_read_b64_tr_b16 v[134:135], v22 offset:16896
  s_waitcnt lgkmcnt(8)
  s_nop 0
  v_mfma_f32_32x32x16_bf16 v[224:239], v[144:147], a[88:91], v[224:239]
  ds_read_b64_tr_b16 v[136:137], v18 offset:18432
  ds_read_b64_tr_b16 v[138:139], v18 offset:18944
  v_mfma_f32_32x32x16_bf16 v[240:255], v[148:151], a[88:91], v[240:255]
  ds_read_b64_tr_b16 v[140:141], v22 offset:18432
  ds_read_b64_tr_b16 v[142:143], v22 offset:18944
  s_waitcnt lgkmcnt(8)
  s_nop 0
  v_mfma_f32_32x32x16_bf16 v[224:239], v[152:155], a[92:95], v[224:239]
  ds_read_b64_tr_b16 v[144:145], v19 offset:16384
  ds_read_b64_tr_b16 v[146:147], v19 offset:16896
  v_mfma_f32_32x32x16_bf16 v[240:255], v[156:159], a[92:95], v[240:255]
  ds_read_b64_tr_b16 v[148:149], v23 offset:16384
  ds_read_b64_tr_b16 v[150:151], v23 offset:16896
  s_waitcnt lgkmcnt(8)
  s_nop 0
  v_mfma_f32_32x32x16_bf16 v[224:239], v[128:131], a[96:99], v[224:239]
  ds_read_b64_tr_b16 v[152:153], v19 offset:18432
  ds_read_b64_tr_b16 v[154:155], v19 offset:18944
  v_mfma_f32_32x32x16_bf16 v[240:255], v[132:135], a[96:99], v[240:255]
  ds_read_b64_tr_b16 v[156:157], v23 offset:18432
  ds_read_b64_tr_b16 v[158:159], v23 offset:18944
  v_smfmac_f32_16x16x64_bf16 v[48:51], v[40:43], v[128:135], v44
  s_waitcnt lgkmcnt(8)
  s_nop 0
  v_smfmac_f32_16x16x64_bf16 v[48:51], v[40:43], v[136:143], v44
  v_mfma_f32_32x32x16_bf16 v[224:239], v[136:139], a[100:103], v[224:239]
  ds_read_b64_tr_b16 v[128:129], v20 offset:16384
  ds_read_b64_tr_b16 v[130:131], v20 offset:16896
  v_mfma_f32_32x32x16_bf16 v[240:255], v[140:143], a[100:103], v[240:255]
  ds_read_b64_tr_b16 v[132:133], v24 offset:16384
  ds_read_b64_tr_b16 v[134:135], v24 offset:16896
  s_waitcnt lgkmcnt(8)
  s_nop 0
  v_mfma_f32_32x32x16_bf16 v[224:239], v[144:147], a[104:107], v[224:239]
  ds_read_b64_tr_b16 v[136:137], v20 offset:18432
  ds_read_b64_tr_b16 v[138:139], v20 offset:18944
  v_mfma_f32_32x32x16_bf16 v[240:255], v[148:151], a[104:107], v[240:255]
  ds_read_b64_tr_b16 v[140:141], v24 offset:18432
  ds_read_b64_tr_b16 v[142:143], v24 offset:18944
  s_waitcnt lgkmcnt(8)
  s_nop 0
  v_mfma_f32_32x32x16_bf16 v[224:239], v[152:155], a[108:111], v[224:239]
  ds_read_b64_tr_b16 v[144:145], v21 offset:16384
  ds_read_b64_tr_b16 v[146:147], v21 offset:16896
  v_mfma_f32_32x32x16_bf16 v[240:255], v[156:159], a[108:111], v[240:255]
  s_barrier
  ds_read_b64_tr_b16 v[148:149], v25 offset:16384
  ds_read_b64_tr_b16 v[150:151], v25 offset:16896
  s_waitcnt lgkmcnt(8)
  v_mfma_f32_32x32x16_bf16 v[224:239], v[128:131], a[112:115], v[224:239]
  ds_read_b64_tr_b16 v[152:153], v21 offset:18432
  ds_read_b64_tr_b16 v[154:155], v21 offset:18944
  v_mfma_f32_32x32x16_bf16 v[240:255], v[132:135], a[112:115], v[240:255]
  ds_read_b64_tr_b16 v[156:157], v25 offset:18432
  ds_read_b64_tr_b16 v[158:159], v25 offset:18944
  s_waitcnt lgkmcnt(8)
  s_nop 0
  v_mfma_f32_32x32x16_bf16 v[224:239], v[136:139], a[116:119], v[224:239]
  ds_read_b64_tr_b16 v[128:129], v18 offset:20480
  ds_read_b64_tr_b16 v[130:131], v18 offset:20992
  v_mfma_f32_32x32x16_bf16 v[240:255], v[140:143], a[116:119], v[240:255]
  ds_read_b64_tr_b16 v[132:133], v22 offset:20480
  ds_read_b64_tr_b16 v[134:135], v22 offset:20992
  s_waitcnt lgkmcnt(8)
  s_nop 0
  v_mfma_f32_32x32x16_bf16 v[224:239], v[144:147], a[120:123], v[224:239]
  ds_read_b64_tr_b16 v[136:137], v18 offset:22528
  ds_read_b64_tr_b16 v[138:139], v18 offset:23040
  v_mfma_f32_32x32x16_bf16 v[240:255], v[148:151], a[120:123], v[240:255]
  ds_read_b64_tr_b16 v[140:141], v22 offset:22528
  ds_read_b64_tr_b16 v[142:143], v22 offset:23040
  s_waitcnt lgkmcnt(8)
  s_nop 0
  v_mfma_f32_32x32x16_bf16 v[224:239], v[152:155], a[124:127], v[224:239]
  ds_read_b64_tr_b16 v[144:145], v19 offset:20480
  ds_read_b64_tr_b16 v[146:147], v19 offset:20992
  v_mfma_f32_32x32x16_bf16 v[240:255], v[156:159], a[124:127], v[240:255]
  ds_read_b64_tr_b16 v[148:149], v23 offset:20480
  ds_read_b64_tr_b16 v[150:151], v23 offset:20992
  s_waitcnt lgkmcnt(8)
  s_nop 0
  v_mfma_f32_32x32x16_bf16 v[224:239], v[128:131], a[128:131], v[224:239]
  ds_read_b64_tr_b16 v[152:153], v19 offset:22528
  ds_read_b64_tr_b16 v[154:155], v19 offset:23040
  v_mfma_f32_32x32x16_bf16 v[240:255], v[132:135], a[128:131], v[240:255]
  ds_read_b64_tr_b16 v[156:157], v23 offset:22528
  ds_read_b64_tr_b16 v[158:159], v23 offset:23040
  v_smfmac_f32_16x16x64_bf16 v[48:51], v[40:43], v[128:135], v44
  s_waitcnt lgkmcnt(8)
  s_nop 0
  v_smfmac_f32_16x16x64_bf16 v[48:51], v[40:43], v[136:143], v44
  v_mfma_f32_32x32x16_bf16 v[224:239], v[136:139], a[132:135], v[224:239]
  ds_read_b64_tr_b16 v[128:129], v20 offset:20480
  ds_read_b64_tr_b16 v[130:131], v20 offset:20992
  v_mfma_f32_32x32x16_bf16 v[240:255], v[140:143], a[132:135], v[240:255]
  ds_read_b64_tr_b16 v[132:133], v24 offset:20480
  ds_read_b64_tr_b16 v[134:135], v24 offset:20992
  v_add_f32 v78, v48, v49
  s_waitcnt lgkmcnt(8)
  v_mfma_f32_32x32x16_bf16 v[224:239], v[144:147], a[136:139], v[224:239]
  ds_read_b64_tr_b16 v[136:137], v20 offset:22528
  ds_read_b64_tr_b16 v[138:139], v20 offset:23040
  ds_write_b32 v37, v78
  v_mov_b32 v48, 0
  v_mov_b32 v49, 0
  v_mfma_f32_32x32x16_bf16 v[240:255], v[148:151], a[136:139], v[240:255]
  ds_read_b64_tr_b16 v[140:141], v24 offset:22528
  ds_read_b64_tr_b16 v[142:143], v24 offset:23040
  s_waitcnt lgkmcnt(9)
  s_nop 0
  v_mfma_f32_32x32x16_bf16 v[224:239], v[152:155], a[140:143], v[224:239]
  ds_read_b64_tr_b16 v[144:145], v21 offset:20480
  ds_read_b64_tr_b16 v[146:147], v21 offset:20992
  v_mfma_f32_32x32x16_bf16 v[240:255], v[156:159], a[140:143], v[240:255]
  s_waitcnt lgkmcnt(4)
  s_barrier
  ds_read2st64_b32 v[74:75], v38 offset1:160
  ds_read2st64_b32 v[76:77], v39 offset1:160
  ds_read_b64_tr_b16 v[148:149], v25 offset:20480
  ds_read_b64_tr_b16 v[150:151], v25 offset:20992
  v_mfma_f32_32x32x16_bf16 v[224:239], v[128:131], a[144:147], v[224:239]
  ds_read_b64_tr_b16 v[152:153], v21 offset:22528
  ds_read_b64_tr_b16 v[154:155], v21 offset:23040
  v_mfma_f32_32x32x16_bf16 v[240:255], v[132:135], a[144:147], v[240:255]
  ds_read_b64_tr_b16 v[156:157], v25 offset:22528
  ds_read_b64_tr_b16 v[158:159], v25 offset:23040
  s_waitcnt lgkmcnt(10)
  s_nop 0
  v_mfma_f32_32x32x16_bf16 v[224:239], v[136:139], a[148:151], v[224:239]
  v_mfma_f32_32x32x16_bf16 v[240:255], v[140:143], a[148:151], v[240:255]
  s_waitcnt lgkmcnt(4)
  s_nop 0
  v_mfma_f32_32x32x16_bf16 v[224:239], v[144:147], a[152:155], v[224:239]
  v_add_f32 v74, v74, v75
  v_add_f32 v76, v76, v77
  v_add_f32 v74, v74, v76
  v_cvt_pk_bf16_f32 v75, v74, v74
  v_and_b32 v75, 0xffff0000, v75
  v_sub_f32 v75, v74, v75
  v_mfma_f32_32x32x16_bf16 v[240:255], v[148:151], a[152:155], v[240:255]
  v_cvt_pk_bf16_f32 v68, v74, v75
  v_cvt_pk_bf16_f32 v69, v74, v75
  s_waitcnt lgkmcnt(0)
  s_nop 0
  v_mfma_f32_32x32x16_bf16 v[224:239], v[152:155], a[156:159], v[224:239]
  v_mfma_f32_32x32x16_bf16 v[240:255], v[156:159], a[156:159], v[240:255]
  v_mfma_f32_32x32x8_bf16 v[224:239], v[68:69], v[70:71], v[224:239]
  v_mfma_f32_32x32x8_bf16 v[240:255], v[68:69], v[72:73], v[240:255]
  buffer_load_dword v74, off, s[24:27], s29 sc1
  s_nop 2
  v_pk_mul_f32 v[84:85], v[224:225], v[224:225]
  v_pk_mul_f32 v[86:87], v[226:227], v[226:227]
  v_pk_mul_f32 v[88:89], v[228:229], v[228:229]
  v_pk_mul_f32 v[90:91], v[230:231], v[230:231]
  v_pk_fma_f32 v[84:85], v[84:85], v[80:81], v[80:81] op_sel:[0,0,1] op_sel_hi:[1,0,1]
  v_pk_fma_f32 v[86:87], v[86:87], v[80:81], v[80:81] op_sel:[0,0,1] op_sel_hi:[1,0,1]
  v_pk_fma_f32 v[88:89], v[88:89], v[80:81], v[80:81] op_sel:[0,0,1] op_sel_hi:[1,0,1]
  v_pk_fma_f32 v[90:91], v[90:91], v[80:81], v[80:81] op_sel:[0,0,1] op_sel_hi:[1,0,1]
  v_pk_mul_f32 v[84:85], v[84:85], v[224:225]
  v_pk_mul_f32 v[86:87], v[86:87], v[226:227]
  v_pk_mul_f32 v[88:89], v[88:89], v[228:229]
  v_pk_mul_f32 v[90:91], v[90:91], v[230:231]
  v_exp_f32 v84, v84
  v_exp_f32 v85, v85
  v_exp_f32 v86, v86
  v_exp_f32 v87, v87
  v_exp_f32 v88, v88
  v_exp_f32 v89, v89
  v_exp_f32 v90, v90
  v_exp_f32 v91, v91
  v_pk_fma_f32 v[84:85], v[84:85], v[82:83], v[82:83] op_sel_hi:[1,0,0]
  v_pk_fma_f32 v[86:87], v[86:87], v[82:83], v[82:83] op_sel_hi:[1,0,0]
  v_pk_fma_f32 v[88:89], v[88:89], v[82:83], v[82:83] op_sel_hi:[1,0,0]
  v_pk_fma_f32 v[90:91], v[90:91], v[82:83], v[82:83] op_sel_hi:[1,0,0]
  v_rcp_f32 v84, v84
  v_rcp_f32 v85, v85
  v_rcp_f32 v86, v86
  v_rcp_f32 v87, v87
  v_rcp_f32 v88, v88
  v_rcp_f32 v89, v89
  v_rcp_f32 v90, v90
  v_rcp_f32 v91, v91
  v_pk_mul_f32 v[224:225], v[224:225], v[84:85]
  v_pk_mul_f32 v[226:227], v[226:227], v[86:87]
  v_pk_mul_f32 v[228:229], v[228:229], v[88:89]
  v_pk_mul_f32 v[230:231], v[230:231], v[90:91]
  v_cvt_pk_bf16_f32 v224, v224, v225
  v_cvt_pk_bf16_f32 v225, v226, v227
  v_cvt_pk_bf16_f32 v226, v228, v229
  v_cvt_pk_bf16_f32 v227, v230, v231
  buffer_store_dwordx4 v[224:227], v1, s[12:15], s78 offen offset:0 sc1
  s_waitcnt vmcnt(1)
K1_POLL:
  v_readfirstlane_b32 s35, v74
  s_nop 0
  s_cmp_ge_u32 s35, 7
  s_cbranch_scc1 K1_GO
  buffer_load_dword v74, off, s[24:27], s29 sc1
  s_waitcnt vmcnt(0)
  s_branch K1_POLL
K1_GO:
  buffer_load_dwordx2 v[128:129], v120, s[12:15], s93 offen offset:0 sc1
  buffer_load_dwordx2 v[130:131], v120, s[12:15], s93 offen offset:1024 sc1
  buffer_load_dwordx2 v[132:133], v120, s[12:15], s93 offen offset:2048 sc1
  buffer_load_dwordx2 v[134:135], v120, s[12:15], s93 offen offset:3072 sc1
  buffer_load_dwordx2 v[136:137], v120, s[12:15], s33 offen offset:0 sc1
  buffer_load_dwordx2 v[138:139], v120, s[12:15], s33 offen offset:1024 sc1
  buffer_load_dwordx2 v[140:141], v120, s[12:15], s33 offen offset:2048 sc1
  v_pk_mul_f32 v[84:85], v[232:233], v[232:233]
  v_pk_mul_f32 v[86:87], v[234:235], v[234:235]
  v_pk_mul_f32 v[88:89], v[236:237], v[236:237]
  v_pk_mul_f32 v[90:91], v[238:239], v[238:239]
  v_pk_fma_f32 v[84:85], v[84:85], v[80:81], v[80:81] op_sel:[0,0,1] op_sel_hi:[1,0,1]
  v_pk_fma_f32 v[86:87], v[86:87], v[80:81], v[80:81] op_sel:[0,0,1] op_sel_hi:[1,0,1]
  v_pk_fma_f32 v[88:89], v[88:89], v[80:81], v[80:81] op_sel:[0,0,1] op_sel_hi:[1,0,1]
  v_pk_fma_f32 v[90:91], v[90:91], v[80:81], v[80:81] op_sel:[0,0,1] op_sel_hi:[1,0,1]
  v_pk_mul_f32 v[84:85], v[84:85], v[232:233]
  v_pk_mul_f32 v[86:87], v[86:87], v[234:235]
  v_pk_mul_f32 v[88:89], v[88:89], v[236:237]
  v_pk_mul_f32 v[90:91], v[90:91], v[238:239]
  v_exp_f32 v84, v84
  v_exp_f32 v85, v85
  v_exp_f32 v86, v86
  v_exp_f32 v87, v87
  v_exp_f32 v88, v88
  v_exp_f32 v89, v89
  v_exp_f32 v90, v90
  v_exp_f32 v91, v91
  v_pk_fma_f32 v[84:85], v[84:85], v[82:83], v[82:83] op_sel_hi:[1,0,0]
  v_pk_fma_f32 v[86:87], v[86:87], v[82:83], v[82:83] op_sel_hi:[1,0,0]
  v_pk_fma_f32 v[88:89], v[88:89], v[82:83], v[82:83] op_sel_hi:[1,0,0]
  v_pk_fma_f32 v[90:91], v[90:91], v[82:83], v[82:83] op_sel_hi:[1,0,0]
  v_rcp_f32 v84, v84
  v_rcp_f32 v85, v85
  v_rcp_f32 v86, v86
  v_rcp_f32 v87, v87
  v_rcp_f32 v88, v88
  v_rcp_f32 v89, v89
  v_rcp_f32 v90, v90
  v_rcp_f32 v91, v91
  v_pk_mul_f32 v[232:233], v[232:233], v[84:85]
  v_pk_mul_f32 v[234:235], v[234:235], v[86:87]
  v_pk_mul_f32 v[236:237], v[236:237], v[88:89]
  v_pk_mul_f32 v[238:239], v[238:239], v[90:91]
  v_cvt_pk_bf16_f32 v232, v232, v233
  v_cvt_pk_bf16_f32 v233, v234, v235
  v_cvt_pk_bf16_f32 v234, v236, v237
  v_cvt_pk_bf16_f32 v235, v238, v239
  buffer_store_dwordx4 v[232:235], v1, s[12:15], s78 offen offset:1024 sc1
  v_pk_mul_f32 v[84:85], v[240:241], v[240:241]
  v_pk_mul_f32 v[86:87], v[242:243], v[242:243]
  v_pk_mul_f32 v[88:89], v[244:245], v[244:245]
  v_pk_mul_f32 v[90:91], v[246:247], v[246:247]
  v_pk_fma_f32 v[84:85], v[84:85], v[80:81], v[80:81] op_sel:[0,0,1] op_sel_hi:[1,0,1]
  v_pk_fma_f32 v[86:87], v[86:87], v[80:81], v[80:81] op_sel:[0,0,1] op_sel_hi:[1,0,1]
  v_pk_fma_f32 v[88:89], v[88:89], v[80:81], v[80:81] op_sel:[0,0,1] op_sel_hi:[1,0,1]
  v_pk_fma_f32 v[90:91], v[90:91], v[80:81], v[80:81] op_sel:[0,0,1] op_sel_hi:[1,0,1]
  v_pk_mul_f32 v[84:85], v[84:85], v[240:241]
  v_pk_mul_f32 v[86:87], v[86:87], v[242:243]
  v_pk_mul_f32 v[88:89], v[88:89], v[244:245]
  v_pk_mul_f32 v[90:91], v[90:91], v[246:247]
  v_exp_f32 v84, v84
  v_exp_f32 v85, v85
  v_exp_f32 v86, v86
  v_exp_f32 v87, v87
  v_exp_f32 v88, v88
  v_exp_f32 v89, v89
  v_exp_f32 v90, v90
  v_exp_f32 v91, v91
  v_pk_fma_f32 v[84:85], v[84:85], v[82:83], v[82:83] op_sel_hi:[1,0,0]
  v_pk_fma_f32 v[86:87], v[86:87], v[82:83], v[82:83] op_sel_hi:[1,0,0]
  v_pk_fma_f32 v[88:89], v[88:89], v[82:83], v[82:83] op_sel_hi:[1,0,0]
  v_pk_fma_f32 v[90:91], v[90:91], v[82:83], v[82:83] op_sel_hi:[1,0,0]
  v_rcp_f32 v84, v84
  v_rcp_f32 v85, v85
  v_rcp_f32 v86, v86
  v_rcp_f32 v87, v87
  v_rcp_f32 v88, v88
  v_rcp_f32 v89, v89
  v_rcp_f32 v90, v90
  v_rcp_f32 v91, v91
  v_pk_mul_f32 v[240:241], v[240:241], v[84:85]
  v_pk_mul_f32 v[242:243], v[242:243], v[86:87]
  v_pk_mul_f32 v[244:245], v[244:245], v[88:89]
  v_pk_mul_f32 v[246:247], v[246:247], v[90:91]
  v_cvt_pk_bf16_f32 v240, v240, v241
  v_cvt_pk_bf16_f32 v241, v242, v243
  v_cvt_pk_bf16_f32 v242, v244, v245
  v_cvt_pk_bf16_f32 v243, v246, v247
  buffer_store_dwordx4 v[240:243], v1, s[12:15], s78 offen offset:2048 sc1
  v_pk_mul_f32 v[84:85], v[248:249], v[248:249]
  v_pk_mul_f32 v[86:87], v[250:251], v[250:251]
  v_pk_mul_f32 v[88:89], v[252:253], v[252:253]
  v_pk_mul_f32 v[90:91], v[254:255], v[254:255]
  v_pk_fma_f32 v[84:85], v[84:85], v[80:81], v[80:81] op_sel:[0,0,1] op_sel_hi:[1,0,1]
  v_pk_fma_f32 v[86:87], v[86:87], v[80:81], v[80:81] op_sel:[0,0,1] op_sel_hi:[1,0,1]
  v_pk_fma_f32 v[88:89], v[88:89], v[80:81], v[80:81] op_sel:[0,0,1] op_sel_hi:[1,0,1]
  v_pk_fma_f32 v[90:91], v[90:91], v[80:81], v[80:81] op_sel:[0,0,1] op_sel_hi:[1,0,1]
  v_pk_mul_f32 v[84:85], v[84:85], v[248:249]
  v_pk_mul_f32 v[86:87], v[86:87], v[250:251]
  v_pk_mul_f32 v[88:89], v[88:89], v[252:253]
  v_pk_mul_f32 v[90:91], v[90:91], v[254:255]
  v_exp_f32 v84, v84
  v_exp_f32 v85, v85
  v_exp_f32 v86, v86
  v_exp_f32 v87, v87
  v_exp_f32 v88, v88
  v_exp_f32 v89, v89
  v_exp_f32 v90, v90
  v_exp_f32 v91, v91
  v_pk_fma_f32 v[84:85], v[84:85], v[82:83], v[82:83] op_sel_hi:[1,0,0]
  v_pk_fma_f32 v[86:87], v[86:87], v[82:83], v[82:83] op_sel_hi:[1,0,0]
  v_pk_fma_f32 v[88:89], v[88:89], v[82:83], v[82:83] op_sel_hi:[1,0,0]
  v_pk_fma_f32 v[90:91], v[90:91], v[82:83], v[82:83] op_sel_hi:[1,0,0]
  v_rcp_f32 v84, v84
  v_rcp_f32 v85, v85
  v_rcp_f32 v86, v86
  v_rcp_f32 v87, v87
  v_rcp_f32 v88, v88
  v_rcp_f32 v89, v89
  v_rcp_f32 v90, v90
  v_rcp_f32 v91, v91
  v_pk_mul_f32 v[248:249], v[248:249], v[84:85]
  v_pk_mul_f32 v[250:251], v[250:251], v[86:87]
  v_pk_mul_f32 v[252:253], v[252:253], v[88:89]
  v_pk_mul_f32 v[254:255], v[254:255], v[90:91]
  v_cvt_pk_bf16_f32 v248, v248, v249
  v_cvt_pk_bf16_f32 v249, v250, v251
  v_cvt_pk_bf16_f32 v250, v252, v253
  v_cvt_pk_bf16_f32 v251, v254, v255
  buffer_store_dwordx4 v[248:251], v1, s[12:15], s78 offen offset:3072 sc1
  s_waitcnt vmcnt(3)
  v_pk_add_f32 v[128:129], v[128:129], v[130:131]
  v_pk_add_f32 v[132:133], v[132:133], v[134:135]
  v_pk_add_f32 v[136:137], v[136:137], v[138:139]
  v_pk_add_f32 v[128:129], v[128:129], v[132:133]
  v_pk_add_f32 v[136:137], v[136:137], v[140:141]
  v_pk_add_f32 v[128:129], v[128:129], v[136:137]
  v_mul_f32 v128, 0xba97b426, v128
  v_mul_f32 v129, 0x3a97b426, v129
  v_fma_f32 v129, -v128, v128, v129
  v_max_f32 v129, 0, v129
  v_add_f32 v129, 0x3727c5ac, v129
  v_rsq_f32 v129, v129
  s_nop 0
  v_mul_f32 v128, v128, v129
  v_pk_fma_f32 v[160:161], v[160:161], v[128:129], v[128:129] op_sel:[0,1,0] op_sel_hi:[1,1,0]
  v_pk_fma_f32 v[162:163], v[162:163], v[128:129], v[128:129] op_sel:[0,1,0] op_sel_hi:[1,1,0]
  v_pk_fma_f32 v[164:165], v[164:165], v[128:129], v[128:129] op_sel:[0,1,0] op_sel_hi:[1,1,0]
  v_pk_fma_f32 v[166:167], v[166:167], v[128:129], v[128:129] op_sel:[0,1,0] op_sel_hi:[1,1,0]
  v_cvt_pk_bf16_f32 v160, v160, v161
  v_cvt_pk_bf16_f32 v161, v162, v163
  v_cvt_pk_bf16_f32 v162, v164, v165
  v_cvt_pk_bf16_f32 v163, v166, v167
  v_pk_fma_f32 v[168:169], v[168:169], v[128:129], v[128:129] op_sel:[0,1,0] op_sel_hi:[1,1,0]
  v_pk_fma_f32 v[170:171], v[170:171], v[128:129], v[128:129] op_sel:[0,1,0] op_sel_hi:[1,1,0]
  v_pk_fma_f32 v[172:173], v[172:173], v[128:129], v[128:129] op_sel:[0,1,0] op_sel_hi:[1,1,0]
  v_pk_fma_f32 v[174:175], v[174:175], v[128:129], v[128:129] op_sel:[0,1,0] op_sel_hi:[1,1,0]
  v_cvt_pk_bf16_f32 v168, v168, v169
  v_cvt_pk_bf16_f32 v169, v170, v171
  v_cvt_pk_bf16_f32 v170, v172, v173
  v_cvt_pk_bf16_f32 v171, v174, v175
  v_pk_fma_f32 v[176:177], v[176:177], v[128:129], v[128:129] op_sel:[0,1,0] op_sel_hi:[1,1,0]
  v_pk_fma_f32 v[178:179], v[178:179], v[128:129], v[128:129] op_sel:[0,1,0] op_sel_hi:[1,1,0]
  v_pk_fma_f32 v[180:181], v[180:181], v[128:129], v[128:129] op_sel:[0,1,0] op_sel_hi:[1,1,0]
  v_pk_fma_f32 v[182:183], v[182:183], v[128:129], v[128:129] op_sel:[0,1,0] op_sel_hi:[1,1,0]
  v_cvt_pk_bf16_f32 v176, v176, v177
  v_cvt_pk_bf16_f32 v177, v178, v179
  v_cvt_pk_bf16_f32 v178, v180, v181
  v_cvt_pk_bf16_f32 v179, v182, v183
  v_pk_fma_f32 v[184:185], v[184:185], v[128:129], v[128:129] op_sel:[0,1,0] op_sel_hi:[1,1,0]
  v_pk_fma_f32 v[186:187], v[186:187], v[128:129], v[128:129] op_sel:[0,1,0] op_sel_hi:[1,1,0]
  v_pk_fma_f32 v[188:189], v[188:189], v[128:129], v[128:129] op_sel:[0,1,0] op_sel_hi:[1,1,0]
  v_pk_fma_f32 v[190:191], v[190:191], v[128:129], v[128:129] op_sel:[0,1,0] op_sel_hi:[1,1,0]
  v_cvt_pk_bf16_f32 v184, v184, v185
  v_cvt_pk_bf16_f32 v185, v186, v187
  v_cvt_pk_bf16_f32 v186, v188, v189
  v_cvt_pk_bf16_f32 v187, v190, v191
  ds_write_b128 v26, v[160:163] offset:32768
  ds_write_b128 v27, v[168:171] offset:32768
  ds_write_b128 v28, v[176:179] offset:32768
  ds_write_b128 v29, v[184:187] offset:32768
  ds_read_b64_tr_b16 v[164:165], v30 offset:32768
  ds_read_b64_tr_b16 v[166:167], v31 offset:33280
  ds_read_b64_tr_b16 v[172:173], v32 offset:33792
  ds_read_b64_tr_b16 v[174:175], v33 offset:34304
  ds_read_b64_tr_b16 v[180:181], v30 offset:34816
  ds_read_b64_tr_b16 v[182:183], v31 offset:35328
  ds_read_b64_tr_b16 v[188:189], v32 offset:35840
  ds_read_b64_tr_b16 v[190:191], v33 offset:36352
  v_pk_fma_f32 v[192:193], v[192:193], v[128:129], v[128:129] op_sel:[0,1,0] op_sel_hi:[1,1,0]
  v_pk_fma_f32 v[194:195], v[194:195], v[128:129], v[128:129] op_sel:[0,1,0] op_sel_hi:[1,1,0]
  v_pk_fma_f32 v[196:197], v[196:197], v[128:129], v[128:129] op_sel:[0,1,0] op_sel_hi:[1,1,0]
  v_pk_fma_f32 v[198:199], v[198:199], v[128:129], v[128:129] op_sel:[0,1,0] op_sel_hi:[1,1,0]
  v_cvt_pk_bf16_f32 v192, v192, v193
  v_cvt_pk_bf16_f32 v193, v194, v195
  v_cvt_pk_bf16_f32 v194, v196, v197
  v_cvt_pk_bf16_f32 v195, v198, v199
  v_pk_fma_f32 v[200:201], v[200:201], v[128:129], v[128:129] op_sel:[0,1,0] op_sel_hi:[1,1,0]
  v_pk_fma_f32 v[202:203], v[202:203], v[128:129], v[128:129] op_sel:[0,1,0] op_sel_hi:[1,1,0]
  v_pk_fma_f32 v[204:205], v[204:205], v[128:129], v[128:129] op_sel:[0,1,0] op_sel_hi:[1,1,0]
  v_pk_fma_f32 v[206:207], v[206:207], v[128:129], v[128:129] op_sel:[0,1,0] op_sel_hi:[1,1,0]
  v_cvt_pk_bf16_f32 v200, v200, v201
  v_cvt_pk_bf16_f32 v201, v202, v203
  v_cvt_pk_bf16_f32 v202, v204, v205
  v_cvt_pk_bf16_f32 v203, v206, v207
  v_pk_fma_f32 v[208:209], v[208:209], v[128:129], v[128:129] op_sel:[0,1,0] op_sel_hi:[1,1,0]
  v_pk_fma_f32 v[210:211], v[210:211], v[128:129], v[128:129] op_sel:[0,1,0] op_sel_hi:[1,1,0]
  v_pk_fma_f32 v[212:213], v[212:213], v[128:129], v[128:129] op_sel:[0,1,0] op_sel_hi:[1,1,0]
  v_pk_fma_f32 v[214:215], v[214:215], v[128:129], v[128:129] op_sel:[0,1,0] op_sel_hi:[1,1,0]
  v_cvt_pk_bf16_f32 v208, v208, v209
  v_cvt_pk_bf16_f32 v209, v210, v211
  v_cvt_pk_bf16_f32 v210, v212, v213
  v_cvt_pk_bf16_f32 v211, v214, v215
  v_pk_fma_f32 v[216:217], v[216:217], v[128:129], v[128:129] op_sel:[0,1,0] op_sel_hi:[1,1,0]
  v_pk_fma_f32 v[218:219], v[218:219], v[128:129], v[128:129] op_sel:[0,1,0] op_sel_hi:[1,1,0]
  v_pk_fma_f32 v[220:221], v[220:221], v[128:129], v[128:129] op_sel:[0,1,0] op_sel_hi:[1,1,0]
  v_pk_fma_f32 v[222:223], v[222:223], v[128:129], v[128:129] op_sel:[0,1,0] op_sel_hi:[1,1,0]
  v_cvt_pk_bf16_f32 v216, v216, v217
  v_cvt_pk_bf16_f32 v217, v218, v219
  v_cvt_pk_bf16_f32 v218, v220, v221
  v_cvt_pk_bf16_f32 v219, v222, v223
  ds_write_b128 v26, v[192:195] offset:16384
  ds_write_b128 v27, v[200:203] offset:16384
  ds_write_b128 v28, v[208:211] offset:16384
  ds_write_b128 v29, v[216:219] offset:16384
  ds_read_b64_tr_b16 v[196:197], v30 offset:16384
  ds_read_b64_tr_b16 v[198:199], v31 offset:16896
  ds_read_b64_tr_b16 v[204:205], v32 offset:17408
  ds_read_b64_tr_b16 v[206:207], v33 offset:17920
  ds_read_b64_tr_b16 v[212:213], v30 offset:18432
  ds_read_b64_tr_b16 v[214:215], v31 offset:18944
  ds_read_b64_tr_b16 v[220:221], v32 offset:19456
  ds_read_b64_tr_b16 v[222:223], v33 offset:19968
  s_cmp_eq_u32 s30, 0
  s_cselect_b32 exec_lo, 0, -1
  s_waitcnt lgkmcnt(15)
  buffer_store_dwordx4 v[164:167], v79, s[12:15], s92 offen offset:0 sc1
  buffer_store_dwordx4 v[172:175], v79, s[12:15], s92 offen offset:512 sc1
  s_waitcnt lgkmcnt(14)
  buffer_store_dwordx4 v[180:183], v79, s[12:15], s92 offen offset:1024 sc1
  s_waitcnt lgkmcnt(12)
  buffer_store_dwordx4 v[188:191], v79, s[12:15], s92 offen offset:1536 sc1
  s_mov_b32 exec_lo, -1
  s_waitcnt lgkmcnt(6)
  buffer_store_dwordx4 v[196:199], v79, s[12:15], s34 offen offset:0 sc1
  s_waitcnt lgkmcnt(4)
  buffer_store_dwordx4 v[204:207], v79, s[12:15], s34 offen offset:512 sc1
  s_waitcnt lgkmcnt(2)
  buffer_store_dwordx4 v[212:215], v79, s[12:15], s34 offen offset:1024 sc1
  s_waitcnt lgkmcnt(0)
  buffer_store_dwordx4 v[220:223], v79, s[12:15], s34 offen offset:1536 sc1
  v_mov_b32 v4, 0
  s_lshl_b32 s32, s2, 2
  s_add_u32 s32, s32, 26812416
  s_mov_b64 exec, 1
  buffer_store_dword v4, off, s[12:15], s32
  s_endpgm
K1_END:
  s_endpgm
.globl k23_kernel
.p2align 8
.type k23_kernel,@function
k23_kernel:
  s_cmp_ge_u32 s2, 256
  s_cbranch_scc1 K2_END
  s_load_dwordx2 s[8:9], s[0:1], 40
  s_load_dwordx2 s[16:17], s[0:1], 48
  s_load_dwordx2 s[4:5], s[0:1], 80
  s_load_dwordx2 s[12:13], s[0:1], 80
  s_load_dwordx2 s[64:65], s[0:1], 0
  s_load_dwordx2 s[68:69], s[0:1], 64
  s_getpc_b64 s[22:23]
K2_PC:
  v_lshlrev_b32 v16, 7, v0
  v_min_u32 v16, CODE_END-K2_PC-4, v16
  v_mov_b32 v17, s23
  v_add_co_u32 v16, vcc, s22, v16
  v_addc_co_u32 v17, vcc, 0, v17, vcc
  global_load_dword v18, v[16:17], off
  v_lshrrev_b32 v1, 6, v0
  v_and_b32 v0, 63, v0
  v_readfirstlane_b32 s20, v1
  s_mov_b32 s6, 268435456
  s_mov_b32 s7, 0x20000
  s_mov_b32 s10, 8388608
  s_mov_b32 s11, 0x20000
  s_mov_b32 s14, 268435456
  s_mov_b32 s15, 0x20000
  s_mov_b32 s18, 4096
  s_mov_b32 s19, 0x20000
  s_and_b32 s42, s2, 7
  s_lshl_b32 s42, s42, 2
  s_bfe_u32 s21, s2, 0x20003
  s_add_u32 s42, s42, s21
  s_lshr_b32 s43, s2, 5
  s_mov_b32 s30, 40960
  s_mul_i32 s46, s43, 983040
  s_lshr_b32 s21, s42, 1
  s_mul_i32 s21, s21, 2560
  s_and_b32 s22, s42, 1
  s_mul_i32 s23, s22, 1536
  s_add_u32 s23, s23, s21
  s_lshl_b32 s22, s22, 3
  s_add_u32 s21, s21, s22
  s_add_u32 s21, s21, 1024
  v_and_b32 v232, 31, v0
  v_lshrrev_b32 v233, 5, v0
  v_lshl_add_u32 v1, v0, 4, s23
  v_lshl_add_u32 v2, v232, 4, s21
  v_lshl_add_u32 v2, v233, 2, v2
  s_waitcnt lgkmcnt(0)
  buffer_load_dwordx4 v[108:111], v1, s[4:7], s30 offen
  buffer_load_dword v118, v2, s[4:7], s30 offen
  s_xor_b32 s21, s20, 0
  s_mul_i32 s21, s21, 245760
  s_add_u32 s21, s21, s46
  s_add_u32 s22, s21, 122880
  buffer_load_dwordx4 v[48:51], v1, s[4:7], s21 offen
  buffer_load_dword v80, v2, s[4:7], s21 offen
  buffer_load_dwordx4 v[52:55], v1, s[4:7], s22 offen
  buffer_load_dword v82, v2, s[4:7], s22 offen
  s_xor_b32 s21, s20, 1
  s_mul_i32 s21, s21, 245760
  s_add_u32 s21, s21, s46
  s_add_u32 s22, s21, 122880
  buffer_load_dwordx4 v[56:59], v1, s[4:7], s21 offen
  buffer_load_dword v84, v2, s[4:7], s21 offen
  buffer_load_dwordx4 v[60:63], v1, s[4:7], s22 offen
  buffer_load_dword v86, v2, s[4:7], s22 offen
  s_xor_b32 s21, s20, 2
  s_mul_i32 s21, s21, 245760
  s_add_u32 s21, s21, s46
  s_add_u32 s22, s21, 122880
  buffer_load_dwordx4 v[64:67], v1, s[4:7], s21 offen
  buffer_load_dword v88, v2, s[4:7], s21 offen
  buffer_load_dwordx4 v[68:71], v1, s[4:7], s22 offen
  buffer_load_dword v90, v2, s[4:7], s22 offen
  s_xor_b32 s21, s20, 3
  s_mul_i32 s21, s21, 245760
  s_add_u32 s21, s21, s46
  s_add_u32 s22, s21, 122880
  buffer_load_dwordx4 v[72:75], v1, s[4:7], s21 offen
  buffer_load_dword v92, v2, s[4:7], s21 offen
  buffer_load_dwordx4 v[76:79], v1, s[4:7], s22 offen
  buffer_load_dword v94, v2, s[4:7], s22 offen
  s_bfe_u32 s44, s2, 0x20001
  s_lshl_b32 s44, s44, 3
  s_bfe_u32 s21, s2, 0x30003
  s_add_u32 s44, s44, s21
  s_and_b32 s45, s2, 1
  s_lshl_b32 s45, s45, 2
  s_lshr_b32 s21, s2, 6
  s_add_u32 s45, s45, s21
  s_lshl_b32 s44, s44, 1
  s_and_b32 s21, s45, 1
  s_add_u32 s44, s44, s21
  s_lshl_b32 s28, s44, 17
  s_lshl_b32 s21, s20, 10
  s_add_u32 s28, s28, s21
  s_xor_b32 s29, s28, 0x20000
  s_lshl_b32 s31, s20, 15
  s_mov_b32 m0, s31
  v_lshrrev_b32 v234, 4, v0
  v_and_b32 v235, 7, v0
  v_xor_b32 v234, v234, v235
  v_lshrrev_b32 v235, 3, v0
  v_lshlrev_b32 v235, 12, v235
  v_lshl_add_u32 v5, v234, 4, v235
  v_xor_b32 v6, 64, v5
  v_add_u32 v6, 31744, v6
  v_add_u32 v7, 63488, v5
  v_add_u32 v8, 63488, v6
  s_mov_b32 s36, 4096
  s_mov_b32 s37, 122880
  s_mov_b32 s38, 128
  s_mov_b32 s39, 16384
  s_mov_b32 s40, 8192
  s_mov_b32 s41, 12288
  s_mov_b32 s47, 268435456
  s_mov_b32 s34, 0xfffff
  s_mov_b32 s35, 0xfffff
  s_mul_i32 s21, s20, 1966080
  s_add_u32 s30, s30, s21
  s_mul_i32 s24, s45, 393216
  s_lshl_b32 s21, s20, 15
  s_add_u32 s21, s21, 10485760
  s_add_u32 s24, s24, s21
  s_add_u32 s25, s24, 131072
  s_add_u32 s26, s24, 262144
  s_lshr_b32 s22, s45, 1
  s_add_u32 s22, s22, 24
  s_min_u32 s22, s22, 26
  s_lshl_b32 s27, s22, 17
  s_add_u32 s27, s27, s21
  s_lshr_b32 s21, s20, 1
  s_lshl_b32 s21, s21, 8
  v_lshlrev_b32 v4, 4, v0
  v_xor_b32 v4, s21, v4
  s_mul_i32 s21, s42, 20
  s_add_u32 s21, s21, 640
  v_add_u32 v235, s21, v232
  v_lshrrev_b32 v3, 6, v235
  v_lshl_add_u32 v3, v3, 2, v233
  v_and_b32 v235, 63, v235
  v_lshlrev_b32 v3, 10, v3
  v_lshl_add_u32 v3, v235, 4, v3
  s_and_b32 s21, s20, 1
  s_xor_b32 s44, s44, s21
  s_lshl_b32 s21, s44, 6
  v_lshlrev_b32 v248, 1, v232
  buffer_load_ushort v248, v248, s[16:19], s21 offen
  v_mov_b32 v120, 0x3f803f80
  v_mov_b32 v121, 0x3f803f80
  v_mov_b32 v122, 0x3f803f80
  v_mov_b32 v123, 0x3f803f80
  v_mov_b32 v124, 0x3f803f80
  v_mov_b32 v125, 0x3f803f80
  v_mov_b32 v126, 0x3f803f80
  v_mov_b32 v127, 0x3f803f80
  v_mov_b32 v128, 0x3f803f80
  v_mov_b32 v129, 0x3f803f80
  v_mov_b32 v130, 0x3f803f80
  v_mov_b32 v131, 0x3f803f80
  v_mov_b32 v132, 0x3f803f80
  v_mov_b32 v133, 0x3f803f80
  v_mov_b32 v134, 0x3f803f80
  v_mov_b32 v135, 0x3f803f80
  v_mov_b32 v136, 0x3f803f80
  v_mov_b32 v137, 0x3f803f80
  v_mov_b32 v138, 0x3f803f80
  v_mov_b32 v139, 0x3f803f80
  v_mov_b32 v140, 0x3f803f80
  v_mov_b32 v141, 0x3f803f80
  v_mov_b32 v142, 0x3f803f80
  v_mov_b32 v143, 0x3f803f80
  v_mov_b32 v144, 0x3f803f80
  v_mov_b32 v145, 0x3f803f80
  v_mov_b32 v146, 0x3f803f80
  v_mov_b32 v147, 0x3f803f80
  v_mov_b32 v148, 0x3f803f80
  v_mov_b32 v149, 0x3f803f80
  v_mov_b32 v150, 0x3f803f80
  v_mov_b32 v151, 0x3f803f80
  buffer_load_dwordx4 v5, s[8:11], s28 offen offset:0 lds
  v_mov_b32 v216, 0
  v_mov_b32 v217, 0
  v_mov_b32 v218, 0
  v_mov_b32 v219, 0
  s_nop 1
  v_mfma_f32_32x32x16_bf16 a[0:15], v[216:219], v[216:219], 0
  buffer_load_dwordx4 v6, s[8:11], s28 offen offset:1024 lds
  v_mfma_f32_32x32x16_bf16 a[16:31], v[216:219], v[216:219], 0
  v_mfma_f32_32x32x16_bf16 a[32:47], v[216:219], v[216:219], 0
  v_mfma_f32_32x32x16_bf16 a[48:63], v[216:219], v[216:219], 0
  v_mfma_f32_32x32x16_bf16 a[64:79], v[216:219], v[216:219], 0
  v_mfma_f32_32x32x16_bf16 a[80:95], v[216:219], v[216:219], 0
  v_mfma_f32_32x32x16_bf16 a[96:111], v[216:219], v[216:219], 0
  buffer_load_dwordx4 v7, s[8:11], s28 offen offset:2048 lds
  v_mfma_f32_32x32x16_bf16 a[112:127], v[216:219], v[216:219], 0
  v_mfma_f32_32x32x16_bf16 a[128:143], v[216:219], v[216:219], 0
  v_mfma_f32_32x32x16_bf16 a[144:159], v[216:219], v[216:219], 0
  v_mfma_f32_32x32x16_bf16 a[160:175], v[216:219], v[216:219], 0
  v_mfma_f32_32x32x16_bf16 a[176:191], v[216:219], v[216:219], 0
  v_mfma_f32_32x32x16_bf16 a[192:207], v[216:219], v[216:219], 0
  buffer_load_dwordx4 v8, s[8:11], s28 offen offset:3072 lds
  s_add_u32 s28, s28, s38
  s_add_u32 m0, s31, s36
  s_nop 0
  v_mfma_f32_32x32x16_bf16 a[208:223], v[216:219], v[216:219], 0
  v_mfma_f32_32x32x16_bf16 a[224:239], v[216:219], v[216:219], 0
  v_mov_b32 v13, 0xdddd
  v_bfe_u32 v234, v0, 1, 3
  v_xor_b32 v234, v234, v233
  v_lshlrev_b32 v234, 4, v234
  buffer_load_dwordx4 v5, s[8:11], s29 offen offset:0 lds
  v_lshl_add_u32 v234, v232, 7, v234
  s_lshl_b32 s21, s20, 15
  v_add_u32 v9, s21, v234
  v_xor_b32 v10, 32, v9
  v_xor_b32 v11, 64, v9
  v_xor_b32 v12, 96, v9
  buffer_load_dwordx4 v6, s[8:11], s29 offen offset:1024 lds
  v_mov_b32 v81, 0
  v_mov_b32 v83, 0
  s_lshl_b32 s21, s20, 9
  s_add_u32 s21, s21, 159744
  v_lshl_add_u32 v236, v0, 2, s21
  v_xor_b32 v237, 512, v236
  buffer_load_dwordx4 v[96:99], v1, s[4:7], s30 offen
  v_xor_b32 v238, 1024, v236
  v_xor_b32 v239, 1536, v236
  v_cmp_lt_u32 vcc, 31, v0
  s_mov_b32 s33, 0
  s_mov_b32 s32, s47
  v_lshlrev_b32 v255, 4, v0
  buffer_load_dwordx4 v7, s[8:11], s29 offen offset:2048 lds
  v_lshlrev_b32 v254, 8, v0
  s_lshl_b32 s21, s20, 15
  v_add_u32 v14, s21, v255
  s_lshr_b32 s21, s20, 1
  s_lshl_b32 s23, s21, 10
  s_mul_i32 s21, s21, 14336
  buffer_load_dword v112, v2, s[4:7], s30 offen
  s_bitcmp1_b32 s20, 0
  s_cselect_b32 s22, 6144, 0
  s_add_u32 s21, s21, s22
  s_add_u32 s21, s21, 131072
  v_add_u32 v15, s21, v255
  s_mul_i32 s21, s44, 55296
  buffer_load_dwordx4 v8, s[8:11], s29 offen offset:3072 lds
  s_add_u32 s29, s29, s38
  s_add_u32 m0, s31, s40
  s_nop 0
  s_add_u32 s21, s21, s23
  s_add_u32 s21, s21, 14024704
  s_mul_i32 s90, s45, 6144
  s_add_u32 s90, s90, s21
  s_add_u32 s91, s90, 4096
  s_lshr_b32 s22, s45, 1
  s_mov_b64 exec, s[34:35]
  buffer_load_dwordx4 v[120:123], v3, s[4:7], s30 offen offset:0
  s_mov_b64 exec, -1
  s_add_u32 s22, s22, 24
  s_min_u32 s22, s22, 26
  s_lshl_b32 s92, s22, 11
  s_add_u32 s92, s92, s21
  s_mul_i32 s93, s44, 40960
  s_add_u32 s93, s93, 3579904
  buffer_load_dwordx4 v[152:155], v4, s[4:7], s24 offen offset:0
  s_lshr_b32 s21, s2, 3
  s_lshl2_add_u32 s21, s21, s20
  s_lshl_b32 s94, s21, 14
  s_add_u32 s94, s94, 23724032
  s_mov_b32 s66, 2621440
  s_mov_b32 s67, 0x20000
  buffer_load_dwordx4 v5, s[8:11], s28 offen offset:0 lds
  s_mov_b32 s70, 2621440
  s_mov_b32 s71, 0x20000
  s_mul_i32 s72, s43, 235
  s_add_u32 s72, s72, s20
  s_lshl_b32 s72, s72, 10
  s_add_u32 s72, s72, 23724032
  buffer_load_dwordx4 v[156:159], v4, s[4:7], s25 offen offset:0
  s_lshr_b32 s21, s20, 1
  s_lshl1_add_u32 s78, s42, s21
  s_xor_b32 s79, s78, 1
  s_mul_i32 s78, s78, 96256
  s_mul_i32 s79, s79, 96256
  s_lshl_b32 s21, s20, 11
  s_mov_b64 exec, s[34:35]
  buffer_load_dwordx4 v[124:127], v3, s[4:7], s30 offen offset:2048
  s_mov_b64 exec, -1
  s_add_u32 s30, s30, s37
  s_add_u32 s21, s21, 17563648
  s_add_u32 s78, s78, s21
  s_add_u32 s79, s79, s21
  v_and_b32 v250, 15, v0
  v_lshrrev_b32 v251, 4, v0
  v_lshlrev_b32 v251, 9, v251
  v_lshl_add_u32 v250, v250, 4, v251
  s_and_b32 s21, s20, 1
  s_lshl_b32 s21, s21, 8
  v_add_u32 v250, s21, v250
  v_xor_b32 v251, 256, v250
  s_lshr_b32 s21, s42, 3
  s_and_b32 s22, s42, 7
  s_lshl2_add_u32 s21, s22, s21
  s_lshl_b32 s21, s21, 1
  v_and_b32 v253, 3, v0
  v_lshl_add_u32 v253, v253, 6, s21
  v_bfe_u32 v252, v0, 2, 1
  v_add_u32 v253, v253, v252
  s_and_b32 s21, s2, 7
  s_lshl_b32 s21, s21, 5
  v_add_u32 v252, s21, v0
  v_cndmask_b32 v252, v252, v253, vcc
  v_lshlrev_b32 v252, 2, v252
  v_mov_b32 v253, 1
  s_lshl_b32 s81, s2, 2
  s_mov_b32 s80, 26812416
  s_add_u32 s81, s81, s80
  s_add_u32 s73, s72, 48128
  s_add_u32 s74, s73, 48128
  s_add_u32 s75, s74, 48128
  s_add_u32 s76, s75, 48128
  v_mov_b32 v113, 0x3f803f80
  v_mov_b32 v115, 0x3f803f80
  v_mov_b32 v117, 0x3f803f80
  v_mov_b32 v119, 0x3f803f80
  s_waitcnt vmcnt(28)
  v_mfma_f32_32x32x16_bf16 v[16:31], v[108:111], v[48:51], 0
  v_mfma_f32_32x32x16_bf16 v[32:47], v[108:111], v[52:55], 0
  v_mfma_f32_32x32x8_bf16 v[16:31], v[118:119], v[80:81], v[16:31]
  v_mfma_f32_32x32x8_bf16 v[32:47], v[118:119], v[82:83], v[32:47]
  s_nop 7
  s_nop 7
  buffer_load_dwordx4 v[160:163], v4, s[4:7], s26 offen offset:0
  v_max_f32 v240, v16, v17
  v_max3_f32 v240, v18, v19, v240
  v_max3_f32 v240, v20, v21, v240
  v_max3_f32 v240, v22, v23, v240
  v_max3_f32 v240, v24, v25, v240
  v_max3_f32 v240, v26, v27, v240
  buffer_load_dwordx4 v6, s[8:11], s28 offen offset:1024 lds
  v_max3_f32 v240, v28, v29, v240
  v_max3_f32 v240, v30, v31, v240
  v_max_f32 v241, v32, v33
  v_max3_f32 v241, v34, v35, v241
  v_max3_f32 v241, v36, v37, v241
  v_max3_f32 v241, v38, v39, v241
  buffer_load_dwordx4 v[164:167], v4, s[4:7], s27 offen offset:0
  v_max3_f32 v241, v40, v41, v241
  v_max3_f32 v241, v42, v43, v241
  v_max3_f32 v241, v44, v45, v241
  v_max3_f32 v241, v46, v47, v241
  v_mov_b32 v242, v240
  v_mov_b32 v243, v241
  buffer_load_dwordx4 v[100:103], v1, s[4:7], s30 offen
  s_nop 1
  v_permlane32_swap_b32 v240, v242
  v_permlane32_swap_b32 v241, v243
  s_nop 1
  v_max_f32 v240, v240, v242
  v_max_f32 v241, v241, v243
  buffer_load_dwordx4 v[168:171], v4, s[4:7], s24 offen offset:1024
  v_add_f32 v240, 0x42c80000, v240
  v_add_f32 v241, 0x42c80000, v241
  v_cvt_pk_bf16_f32 v242, v240, v240
  v_and_b32 v242, 0xffff0000, v242
  v_sub_f32 v242, v240, v242
  v_cvt_pk_bf16_f32 v81, v240, v242
  buffer_load_dwordx4 v7, s[8:11], s28 offen offset:2048 lds
  v_and_b32 v243, 0xffff0000, v81
  v_sub_f32 v242, v242, v243
  v_cvt_pk_bf16_f32 v242, v242, 0
  v_cndmask_b32 v81, v81, v242, vcc
  v_xor_b32 v81, 0x80008000, v81
  v_cvt_pk_bf16_f32 v242, v241, v241
  buffer_load_dwordx4 v[172:175], v4, s[4:7], s25 offen offset:1024
  v_and_b32 v242, 0xffff0000, v242
  v_sub_f32 v242, v241, v242
  v_cvt_pk_bf16_f32 v83, v241, v242
  v_and_b32 v243, 0xffff0000, v83
  v_sub_f32 v242, v242, v243
  v_cvt_pk_bf16_f32 v242, v242, 0
  buffer_load_dword v114, v2, s[4:7], s30 offen
  v_cndmask_b32 v83, v83, v242, vcc
  v_xor_b32 v83, 0x80008000, v83
  ds_write_b32 v236, v81
  ds_write_b32 v236, v83 offset:256
  v_mov_b32 v40, 0
  v_mov_b32 v41, 0
  buffer_load_dwordx4 v[176:179], v4, s[4:7], s26 offen offset:1024
  v_mov_b32 v42, 0
  v_mov_b32 v43, 0
  v_mov_b32 v44, 0
  v_mov_b32 v45, 0
  v_mov_b32 v46, 0
  v_mov_b32 v47, 0
  buffer_load_dwordx4 v8, s[8:11], s28 offen offset:3072 lds
  s_add_u32 s28, s28, s38
  s_add_u32 m0, s31, s41
  s_nop 0
  s_waitcnt lgkmcnt(0)
  s_barrier
  ds_read_b32 v85, v237 offset:0
  ds_read_b32 v87, v237 offset:256
  ds_read_b32 v89, v238 offset:0
  ds_read_b32 v91, v238 offset:256
  buffer_load_dwordx4 v[180:183], v4, s[4:7], s27 offen offset:1024
  ds_read_b32 v93, v239 offset:0
  ds_read_b32 v95, v239 offset:256
  s_mov_b64 exec, s[34:35]
  buffer_load_dwordx4 v[128:131], v3, s[4:7], s30 offen offset:0
  s_mov_b64 exec, -1
  s_waitcnt vmcnt(17)
  v_mfma_f32_32x32x16_bf16 v[16:31], v[96:99], v[48:51], 0
  v_mfma_f32_32x32x8_bf16 v[16:31], v[112:113], v[80:81], v[16:31]
  ds_read_b128 v[216:219], v9 offset:0
  ds_read_b128 v[220:223], v9 offset:4096
  buffer_load_dwordx4 v[184:187], v4, s[4:7], s24 offen offset:2048
  buffer_load_dwordx4 v5, s[8:11], s29 offen offset:0 lds
  s_nop 7
  s_nop 3
  v_exp_f32 v16, v16
  v_exp_f32 v17, v17
  .p2align 3
K2_LOOP:
  v_smfmac_f32_32x32x32_bf16 a[112:127], v[148:151], v[40:47], v13
  s_cmp_eq_u32 s33, 3
  s_cbranch_scc1 K2_PF
K2_PFR:
  s_waitcnt vmcnt(14) lgkmcnt(0)
  buffer_load_dwordx4 v[188:191], v4, s[4:7], s25 offen offset:2048
  v_exp_f32 v18, v18
  v_exp_f32_e64 v19, v19
  v_mfma_f32_32x32x16_bf16 v[32:47], v[96:99], v[52:55], 0
  v_exp_f32 v20, v20
  v_exp_f32 v21, v21
  v_exp_f32_e64 v22, v22
  v_mfma_f32_32x32x8_bf16 v[32:47], v[112:113], v[82:83], v[32:47]
  v_exp_f32 v23, v23
  v_exp_f32 v24, v24
  v_exp_f32 v25, v25
  v_exp_f32 v26, v26
  v_smfmac_f32_32x32x32_bf16 a[0:15], v[120:123], v[16:23], v13
  s_mov_b64 exec, s[34:35]
  buffer_load_dwordx4 v[132:135], v3, s[4:7], s30 offen offset:2048
  s_mov_b64 exec, -1
  v_exp_f32 v27, v27
  v_exp_f32 v28, v28
  v_mfma_f32_32x32x16_bf16 a[128:143], v[152:155], v[216:219], a[128:143]
  s_add_u32 s30, s30, s37
  v_exp_f32 v29, v29
  v_exp_f32 v30, v30
  v_exp_f32 v31, v31
  v_mfma_f32_32x32x16_bf16 a[144:159], v[152:155], v[220:223], a[144:159]
  v_exp_f32 v32, v32
  v_exp_f32 v33, v33
  v_exp_f32_e64 v34, v34
  v_smfmac_f32_32x32x32_bf16 a[0:15], v[124:127], v[24:31], v13
  s_waitcnt vmcnt(17)
  buffer_load_dwordx4 v[192:195], v4, s[4:7], s26 offen offset:2048
  v_exp_f32 v35, v35
  v_exp_f32_e64 v36, v36
  v_mfma_f32_32x32x16_bf16 v[16:31], v[96:99], v[56:59], 0
  ds_read_b128 v[224:227], v10 offset:0
  v_exp_f32 v37, v37
  v_exp_f32 v38, v38
  v_exp_f32_e64 v39, v39
  v_mfma_f32_32x32x8_bf16 v[16:31], v[112:113], v[84:85], v[16:31]
  v_exp_f32 v40, v40
  v_exp_f32 v41, v41
  v_exp_f32 v42, v42
  v_exp_f32 v43, v43
  v_smfmac_f32_32x32x32_bf16 a[16:31], v[120:123], v[32:39], v13
  buffer_load_dwordx4 v6, s[8:11], s29 offen offset:1024 lds
  v_exp_f32 v44, v44
  v_exp_f32 v45, v45
  v_mfma_f32_32x32x16_bf16 a[160:175], v[156:159], v[216:219], a[160:175]
  v_exp_f32 v46, v46
  v_exp_f32 v47, v47
  v_exp_f32_e64 v16, v16
  v_mfma_f32_32x32x16_bf16 a[176:191], v[156:159], v[220:223], a[176:191]
  v_exp_f32 v17, v17
  v_exp_f32 v18, v18
  v_exp_f32_e64 v19, v19
  v_smfmac_f32_32x32x32_bf16 a[16:31], v[124:127], v[40:47], v13
  s_waitcnt vmcnt(17)
  buffer_load_dwordx4 v[196:199], v4, s[4:7], s27 offen offset:2048
  v_exp_f32 v20, v20
  v_exp_f32_e64 v21, v21
  v_mfma_f32_32x32x16_bf16 v[32:47], v[96:99], v[60:63], 0
  ds_read_b128 v[228:231], v10 offset:4096
  v_exp_f32 v22, v22
  v_exp_f32 v23, v23
  v_exp_f32_e64 v24, v24
  v_mfma_f32_32x32x8_bf16 v[32:47], v[112:113], v[86:87], v[32:47]
  v_exp_f32 v25, v25
  v_exp_f32 v26, v26
  v_exp_f32_e64 v27, v27
  v_smfmac_f32_32x32x32_bf16 a[32:47], v[120:123], v[16:23], v13
  buffer_load_dwordx4 v[104:107], v1, s[4:7], s30 offen
  v_exp_f32 v28, v28
  v_exp_f32 v29, v29
  v_mfma_f32_32x32x16_bf16 a[192:207], v[160:163], v[216:219], a[192:207]
  v_exp_f32 v30, v30
  v_exp_f32 v31, v31
  v_exp_f32_e64 v32, v32
  v_mfma_f32_32x32x16_bf16 a[208:223], v[160:163], v[220:223], a[208:223]
  v_exp_f32 v33, v33
  v_exp_f32 v34, v34
  v_exp_f32_e64 v35, v35
  v_smfmac_f32_32x32x32_bf16 a[32:47], v[124:127], v[24:31], v13
  s_waitcnt vmcnt(17)
  buffer_load_dwordx4 v[200:203], v4, s[4:7], s24 offen offset:3072
  v_exp_f32 v36, v36
  v_exp_f32_e64 v37, v37
  v_mfma_f32_32x32x16_bf16 v[16:31], v[96:99], v[64:67], 0
  s_add_u32 s24, s24, s36
  v_exp_f32 v38, v38
  v_exp_f32 v39, v39
  v_exp_f32 v40, v40
  v_mfma_f32_32x32x8_bf16 v[16:31], v[112:113], v[88:89], v[16:31]
  v_exp_f32 v41, v41
  v_exp_f32 v42, v42
  v_exp_f32 v43, v43
  v_exp_f32 v44, v44
  v_smfmac_f32_32x32x32_bf16 a[48:63], v[120:123], v[32:39], v13
  buffer_load_dwordx4 v7, s[8:11], s29 offen offset:2048 lds
  v_exp_f32 v45, v45
  v_exp_f32 v46, v46
  v_mfma_f32_32x32x16_bf16 a[224:239], v[164:167], v[216:219], a[224:239]
  v_exp_f32 v47, v47
  v_exp_f32 v16, v16
  v_exp_f32_e64 v17, v17
  v_smfmac_f32_32x32x32_bf16 a[48:63], v[124:127], v[40:47], v13
  s_waitcnt vmcnt(17) lgkmcnt(0)
  buffer_load_dwordx4 v[204:207], v4, s[4:7], s25 offen offset:3072
  v_exp_f32 v18, v18
  v_exp_f32_e64 v19, v19
  v_mfma_f32_32x32x16_bf16 v[32:47], v[96:99], v[68:71], 0
  s_add_u32 s25, s25, s36
  v_exp_f32 v20, v20
  v_exp_f32 v21, v21
  v_exp_f32 v22, v22
  v_mfma_f32_32x32x8_bf16 v[32:47], v[112:113], v[90:91], v[32:47]
  v_exp_f32 v23, v23
  v_exp_f32 v24, v24
  v_exp_f32 v25, v25
  v_exp_f32 v26, v26
  v_smfmac_f32_32x32x32_bf16 a[64:79], v[120:123], v[16:23], v13
  buffer_load_dword v116, v2, s[4:7], s30 offen
  v_exp_f32 v27, v27
  v_exp_f32 v28, v28
  v_mfma_f32_32x32x16_bf16 a[128:143], v[168:171], v[224:227], a[128:143]
  v_exp_f32 v29, v29
  v_exp_f32 v30, v30
  v_exp_f32_e64 v31, v31
  v_mfma_f32_32x32x16_bf16 a[144:159], v[168:171], v[228:231], a[144:159]
  v_exp_f32 v32, v32
  v_exp_f32 v33, v33
  v_exp_f32_e64 v34, v34
  v_smfmac_f32_32x32x32_bf16 a[64:79], v[124:127], v[24:31], v13
  s_waitcnt vmcnt(17)
  buffer_load_dwordx4 v[208:211], v4, s[4:7], s26 offen offset:3072
  v_exp_f32 v35, v35
  v_exp_f32_e64 v36, v36
  v_mfma_f32_32x32x16_bf16 v[16:31], v[96:99], v[72:75], 0
  s_add_u32 s26, s26, s36
  ds_read_b128 v[216:219], v11 offset:0
  v_exp_f32 v37, v37
  v_exp_f32 v38, v38
  v_exp_f32 v39, v39
  v_mfma_f32_32x32x8_bf16 v[16:31], v[112:113], v[92:93], v[16:31]
  v_exp_f32 v40, v40
  v_exp_f32 v41, v41
  v_exp_f32 v42, v42
  v_exp_f32 v43, v43
  v_smfmac_f32_32x32x32_bf16 a[80:95], v[120:123], v[32:39], v13
  buffer_load_dwordx4 v8, s[8:11], s29 offen offset:3072 lds
  v_exp_f32 v44, v44
  v_exp_f32 v45, v45
  v_mfma_f32_32x32x16_bf16 a[160:175], v[172:175], v[224:227], a[160:175]
  s_add_u32 s29, s29, s38
  v_exp_f32 v46, v46
  v_exp_f32 v47, v47
  v_exp_f32 v16, v16
  v_mfma_f32_32x32x16_bf16 a[176:191], v[172:175], v[228:231], a[176:191]
  s_xor_b32 s31, s31, s39
  v_exp_f32 v17, v17
  v_exp_f32 v18, v18
  v_exp_f32 v19, v19
  v_smfmac_f32_32x32x32_bf16 a[80:95], v[124:127], v[40:47], v13
  s_waitcnt vmcnt(17)
  buffer_load_dwordx4 v[212:215], v4, s[4:7], s27 offen offset:3072
  v_exp_f32 v20, v20
  v_exp_f32_e64 v21, v21
  v_mfma_f32_32x32x16_bf16 v[32:47], v[96:99], v[76:79], 0
  s_min_u32 s10, s10, s32
  ds_read_b128 v[220:223], v11 offset:4096
  v_exp_f32 v22, v22
  v_exp_f32 v23, v23
  v_exp_f32 v24, v24
  v_mfma_f32_32x32x8_bf16 v[32:47], v[112:113], v[94:95], v[32:47]
  v_exp_f32 v25, v25
  v_exp_f32 v26, v26
  v_exp_f32_e64 v27, v27
  v_smfmac_f32_32x32x32_bf16 a[96:111], v[120:123], v[16:23], v13
  s_mov_b64 exec, s[34:35]
  buffer_load_dwordx4 v[136:139], v3, s[4:7], s30 offen offset:0
  s_mov_b64 exec, -1
  v_exp_f32 v28, v28
  v_exp_f32 v29, v29
  v_mfma_f32_32x32x16_bf16 a[192:207], v[176:179], v[224:227], a[192:207]
  s_mov_b32 m0, s31
  v_exp_f32 v30, v30
  v_exp_f32 v31, v31
  v_exp_f32 v32, v32
  v_mfma_f32_32x32x16_bf16 a[208:223], v[176:179], v[228:231], a[208:223]
  s_add_u32 s27, s27, s36
  v_exp_f32 v33, v33
  v_exp_f32 v34, v34
  v_exp_f32 v35, v35
  v_smfmac_f32_32x32x32_bf16 a[96:111], v[124:127], v[24:31], v13
  s_waitcnt vmcnt(17)
  buffer_load_dwordx4 v[152:155], v4, s[4:7], s24 offen offset:0
  v_exp_f32 v36, v36
  v_exp_f32_e64 v37, v37
  v_mfma_f32_32x32x16_bf16 v[16:31], v[100:103], v[48:51], 0
  v_exp_f32 v38, v38
  v_exp_f32 v39, v39
  v_exp_f32_e64 v40, v40
  v_mfma_f32_32x32x8_bf16 v[16:31], v[114:115], v[80:81], v[16:31]
  v_exp_f32 v41, v41
  v_exp_f32 v42, v42
  v_exp_f32 v43, v43
  v_exp_f32 v44, v44
  v_smfmac_f32_32x32x32_bf16 a[112:127], v[120:123], v[32:39], v13
  buffer_load_dwordx4 v5, s[8:11], s28 offen offset:0 lds
  v_exp_f32 v45, v45
  v_exp_f32 v46, v46
  v_mfma_f32_32x32x16_bf16 a[224:239], v[180:183], v[224:227], a[224:239]
  v_exp_f32 v47, v47
  v_exp_f32 v16, v16
  v_exp_f32_e64 v17, v17
  v_smfmac_f32_32x32x32_bf16 a[112:127], v[124:127], v[40:47], v13
  s_waitcnt vmcnt(14) lgkmcnt(0)
  buffer_load_dwordx4 v[156:159], v4, s[4:7], s25 offen offset:0
  v_exp_f32 v18, v18
  v_exp_f32_e64 v19, v19
  v_mfma_f32_32x32x16_bf16 v[32:47], v[100:103], v[52:55], 0
  v_exp_f32 v20, v20
  v_exp_f32 v21, v21
  v_exp_f32_e64 v22, v22
  v_mfma_f32_32x32x8_bf16 v[32:47], v[114:115], v[82:83], v[32:47]
  v_exp_f32 v23, v23
  v_exp_f32 v24, v24
  v_exp_f32 v25, v25
  v_exp_f32 v26, v26
  v_smfmac_f32_32x32x32_bf16 a[0:15], v[128:131], v[16:23], v13
  s_mov_b64 exec, s[34:35]
  buffer_load_dwordx4 v[140:143], v3, s[4:7], s30 offen offset:2048
  s_mov_b64 exec, -1
  v_exp_f32 v27, v27
  v_exp_f32 v28, v28
  v_mfma_f32_32x32x16_bf16 a[128:143], v[184:187], v[216:219], a[128:143]
  s_add_u32 s30, s30, s37
  v_exp_f32 v29, v29
  v_exp_f32 v30, v30
  v_exp_f32 v31, v31
  v_mfma_f32_32x32x16_bf16 a[144:159], v[184:187], v[220:223], a[144:159]
  v_exp_f32 v32, v32
  v_exp_f32 v33, v33
  v_exp_f32_e64 v34, v34
  v_smfmac_f32_32x32x32_bf16 a[0:15], v[132:135], v[24:31], v13
  s_waitcnt vmcnt(17)
  buffer_load_dwordx4 v[160:163], v4, s[4:7], s26 offen offset:0
  v_exp_f32 v35, v35
  v_exp_f32_e64 v36, v36
  v_mfma_f32_32x32x16_bf16 v[16:31], v[100:103], v[56:59], 0
  ds_read_b128 v[224:227], v12 offset:0
  v_exp_f32 v37, v37
  v_exp_f32 v38, v38
  v_exp_f32_e64 v39, v39
  v_mfma_f32_32x32x8_bf16 v[16:31], v[114:115], v[84:85], v[16:31]
  v_exp_f32 v40, v40
  v_exp_f32 v41, v41
  v_exp_f32 v42, v42
  v_exp_f32 v43, v43
  v_smfmac_f32_32x32x32_bf16 a[16:31], v[128:131], v[32:39], v13
  buffer_load_dwordx4 v6, s[8:11], s28 offen offset:1024 lds
  v_exp_f32 v44, v44
  v_exp_f32 v45, v45
  v_mfma_f32_32x32x16_bf16 a[160:175], v[188:191], v[216:219], a[160:175]
  v_exp_f32 v46, v46
  v_exp_f32 v47, v47
  v_exp_f32_e64 v16, v16
  v_mfma_f32_32x32x16_bf16 a[176:191], v[188:191], v[220:223], a[176:191]
  v_exp_f32 v17, v17
  v_exp_f32 v18, v18
  v_exp_f32_e64 v19, v19
  v_smfmac_f32_32x32x32_bf16 a[16:31], v[132:135], v[40:47], v13
  s_waitcnt vmcnt(17)
  buffer_load_dwordx4 v[164:167], v4, s[4:7], s27 offen offset:0
  v_exp_f32 v20, v20
  v_exp_f32_e64 v21, v21
  v_mfma_f32_32x32x16_bf16 v[32:47], v[100:103], v[60:63], 0
  ds_read_b128 v[228:231], v12 offset:4096
  v_exp_f32 v22, v22
  v_exp_f32 v23, v23
  v_exp_f32_e64 v24, v24
  v_mfma_f32_32x32x8_bf16 v[32:47], v[114:115], v[86:87], v[32:47]
  v_exp_f32 v25, v25
  v_exp_f32 v26, v26
  v_exp_f32_e64 v27, v27
  v_smfmac_f32_32x32x32_bf16 a[32:47], v[128:131], v[16:23], v13
  buffer_load_dwordx4 v[108:111], v1, s[4:7], s30 offen
  v_exp_f32 v28, v28
  v_exp_f32 v29, v29
  v_mfma_f32_32x32x16_bf16 a[192:207], v[192:195], v[216:219], a[192:207]
  v_exp_f32 v30, v30
  v_exp_f32 v31, v31
  v_exp_f32_e64 v32, v32
  v_mfma_f32_32x32x16_bf16 a[208:223], v[192:195], v[220:223], a[208:223]
  v_exp_f32 v33, v33
  v_exp_f32 v34, v34
  v_exp_f32_e64 v35, v35
  v_smfmac_f32_32x32x32_bf16 a[32:47], v[132:135], v[24:31], v13
  s_waitcnt vmcnt(17)
  buffer_load_dwordx4 v[168:171], v4, s[4:7], s24 offen offset:1024
  v_exp_f32 v36, v36
  v_exp_f32_e64 v37, v37
  v_mfma_f32_32x32x16_bf16 v[16:31], v[100:103], v[64:67], 0
  v_exp_f32 v38, v38
  v_exp_f32 v39, v39
  v_exp_f32_e64 v40, v40
  v_mfma_f32_32x32x8_bf16 v[16:31], v[114:115], v[88:89], v[16:31]
  v_exp_f32 v41, v41
  v_exp_f32 v42, v42
  v_exp_f32 v43, v43
  v_exp_f32 v44, v44
  v_smfmac_f32_32x32x32_bf16 a[48:63], v[128:131], v[32:39], v13
  buffer_load_dwordx4 v7, s[8:11], s28 offen offset:2048 lds
  v_exp_f32 v45, v45
  v_exp_f32 v46, v46
  v_mfma_f32_32x32x16_bf16 a[224:239], v[196:199], v[216:219], a[224:239]
  v_exp_f32 v47, v47
  v_exp_f32 v16, v16
  v_exp_f32_e64 v17, v17
  v_smfmac_f32_32x32x32_bf16 a[48:63], v[132:135], v[40:47], v13
  s_waitcnt vmcnt(17) lgkmcnt(0)
  buffer_load_dwordx4 v[172:175], v4, s[4:7], s25 offen offset:1024
  v_exp_f32 v18, v18
  v_exp_f32_e64 v19, v19
  v_mfma_f32_32x32x16_bf16 v[32:47], v[100:103], v[68:71], 0
  v_exp_f32 v20, v20
  v_exp_f32 v21, v21
  v_exp_f32_e64 v22, v22
  v_mfma_f32_32x32x8_bf16 v[32:47], v[114:115], v[90:91], v[32:47]
  v_exp_f32 v23, v23
  v_exp_f32 v24, v24
  v_exp_f32 v25, v25
  v_exp_f32 v26, v26
  v_smfmac_f32_32x32x32_bf16 a[64:79], v[128:131], v[16:23], v13
  buffer_load_dword v118, v2, s[4:7], s30 offen
  v_exp_f32 v27, v27
  v_exp_f32 v28, v28
  v_mfma_f32_32x32x16_bf16 a[128:143], v[200:203], v[224:227], a[128:143]
  v_exp_f32 v29, v29
  v_exp_f32 v30, v30
  v_exp_f32_e64 v31, v31
  v_mfma_f32_32x32x16_bf16 a[144:159], v[200:203], v[228:231], a[144:159]
  v_exp_f32 v32, v32
  v_exp_f32 v33, v33
  v_exp_f32_e64 v34, v34
  v_smfmac_f32_32x32x32_bf16 a[64:79], v[132:135], v[24:31], v13
  s_waitcnt vmcnt(14)
  buffer_load_dwordx4 v[176:179], v4, s[4:7], s26 offen offset:1024
  v_exp_f32 v35, v35
  v_exp_f32_e64 v36, v36
  v_mfma_f32_32x32x16_bf16 v[16:31], v[100:103], v[72:75], 0
  ds_read_b128 v[216:219], v9 offset:8192
  v_exp_f32 v37, v37
  v_exp_f32 v38, v38
  v_exp_f32_e64 v39, v39
  v_mfma_f32_32x32x8_bf16 v[16:31], v[114:115], v[92:93], v[16:31]
  v_exp_f32 v40, v40
  v_exp_f32 v41, v41
  v_exp_f32 v42, v42
  v_exp_f32 v43, v43
  v_smfmac_f32_32x32x32_bf16 a[80:95], v[128:131], v[32:39], v13
  buffer_load_dwordx4 v8, s[8:11], s28 offen offset:3072 lds
  v_exp_f32 v44, v44
  v_exp_f32 v45, v45
  v_mfma_f32_32x32x16_bf16 a[160:175], v[204:207], v[224:227], a[160:175]
  s_add_u32 s28, s28, s38
  v_exp_f32 v46, v46
  v_exp_f32 v47, v47
  v_exp_f32 v16, v16
  v_mfma_f32_32x32x16_bf16 a[176:191], v[204:207], v[228:231], a[176:191]
  s_add_u32 m0, s31, s36
  v_exp_f32 v17, v17
  v_exp_f32 v18, v18
  v_exp_f32 v19, v19
  v_smfmac_f32_32x32x32_bf16 a[80:95], v[132:135], v[40:47], v13
  s_waitcnt vmcnt(17)
  buffer_load_dwordx4 v[180:183], v4, s[4:7], s27 offen offset:1024
  v_exp_f32 v20, v20
  v_exp_f32_e64 v21, v21
  v_mfma_f32_32x32x16_bf16 v[32:47], v[100:103], v[76:79], 0
  ds_read_b128 v[220:223], v9 offset:12288
  v_exp_f32 v22, v22
  v_exp_f32 v23, v23
  v_exp_f32_e64 v24, v24
  v_mfma_f32_32x32x8_bf16 v[32:47], v[114:115], v[94:95], v[32:47]
  v_xor_b32 v9, s39, v9
  v_exp_f32 v25, v25
  v_exp_f32 v26, v26
  v_exp_f32 v27, v27
  v_smfmac_f32_32x32x32_bf16 a[96:111], v[128:131], v[16:23], v13
  s_mov_b64 exec, s[34:35]
  buffer_load_dwordx4 v[144:147], v3, s[4:7], s30 offen offset:0
  s_mov_b64 exec, -1
  v_exp_f32 v28, v28
  v_exp_f32 v29, v29
  v_mfma_f32_32x32x16_bf16 a[192:207], v[208:211], v[224:227], a[192:207]
  v_exp_f32 v30, v30
  v_exp_f32 v31, v31
  v_exp_f32_e64 v32, v32
  v_mfma_f32_32x32x16_bf16 a[208:223], v[208:211], v[228:231], a[208:223]
  v_exp_f32 v33, v33
  v_exp_f32 v34, v34
  v_exp_f32_e64 v35, v35
  v_smfmac_f32_32x32x32_bf16 a[96:111], v[132:135], v[24:31], v13
  s_waitcnt vmcnt(17)
  buffer_load_dwordx4 v[184:187], v4, s[4:7], s24 offen offset:2048
  v_exp_f32 v36, v36
  v_exp_f32_e64 v37, v37
  v_mfma_f32_32x32x16_bf16 v[16:31], v[104:107], v[48:51], 0
  v_exp_f32 v38, v38
  v_exp_f32 v39, v39
  v_exp_f32_e64 v40, v40
  v_mfma_f32_32x32x8_bf16 v[16:31], v[116:117], v[80:81], v[16:31]
  v_exp_f32 v41, v41
  v_exp_f32 v42, v42
  v_exp_f32 v43, v43
  v_exp_f32 v44, v44
  v_smfmac_f32_32x32x32_bf16 a[112:127], v[128:131], v[32:39], v13
  buffer_load_dwordx4 v5, s[8:11], s29 offen offset:0 lds
  v_exp_f32 v45, v45
  v_exp_f32 v46, v46
  v_mfma_f32_32x32x16_bf16 a[224:239], v[212:215], v[224:227], a[224:239]
  v_exp_f32 v47, v47
  v_exp_f32 v16, v16
  v_exp_f32_e64 v17, v17
  v_smfmac_f32_32x32x32_bf16 a[112:127], v[132:135], v[40:47], v13
  s_waitcnt vmcnt(14) lgkmcnt(0)
  buffer_load_dwordx4 v[188:191], v4, s[4:7], s25 offen offset:2048
  v_exp_f32 v18, v18
  v_exp_f32_e64 v19, v19
  v_mfma_f32_32x32x16_bf16 v[32:47], v[104:107], v[52:55], 0
  v_exp_f32 v20, v20
  v_exp_f32 v21, v21
  v_exp_f32_e64 v22, v22
  v_mfma_f32_32x32x8_bf16 v[32:47], v[116:117], v[82:83], v[32:47]
  v_exp_f32 v23, v23
  v_exp_f32 v24, v24
  v_exp_f32 v25, v25
  v_exp_f32 v26, v26
  v_smfmac_f32_32x32x32_bf16 a[0:15], v[136:139], v[16:23], v13
  s_mov_b64 exec, s[34:35]
  buffer_load_dwordx4 v[148:151], v3, s[4:7], s30 offen offset:2048
  s_mov_b64 exec, -1
  v_exp_f32 v27, v27
  v_exp_f32 v28, v28
  v_mfma_f32_32x32x16_bf16 a[128:143], v[152:155], v[216:219], a[128:143]
  s_add_u32 s30, s30, s37
  v_exp_f32 v29, v29
  v_exp_f32 v30, v30
  v_exp_f32 v31, v31
  v_mfma_f32_32x32x16_bf16 a[144:159], v[152:155], v[220:223], a[144:159]
  v_exp_f32 v32, v32
  v_exp_f32 v33, v33
  v_exp_f32_e64 v34, v34
  v_smfmac_f32_32x32x32_bf16 a[0:15], v[140:143], v[24:31], v13
  s_waitcnt vmcnt(17)
  buffer_load_dwordx4 v[192:195], v4, s[4:7], s26 offen offset:2048
  v_exp_f32 v35, v35
  v_exp_f32_e64 v36, v36
  v_mfma_f32_32x32x16_bf16 v[16:31], v[104:107], v[56:59], 0
  ds_read_b128 v[224:227], v10 offset:8192
  v_exp_f32 v37, v37
  v_exp_f32 v38, v38
  v_exp_f32_e64 v39, v39
  v_mfma_f32_32x32x8_bf16 v[16:31], v[116:117], v[84:85], v[16:31]
  v_exp_f32 v40, v40
  v_exp_f32 v41, v41
  v_exp_f32 v42, v42
  v_exp_f32 v43, v43
  v_smfmac_f32_32x32x32_bf16 a[16:31], v[136:139], v[32:39], v13
  buffer_load_dwordx4 v6, s[8:11], s29 offen offset:1024 lds
  v_exp_f32 v44, v44
  v_exp_f32 v45, v45
  v_mfma_f32_32x32x16_bf16 a[160:175], v[156:159], v[216:219], a[160:175]
  v_exp_f32 v46, v46
  v_exp_f32 v47, v47
  v_exp_f32_e64 v16, v16
  v_mfma_f32_32x32x16_bf16 a[176:191], v[156:159], v[220:223], a[176:191]
  v_exp_f32 v17, v17
  v_exp_f32 v18, v18
  v_exp_f32_e64 v19, v19
  v_smfmac_f32_32x32x32_bf16 a[16:31], v[140:143], v[40:47], v13
  s_waitcnt vmcnt(17)
  buffer_load_dwordx4 v[196:199], v4, s[4:7], s27 offen offset:2048
  v_exp_f32 v20, v20
  v_exp_f32_e64 v21, v21
  v_mfma_f32_32x32x16_bf16 v[32:47], v[104:107], v[60:63], 0
  ds_read_b128 v[228:231], v10 offset:12288
  v_exp_f32 v22, v22
  v_exp_f32 v23, v23
  v_exp_f32_e64 v24, v24
  v_mfma_f32_32x32x8_bf16 v[32:47], v[116:117], v[86:87], v[32:47]
  v_xor_b32 v10, s39, v10
  v_exp_f32 v25, v25
  v_exp_f32 v26, v26
  v_exp_f32 v27, v27
  v_smfmac_f32_32x32x32_bf16 a[32:47], v[136:139], v[16:23], v13
  buffer_load_dwordx4 v[96:99], v1, s[4:7], s30 offen
  v_exp_f32 v28, v28
  v_exp_f32 v29, v29
  v_mfma_f32_32x32x16_bf16 a[192:207], v[160:163], v[216:219], a[192:207]
  v_exp_f32 v30, v30
  v_exp_f32 v31, v31
  v_exp_f32_e64 v32, v32
  v_mfma_f32_32x32x16_bf16 a[208:223], v[160:163], v[220:223], a[208:223]
  v_exp_f32 v33, v33
  v_exp_f32 v34, v34
  v_exp_f32_e64 v35, v35
  v_smfmac_f32_32x32x32_bf16 a[32:47], v[140:143], v[24:31], v13
  s_waitcnt vmcnt(17)
  buffer_load_dwordx4 v[200:203], v4, s[4:7], s24 offen offset:3072
  v_exp_f32 v36, v36
  v_exp_f32_e64 v37, v37
  v_mfma_f32_32x32x16_bf16 v[16:31], v[104:107], v[64:67], 0
  s_add_u32 s24, s24, s36
  v_exp_f32 v38, v38
  v_exp_f32 v39, v39
  v_exp_f32 v40, v40
  v_mfma_f32_32x32x8_bf16 v[16:31], v[116:117], v[88:89], v[16:31]
  v_exp_f32 v41, v41
  v_exp_f32 v42, v42
  v_exp_f32 v43, v43
  v_exp_f32 v44, v44
  v_smfmac_f32_32x32x32_bf16 a[48:63], v[136:139], v[32:39], v13
  buffer_load_dwordx4 v7, s[8:11], s29 offen offset:2048 lds
  v_exp_f32 v45, v45
  v_exp_f32 v46, v46
  v_mfma_f32_32x32x16_bf16 a[224:239], v[164:167], v[216:219], a[224:239]
  v_exp_f32 v47, v47
  v_exp_f32 v16, v16
  v_exp_f32_e64 v17, v17
  v_smfmac_f32_32x32x32_bf16 a[48:63], v[140:143], v[40:47], v13
  s_waitcnt vmcnt(17) lgkmcnt(0)
  buffer_load_dwordx4 v[204:207], v4, s[4:7], s25 offen offset:3072
  v_exp_f32 v18, v18
  v_exp_f32_e64 v19, v19
  v_mfma_f32_32x32x16_bf16 v[32:47], v[104:107], v[68:71], 0
  s_add_u32 s25, s25, s36
  v_exp_f32 v20, v20
  v_exp_f32 v21, v21
  v_exp_f32 v22, v22
  v_mfma_f32_32x32x8_bf16 v[32:47], v[116:117], v[90:91], v[32:47]
  v_exp_f32 v23, v23
  v_exp_f32 v24, v24
  v_exp_f32 v25, v25
  v_exp_f32 v26, v26
  v_smfmac_f32_32x32x32_bf16 a[64:79], v[136:139], v[16:23], v13
  buffer_load_dword v112, v2, s[4:7], s30 offen
  v_exp_f32 v27, v27
  v_exp_f32 v28, v28
  v_mfma_f32_32x32x16_bf16 a[128:143], v[168:171], v[224:227], a[128:143]
  v_exp_f32 v29, v29
  v_exp_f32 v30, v30
  v_exp_f32_e64 v31, v31
  v_mfma_f32_32x32x16_bf16 a[144:159], v[168:171], v[228:231], a[144:159]
  v_exp_f32 v32, v32
  v_exp_f32 v33, v33
  v_exp_f32_e64 v34, v34
  v_smfmac_f32_32x32x32_bf16 a[64:79], v[140:143], v[24:31], v13
  s_waitcnt vmcnt(17)
  buffer_load_dwordx4 v[208:211], v4, s[4:7], s26 offen offset:3072
  v_exp_f32 v35, v35
  v_exp_f32_e64 v36, v36
  v_mfma_f32_32x32x16_bf16 v[16:31], v[104:107], v[72:75], 0
  s_add_u32 s26, s26, s36
  ds_read_b128 v[216:219], v11 offset:8192
  v_exp_f32 v37, v37
  v_exp_f32 v38, v38
  v_exp_f32 v39, v39
  v_mfma_f32_32x32x8_bf16 v[16:31], v[116:117], v[92:93], v[16:31]
  v_exp_f32 v40, v40
  v_exp_f32 v41, v41
  v_exp_f32 v42, v42
  v_exp_f32 v43, v43
  v_smfmac_f32_32x32x32_bf16 a[80:95], v[136:139], v[32:39], v13
  buffer_load_dwordx4 v8, s[8:11], s29 offen offset:3072 lds
  v_exp_f32 v44, v44
  v_exp_f32 v45, v45
  v_mfma_f32_32x32x16_bf16 a[160:175], v[172:175], v[224:227], a[160:175]
  s_add_u32 s29, s29, s38
  v_exp_f32 v46, v46
  v_exp_f32 v47, v47
  v_exp_f32 v16, v16
  v_mfma_f32_32x32x16_bf16 a[176:191], v[172:175], v[228:231], a[176:191]
  s_add_u32 m0, s31, s40
  v_exp_f32 v17, v17
  v_exp_f32 v18, v18
  v_exp_f32 v19, v19
  v_smfmac_f32_32x32x32_bf16 a[80:95], v[140:143], v[40:47], v13
  s_waitcnt vmcnt(17)
  buffer_load_dwordx4 v[212:215], v4, s[4:7], s27 offen offset:3072
  v_exp_f32 v20, v20
  v_exp_f32_e64 v21, v21
  v_mfma_f32_32x32x16_bf16 v[32:47], v[104:107], v[76:79], 0
  s_mov_b32 s6, s32
  ds_read_b128 v[220:223], v11 offset:12288
  v_exp_f32 v22, v22
  v_exp_f32 v23, v23
  v_exp_f32 v24, v24
  v_mfma_f32_32x32x8_bf16 v[32:47], v[116:117], v[94:95], v[32:47]
  v_xor_b32 v11, s39, v11
  v_exp_f32 v25, v25
  v_exp_f32 v26, v26
  v_exp_f32 v27, v27
  v_smfmac_f32_32x32x32_bf16 a[96:111], v[136:139], v[16:23], v13
  s_mov_b64 exec, s[34:35]
  buffer_load_dwordx4 v[120:123], v3, s[4:7], s30 offen offset:0
  s_mov_b64 exec, -1
  v_exp_f32 v28, v28
  v_exp_f32 v29, v29
  v_mfma_f32_32x32x16_bf16 a[192:207], v[176:179], v[224:227], a[192:207]
  s_add_u32 s27, s27, s36
  v_exp_f32 v30, v30
  v_exp_f32 v31, v31
  v_exp_f32 v32, v32
  v_mfma_f32_32x32x16_bf16 a[208:223], v[176:179], v[228:231], a[208:223]
  v_exp_f32 v33, v33
  v_exp_f32 v34, v34
  v_exp_f32_e64 v35, v35
  v_smfmac_f32_32x32x32_bf16 a[96:111], v[140:143], v[24:31], v13
  s_waitcnt vmcnt(17)
  buffer_load_dwordx4 v[152:155], v4, s[4:7], s24 offen offset:0
  v_exp_f32 v36, v36
  v_exp_f32_e64 v37, v37
  v_mfma_f32_32x32x16_bf16 v[16:31], v[108:111], v[48:51], 0
  v_exp_f32 v38, v38
  v_exp_f32 v39, v39
  v_exp_f32_e64 v40, v40
  v_mfma_f32_32x32x8_bf16 v[16:31], v[118:119], v[80:81], v[16:31]
  v_exp_f32 v41, v41
  v_exp_f32 v42, v42
  v_exp_f32 v43, v43
  v_exp_f32 v44, v44
  v_smfmac_f32_32x32x32_bf16 a[112:127], v[136:139], v[32:39], v13
  buffer_load_dwordx4 v5, s[8:11], s28 offen offset:0 lds
  v_exp_f32 v45, v45
  v_exp_f32 v46, v46
  v_mfma_f32_32x32x16_bf16 a[224:239], v[180:183], v[224:227], a[224:239]
  v_exp_f32 v47, v47
  v_exp_f32 v16, v16
  v_exp_f32_e64 v17, v17
  v_smfmac_f32_32x32x32_bf16 a[112:127], v[140:143], v[40:47], v13
  s_waitcnt vmcnt(14) lgkmcnt(0)
  buffer_load_dwordx4 v[156:159], v4, s[4:7], s25 offen offset:0
  v_exp_f32 v18, v18
  v_exp_f32_e64 v19, v19
  v_mfma_f32_32x32x16_bf16 v[32:47], v[108:111], v[52:55], 0
  v_exp_f32 v20, v20
  v_exp_f32 v21, v21
  v_exp_f32_e64 v22, v22
  v_mfma_f32_32x32x8_bf16 v[32:47], v[118:119], v[82:83], v[32:47]
  v_exp_f32 v23, v23
  v_exp_f32 v24, v24
  v_exp_f32 v25, v25
  v_exp_f32 v26, v26
  v_smfmac_f32_32x32x32_bf16 a[0:15], v[144:147], v[16:23], v13
  s_mov_b64 exec, s[34:35]
  buffer_load_dwordx4 v[124:127], v3, s[4:7], s30 offen offset:2048
  s_mov_b64 exec, -1
  v_exp_f32 v27, v27
  v_exp_f32 v28, v28
  v_mfma_f32_32x32x16_bf16 a[128:143], v[184:187], v[216:219], a[128:143]
  s_add_u32 s30, s30, s37
  v_exp_f32 v29, v29
  v_exp_f32 v30, v30
  v_exp_f32 v31, v31
  v_mfma_f32_32x32x16_bf16 a[144:159], v[184:187], v[220:223], a[144:159]
  v_exp_f32 v32, v32
  v_exp_f32 v33, v33
  v_exp_f32_e64 v34, v34
  v_smfmac_f32_32x32x32_bf16 a[0:15], v[148:151], v[24:31], v13
  s_waitcnt vmcnt(17)
  buffer_load_dwordx4 v[160:163], v4, s[4:7], s26 offen offset:0
  v_exp_f32 v35, v35
  v_exp_f32_e64 v36, v36
  v_mfma_f32_32x32x16_bf16 v[16:31], v[108:111], v[56:59], 0
  ds_read_b128 v[224:227], v12 offset:8192
  v_exp_f32 v37, v37
  v_exp_f32 v38, v38
  v_exp_f32_e64 v39, v39
  v_mfma_f32_32x32x8_bf16 v[16:31], v[118:119], v[84:85], v[16:31]
  v_exp_f32 v40, v40
  v_exp_f32 v41, v41
  v_exp_f32 v42, v42
  v_exp_f32 v43, v43
  v_smfmac_f32_32x32x32_bf16 a[16:31], v[144:147], v[32:39], v13
  buffer_load_dwordx4 v6, s[8:11], s28 offen offset:1024 lds
  v_exp_f32 v44, v44
  v_exp_f32 v45, v45
  v_mfma_f32_32x32x16_bf16 a[160:175], v[188:191], v[216:219], a[160:175]
  v_exp_f32 v46, v46
  v_exp_f32 v47, v47
  v_exp_f32_e64 v16, v16
  v_mfma_f32_32x32x16_bf16 a[176:191], v[188:191], v[220:223], a[176:191]
  v_exp_f32 v17, v17
  v_exp_f32 v18, v18
  v_exp_f32_e64 v19, v19
  v_smfmac_f32_32x32x32_bf16 a[16:31], v[148:151], v[40:47], v13
  s_waitcnt vmcnt(17)
  buffer_load_dwordx4 v[164:167], v4, s[4:7], s27 offen offset:0
  v_exp_f32 v20, v20
  v_exp_f32_e64 v21, v21
  v_mfma_f32_32x32x16_bf16 v[32:47], v[108:111], v[60:63], 0
  ds_read_b128 v[228:231], v12 offset:12288
  v_exp_f32 v22, v22
  v_exp_f32 v23, v23
  v_exp_f32_e64 v24, v24
  v_mfma_f32_32x32x8_bf16 v[32:47], v[118:119], v[86:87], v[32:47]
  v_xor_b32 v12, s39, v12
  v_exp_f32 v25, v25
  v_exp_f32 v26, v26
  v_exp_f32 v27, v27
  v_smfmac_f32_32x32x32_bf16 a[32:47], v[144:147], v[16:23], v13
  buffer_load_dwordx4 v[100:103], v1, s[4:7], s30 offen
  v_exp_f32 v28, v28
  v_exp_f32 v29, v29
  v_mfma_f32_32x32x16_bf16 a[192:207], v[192:195], v[216:219], a[192:207]
  v_exp_f32 v30, v30
  v_exp_f32 v31, v31
  v_exp_f32_e64 v32, v32
  v_mfma_f32_32x32x16_bf16 a[208:223], v[192:195], v[220:223], a[208:223]
  v_exp_f32 v33, v33
  v_exp_f32 v34, v34
  v_exp_f32_e64 v35, v35
  v_smfmac_f32_32x32x32_bf16 a[32:47], v[148:151], v[24:31], v13
  s_waitcnt vmcnt(17)
  buffer_load_dwordx4 v[168:171], v4, s[4:7], s24 offen offset:1024
  v_exp_f32 v36, v36
  v_exp_f32_e64 v37, v37
  v_mfma_f32_32x32x16_bf16 v[16:31], v[108:111], v[64:67], 0
  v_exp_f32 v38, v38
  v_exp_f32 v39, v39
  v_exp_f32_e64 v40, v40
  v_mfma_f32_32x32x8_bf16 v[16:31], v[118:119], v[88:89], v[16:31]
  v_exp_f32 v41, v41
  v_exp_f32 v42, v42
  v_exp_f32 v43, v43
  v_exp_f32 v44, v44
  v_smfmac_f32_32x32x32_bf16 a[48:63], v[144:147], v[32:39], v13
  buffer_load_dwordx4 v7, s[8:11], s28 offen offset:2048 lds
  v_exp_f32 v45, v45
  v_exp_f32 v46, v46
  v_mfma_f32_32x32x16_bf16 a[224:239], v[196:199], v[216:219], a[224:239]
  v_exp_f32 v47, v47
  v_exp_f32 v16, v16
  v_exp_f32_e64 v17, v17
  v_smfmac_f32_32x32x32_bf16 a[48:63], v[148:151], v[40:47], v13
  s_waitcnt vmcnt(17) lgkmcnt(0)
  buffer_load_dwordx4 v[172:175], v4, s[4:7], s25 offen offset:1024
  v_exp_f32 v18, v18
  v_exp_f32_e64 v19, v19
  v_mfma_f32_32x32x16_bf16 v[32:47], v[108:111], v[68:71], 0
  v_exp_f32 v20, v20
  v_exp_f32 v21, v21
  v_exp_f32_e64 v22, v22
  v_mfma_f32_32x32x8_bf16 v[32:47], v[118:119], v[90:91], v[32:47]
  v_exp_f32 v23, v23
  v_exp_f32 v24, v24
  v_exp_f32 v25, v25
  v_exp_f32 v26, v26
  v_smfmac_f32_32x32x32_bf16 a[64:79], v[144:147], v[16:23], v13
  buffer_load_dword v114, v2, s[4:7], s30 offen
  v_exp_f32 v27, v27
  v_exp_f32 v28, v28
  v_mfma_f32_32x32x16_bf16 a[128:143], v[200:203], v[224:227], a[128:143]
  v_exp_f32 v29, v29
  v_exp_f32 v30, v30
  v_exp_f32_e64 v31, v31
  v_mfma_f32_32x32x16_bf16 a[144:159], v[200:203], v[228:231], a[144:159]
  v_exp_f32 v32, v32
  v_exp_f32 v33, v33
  v_exp_f32_e64 v34, v34
  v_smfmac_f32_32x32x32_bf16 a[64:79], v[148:151], v[24:31], v13
  s_waitcnt vmcnt(14)
  buffer_load_dwordx4 v[176:179], v4, s[4:7], s26 offen offset:1024
  v_exp_f32 v35, v35
  v_exp_f32_e64 v36, v36
  v_mfma_f32_32x32x16_bf16 v[16:31], v[108:111], v[72:75], 0
  ds_read_b128 v[216:219], v9 offset:0
  v_exp_f32 v37, v37
  v_exp_f32 v38, v38
  v_exp_f32_e64 v39, v39
  v_mfma_f32_32x32x8_bf16 v[16:31], v[118:119], v[92:93], v[16:31]
  v_exp_f32 v40, v40
  v_exp_f32 v41, v41
  v_exp_f32 v42, v42
  v_exp_f32 v43, v43
  v_smfmac_f32_32x32x32_bf16 a[80:95], v[144:147], v[32:39], v13
  buffer_load_dwordx4 v8, s[8:11], s28 offen offset:3072 lds
  v_exp_f32 v44, v44
  v_exp_f32 v45, v45
  v_mfma_f32_32x32x16_bf16 a[160:175], v[204:207], v[224:227], a[160:175]
  s_add_u32 s28, s28, s38
  v_exp_f32 v46, v46
  v_exp_f32 v47, v47
  v_exp_f32 v16, v16
  v_mfma_f32_32x32x16_bf16 a[176:191], v[204:207], v[228:231], a[176:191]
  s_add_u32 m0, s31, s41
  v_exp_f32 v17, v17
  v_exp_f32 v18, v18
  v_exp_f32 v19, v19
  v_smfmac_f32_32x32x32_bf16 a[80:95], v[148:151], v[40:47], v13
  s_waitcnt vmcnt(17)
  buffer_load_dwordx4 v[180:183], v4, s[4:7], s27 offen offset:1024
  v_exp_f32 v20, v20
  v_exp_f32_e64 v21, v21
  v_mfma_f32_32x32x16_bf16 v[32:47], v[108:111], v[76:79], 0
  s_add_u32 s33, s33, 1
  ds_read_b128 v[220:223], v9 offset:4096
  v_exp_f32 v22, v22
  v_exp_f32 v23, v23
  v_exp_f32 v24, v24
  v_mfma_f32_32x32x8_bf16 v[32:47], v[118:119], v[94:95], v[32:47]
  v_exp_f32 v25, v25
  v_exp_f32 v26, v26
  v_exp_f32_e64 v27, v27
  v_smfmac_f32_32x32x32_bf16 a[96:111], v[144:147], v[16:23], v13
  s_mov_b64 exec, s[34:35]
  buffer_load_dwordx4 v[128:131], v3, s[4:7], s30 offen offset:0
  s_mov_b64 exec, -1
  v_exp_f32 v28, v28
  v_exp_f32 v29, v29
  v_mfma_f32_32x32x16_bf16 a[192:207], v[208:211], v[224:227], a[192:207]
  v_exp_f32 v30, v30
  v_exp_f32 v31, v31
  v_exp_f32_e64 v32, v32
  v_mfma_f32_32x32x16_bf16 a[208:223], v[208:211], v[228:231], a[208:223]
  v_exp_f32 v33, v33
  v_exp_f32 v34, v34
  v_exp_f32_e64 v35, v35
  v_smfmac_f32_32x32x32_bf16 a[96:111], v[148:151], v[24:31], v13
  s_waitcnt vmcnt(17)
  buffer_load_dwordx4 v[184:187], v4, s[4:7], s24 offen offset:2048
  v_exp_f32 v36, v36
  v_exp_f32_e64 v37, v37
  v_mfma_f32_32x32x16_bf16 v[16:31], v[96:99], v[48:51], 0
  v_exp_f32 v38, v38
  v_exp_f32 v39, v39
  v_exp_f32_e64 v40, v40
  v_mfma_f32_32x32x8_bf16 v[16:31], v[112:113], v[80:81], v[16:31]
  v_exp_f32 v41, v41
  v_exp_f32 v42, v42
  v_exp_f32 v43, v43
  v_exp_f32 v44, v44
  v_smfmac_f32_32x32x32_bf16 a[112:127], v[144:147], v[32:39], v13
  buffer_load_dwordx4 v5, s[8:11], s29 offen offset:0 lds
  v_exp_f32 v45, v45
  v_exp_f32 v46, v46
  v_mfma_f32_32x32x16_bf16 a[224:239], v[212:215], v[224:227], a[224:239]
  v_exp_f32 v47, v47
  v_exp_f32 v16, v16
  v_exp_f32_e64 v17, v17
  s_cmp_lt_u32 s33, 4
  s_cbranch_scc1 K2_LOOP
  v_smfmac_f32_32x32x32_bf16 a[112:127], v[148:151], v[40:47], v13
  s_bitcmp1_b32 s20, 0
  s_cbranch_scc1 K2_T1
  ds_write_b128 v15, a[144:147] offset:0
  ds_write_b128 v15, a[148:151] offset:1024
  ds_write_b128 v15, a[176:179] offset:2048
  ds_write_b128 v15, a[180:183] offset:3072
  ds_write_b128 v15, a[208:211] offset:4096
  ds_write_b128 v15, a[212:215] offset:5120
  s_mul_i32 s21, s20, 10240
  s_add_u32 s21, s21, 4096
  v_add_u32 v9, s21, v255
  v_add_u32 v10, 4096, v9
  v_add_u32 v11, 8192, v9
  v_accvgpr_read_b32 v48, a0
  v_accvgpr_read_b32 v49, a1
  v_accvgpr_read_b32 v50, a2
  v_accvgpr_read_b32 v51, a3
  v_accvgpr_read_b32 v52, a4
  v_accvgpr_read_b32 v53, a5
  v_accvgpr_read_b32 v54, a6
  v_accvgpr_read_b32 v55, a7
  v_accvgpr_read_b32 v56, a8
  v_accvgpr_read_b32 v57, a9
  v_accvgpr_read_b32 v58, a10
  v_accvgpr_read_b32 v59, a11
  v_accvgpr_read_b32 v60, a16
  v_accvgpr_read_b32 v61, a17
  v_accvgpr_read_b32 v62, a18
  v_accvgpr_read_b32 v63, a19
  v_accvgpr_read_b32 v64, a20
  v_accvgpr_read_b32 v65, a21
  v_accvgpr_read_b32 v66, a22
  v_accvgpr_read_b32 v67, a23
  v_accvgpr_read_b32 v68, a24
  v_accvgpr_read_b32 v69, a25
  v_accvgpr_read_b32 v70, a26
  v_accvgpr_read_b32 v71, a27
  s_waitcnt vmcnt(0)
  ds_write_b128 v14, a[152:155] offset:2048
  ds_write_b128 v14, a[156:159] offset:3072
  buffer_load_dwordx4 a[0:3], v255, s[12:15], s72 offen
  buffer_load_dwordx4 a[4:7], v255, s[12:15], s73 offen
  ds_write_b128 v14, a[184:187] offset:6144
  ds_write_b128 v14, a[188:191] offset:7168
  s_waitcnt lgkmcnt(2)
  buffer_load_dwordx4 a[8:11], v255, s[12:15], s74 offen
  buffer_load_dwordx4 a[12:15], v255, s[12:15], s75 offen
  ds_write_b128 v14, a[216:219] offset:10240
  ds_write_b128 v14, a[220:223] offset:11264
  s_waitcnt lgkmcnt(2)
  buffer_load_dwordx4 a[16:19], v255, s[12:15], s76 offen
  buffer_load_dwordx4 a[20:23], v9, s[12:15], s72 offen offset:0
  ds_write_b128 v14, a[136:139] offset:0
  ds_write_b128 v14, a[140:143] offset:1024
  s_waitcnt lgkmcnt(2)
  buffer_load_dwordx4 a[24:27], v9, s[12:15], s73 offen offset:0
  buffer_load_dwordx4 a[28:31], v9, s[12:15], s74 offen offset:0
  v_accvgpr_read_b32 v16, a128
  v_accvgpr_read_b32 v17, a129
  v_accvgpr_read_b32 v18, a130
  v_accvgpr_read_b32 v19, a131
  v_accvgpr_read_b32 v20, a132
  v_accvgpr_read_b32 v21, a133
  v_accvgpr_read_b32 v22, a134
  v_accvgpr_read_b32 v23, a135
  ds_write_b128 v14, a[168:171] offset:4096
  ds_write_b128 v14, a[172:175] offset:5120
  s_waitcnt lgkmcnt(2)
  v_accvgpr_read_b32 v24, a160
  v_accvgpr_read_b32 v25, a161
  v_accvgpr_read_b32 v26, a162
  v_accvgpr_read_b32 v27, a163
  v_accvgpr_read_b32 v28, a164
  v_accvgpr_read_b32 v29, a165
  v_accvgpr_read_b32 v30, a166
  v_accvgpr_read_b32 v31, a167
  ds_write_b128 v14, a[200:203] offset:8192
  ds_write_b128 v14, a[204:207] offset:9216
  s_waitcnt lgkmcnt(2)
  v_accvgpr_read_b32 v32, a192
  v_accvgpr_read_b32 v33, a193
  v_accvgpr_read_b32 v34, a194
  v_accvgpr_read_b32 v35, a195
  v_accvgpr_read_b32 v36, a196
  v_accvgpr_read_b32 v37, a197
  v_accvgpr_read_b32 v38, a198
  v_accvgpr_read_b32 v39, a199
  ds_write_b128 v14, a[232:235] offset:12288
  ds_write_b128 v14, a[236:239] offset:13312
  s_waitcnt lgkmcnt(2)
  v_accvgpr_read_b32 v40, a224
  v_accvgpr_read_b32 v41, a225
  v_accvgpr_read_b32 v42, a226
  v_accvgpr_read_b32 v43, a227
  v_accvgpr_read_b32 v44, a228
  v_accvgpr_read_b32 v45, a229
  v_accvgpr_read_b32 v46, a230
  v_accvgpr_read_b32 v47, a231
  v_lshlrev_b32 v248, 16, v248
  v_xor_b32 v5, 0x8000, v14
  v_xor_b32 v6, 0x10000, v14
  v_xor_b32 v7, 0x18000, v14
  v_add_u32 v8, 0x1800, v15
  v_pk_add_f32 v[16:17], v[16:17], v[248:249] op_sel_hi:[1,0]
  v_pk_add_f32 v[18:19], v[18:19], v[248:249] op_sel_hi:[1,0]
  v_pk_add_f32 v[20:21], v[20:21], v[248:249] op_sel_hi:[1,0]
  v_pk_add_f32 v[22:23], v[22:23], v[248:249] op_sel_hi:[1,0]
  v_pk_add_f32 v[24:25], v[24:25], v[248:249] op_sel_hi:[1,0]
  v_pk_add_f32 v[26:27], v[26:27], v[248:249] op_sel_hi:[1,0]
  v_pk_add_f32 v[28:29], v[28:29], v[248:249] op_sel_hi:[1,0]
  v_pk_add_f32 v[30:31], v[30:31], v[248:249] op_sel_hi:[1,0]
  v_pk_add_f32 v[32:33], v[32:33], v[248:249] op_sel_hi:[1,0]
  v_pk_add_f32 v[34:35], v[34:35], v[248:249] op_sel_hi:[1,0]
  v_pk_add_f32 v[36:37], v[36:37], v[248:249] op_sel_hi:[1,0]
  v_pk_add_f32 v[38:39], v[38:39], v[248:249] op_sel_hi:[1,0]
  v_pk_add_f32 v[40:41], v[40:41], v[248:249] op_sel_hi:[1,0]
  v_pk_add_f32 v[42:43], v[42:43], v[248:249] op_sel_hi:[1,0]
  v_pk_add_f32 v[44:45], v[44:45], v[248:249] op_sel_hi:[1,0]
  v_pk_add_f32 v[46:47], v[46:47], v[248:249] op_sel_hi:[1,0]
  s_waitcnt lgkmcnt(0)
  s_barrier
  ds_read_b128 v[72:75], v8 offset:0
  ds_read_b128 v[80:83], v6 offset:0
  ds_read_b128 v[88:91], v7 offset:0
  ds_read_b128 v[76:79], v8 offset:1024
  ds_read_b128 v[84:87], v6 offset:1024
  ds_read_b128 v[92:95], v7 offset:1024
  s_add_u32 s90, s90, s93
  s_add_u32 s91, s91, s93
  s_add_u32 s92, s92, s93
  ds_read_b128 v[96:99], v8 offset:2048
  ds_read_b128 v[104:107], v6 offset:4096
  ds_read_b128 v[112:115], v7 offset:4096
  ds_read_b128 v[100:103], v8 offset:3072
  ds_read_b128 v[108:111], v6 offset:5120
  ds_read_b128 v[116:119], v7 offset:5120
  s_waitcnt lgkmcnt(6)
  ds_write_b128 v14, a[32:35] offset:14336
  ds_write_b128 v14, a[36:39] offset:15360
  ds_write_b128 v14, a[40:43] offset:16384
  ds_write_b128 v14, a[48:51] offset:17408
  ds_write_b128 v14, a[52:55] offset:18432
  ds_write_b128 v14, a[56:59] offset:19456
  v_pk_add_f32 v[72:73], v[72:73], v[80:81]
  v_pk_add_f32 v[16:17], v[16:17], v[88:89]
  v_pk_add_f32 v[74:75], v[74:75], v[82:83]
  v_pk_add_f32 v[18:19], v[18:19], v[90:91]
  v_pk_add_f32 v[76:77], v[76:77], v[84:85]
  v_pk_add_f32 v[20:21], v[20:21], v[92:93]
  v_pk_add_f32 v[78:79], v[78:79], v[86:87]
  v_pk_add_f32 v[22:23], v[22:23], v[94:95]
  v_pk_add_f32 v[16:17], v[16:17], v[72:73]
  v_pk_add_f32 v[18:19], v[18:19], v[74:75]
  v_pk_add_f32 v[20:21], v[20:21], v[76:77]
  v_pk_add_f32 v[22:23], v[22:23], v[78:79]
  v_lshlrev_b32 v72, 16, v232
  v_and_b32 v73, 0xffff0000, v232
  v_lshlrev_b32 v74, 16, v233
  v_and_b32 v75, 0xffff0000, v233
  v_lshlrev_b32 v76, 16, v234
  v_and_b32 v77, 0xffff0000, v234
  v_lshlrev_b32 v78, 16, v235
  v_and_b32 v79, 0xffff0000, v235
  v_pk_mul_f32 v[16:17], v[16:17], v[72:73]
  v_pk_mul_f32 v[18:19], v[18:19], v[74:75]
  v_pk_mul_f32 v[20:21], v[20:21], v[76:77]
  v_pk_mul_f32 v[22:23], v[22:23], v[78:79]
  v_cvt_pk_bf16_f32 v232, v16, v17
  v_cvt_pk_bf16_f32 v233, v18, v19
  v_cvt_pk_bf16_f32 v234, v20, v21
  v_cvt_pk_bf16_f32 v235, v22, v23
  buffer_store_dwordx4 v[232:235], v255, s[12:15], s90 offen offset:0 sc1
  ds_read_b128 v[120:123], v8 offset:4096
  ds_read_b128 v[128:131], v6 offset:8192
  ds_read_b128 v[136:139], v7 offset:8192
  ds_read_b128 v[124:127], v8 offset:5120
  ds_read_b128 v[132:135], v6 offset:9216
  ds_read_b128 v[140:143], v7 offset:9216
  s_waitcnt lgkmcnt(12)
  ds_write_b128 v14, a[64:67] offset:20480
  ds_write_b128 v14, a[68:71] offset:21504
  ds_write_b128 v14, a[72:75] offset:22528
  ds_write_b128 v14, a[80:83] offset:23552
  ds_write_b128 v14, a[84:87] offset:24576
  ds_write_b128 v14, a[88:91] offset:25600
  v_pk_add_f32 v[96:97], v[96:97], v[104:105]
  v_pk_add_f32 v[24:25], v[24:25], v[112:113]
  v_pk_add_f32 v[98:99], v[98:99], v[106:107]
  v_pk_add_f32 v[26:27], v[26:27], v[114:115]
  v_pk_add_f32 v[100:101], v[100:101], v[108:109]
  v_pk_add_f32 v[28:29], v[28:29], v[116:117]
  v_pk_add_f32 v[102:103], v[102:103], v[110:111]
  v_pk_add_f32 v[30:31], v[30:31], v[118:119]
  v_pk_add_f32 v[24:25], v[24:25], v[96:97]
  v_pk_add_f32 v[26:27], v[26:27], v[98:99]
  v_pk_add_f32 v[28:29], v[28:29], v[100:101]
  v_pk_add_f32 v[30:31], v[30:31], v[102:103]
  v_lshlrev_b32 v96, 16, v236
  v_and_b32 v97, 0xffff0000, v236
  v_lshlrev_b32 v98, 16, v237
  v_and_b32 v99, 0xffff0000, v237
  v_lshlrev_b32 v100, 16, v238
  v_and_b32 v101, 0xffff0000, v238
  v_lshlrev_b32 v102, 16, v239
  v_and_b32 v103, 0xffff0000, v239
  v_pk_mul_f32 v[24:25], v[24:25], v[96:97]
  v_pk_mul_f32 v[26:27], v[26:27], v[98:99]
  v_pk_mul_f32 v[28:29], v[28:29], v[100:101]
  v_pk_mul_f32 v[30:31], v[30:31], v[102:103]
  v_cvt_pk_bf16_f32 v236, v24, v25
  v_cvt_pk_bf16_f32 v237, v26, v27
  v_cvt_pk_bf16_f32 v238, v28, v29
  v_cvt_pk_bf16_f32 v239, v30, v31
  buffer_store_dwordx4 v[236:239], v255, s[12:15], s90 offen offset:2048 sc1
  ds_read_b128 v[144:147], v8 offset:6144
  ds_read_b128 v[152:155], v6 offset:12288
  ds_read_b128 v[160:163], v7 offset:12288
  ds_read_b128 v[148:151], v8 offset:7168
  ds_read_b128 v[156:159], v6 offset:13312
  ds_read_b128 v[164:167], v7 offset:13312
  s_waitcnt lgkmcnt(12)
  ds_write_b128 v14, a[96:99] offset:26624
  ds_write_b128 v14, a[100:103] offset:27648
  ds_write_b128 v14, a[104:107] offset:28672
  v_pk_add_f32 v[120:121], v[120:121], v[128:129]
  v_pk_add_f32 v[32:33], v[32:33], v[136:137]
  v_pk_add_f32 v[122:123], v[122:123], v[130:131]
  v_pk_add_f32 v[34:35], v[34:35], v[138:139]
  v_pk_add_f32 v[124:125], v[124:125], v[132:133]
  v_pk_add_f32 v[36:37], v[36:37], v[140:141]
  v_pk_add_f32 v[126:127], v[126:127], v[134:135]
  v_pk_add_f32 v[38:39], v[38:39], v[142:143]
  v_pk_add_f32 v[32:33], v[32:33], v[120:121]
  v_pk_add_f32 v[34:35], v[34:35], v[122:123]
  v_pk_add_f32 v[36:37], v[36:37], v[124:125]
  v_pk_add_f32 v[38:39], v[38:39], v[126:127]
  v_lshlrev_b32 v120, 16, v240
  v_and_b32 v121, 0xffff0000, v240
  v_lshlrev_b32 v122, 16, v241
  v_and_b32 v123, 0xffff0000, v241
  v_lshlrev_b32 v124, 16, v242
  v_and_b32 v125, 0xffff0000, v242
  v_lshlrev_b32 v126, 16, v243
  v_and_b32 v127, 0xffff0000, v243
  v_pk_mul_f32 v[32:33], v[32:33], v[120:121]
  v_pk_mul_f32 v[34:35], v[34:35], v[122:123]
  v_pk_mul_f32 v[36:37], v[36:37], v[124:125]
  v_pk_mul_f32 v[38:39], v[38:39], v[126:127]
  v_cvt_pk_bf16_f32 v240, v32, v33
  v_cvt_pk_bf16_f32 v241, v34, v35
  v_cvt_pk_bf16_f32 v242, v36, v37
  v_cvt_pk_bf16_f32 v243, v38, v39
  buffer_store_dwordx4 v[240:243], v255, s[12:15], s91 offen offset:0 sc1
  s_waitcnt lgkmcnt(3)
  ds_write_b128 v14, a[112:115] offset:29696
  ds_write_b128 v14, a[116:119] offset:30720
  ds_write_b128 v14, a[120:123] offset:31744
  v_pk_add_f32 v[144:145], v[144:145], v[152:153]
  v_pk_add_f32 v[40:41], v[40:41], v[160:161]
  v_pk_add_f32 v[146:147], v[146:147], v[154:155]
  v_pk_add_f32 v[42:43], v[42:43], v[162:163]
  v_pk_add_f32 v[148:149], v[148:149], v[156:157]
  v_pk_add_f32 v[44:45], v[44:45], v[164:165]
  v_pk_add_f32 v[150:151], v[150:151], v[158:159]
  v_pk_add_f32 v[46:47], v[46:47], v[166:167]
  v_pk_add_f32 v[40:41], v[40:41], v[144:145]
  v_pk_add_f32 v[42:43], v[42:43], v[146:147]
  v_pk_add_f32 v[44:45], v[44:45], v[148:149]
  v_pk_add_f32 v[46:47], v[46:47], v[150:151]
  v_lshlrev_b32 v144, 16, v244
  v_and_b32 v145, 0xffff0000, v244
  v_lshlrev_b32 v146, 16, v245
  v_and_b32 v147, 0xffff0000, v245
  v_lshlrev_b32 v148, 16, v246
  v_and_b32 v149, 0xffff0000, v246
  v_lshlrev_b32 v150, 16, v247
  v_and_b32 v151, 0xffff0000, v247
  v_pk_mul_f32 v[40:41], v[40:41], v[144:145]
  v_pk_mul_f32 v[42:43], v[42:43], v[146:147]
  v_pk_mul_f32 v[44:45], v[44:45], v[148:149]
  v_pk_mul_f32 v[46:47], v[46:47], v[150:151]
  v_cvt_pk_bf16_f32 v244, v40, v41
  v_cvt_pk_bf16_f32 v245, v42, v43
  v_cvt_pk_bf16_f32 v246, v44, v45
  v_cvt_pk_bf16_f32 v247, v46, v47
  s_cmp_ge_u32 s45, 6
  s_cbranch_scc1 K2_NOX
  buffer_store_dwordx4 v[244:247], v255, s[12:15], s92 offen offset:0 sc1
K2_NOX:
  s_waitcnt lgkmcnt(0)
  s_branch K2_T2
K2_T1:
  ds_write_b128 v15, a[128:131] offset:0
  ds_write_b128 v15, a[132:135] offset:1024
  ds_write_b128 v15, a[160:163] offset:2048
  ds_write_b128 v15, a[164:167] offset:3072
  ds_write_b128 v15, a[192:195] offset:4096
  ds_write_b128 v15, a[196:199] offset:5120
  ds_write_b128 v15, a[224:227] offset:6144
  ds_write_b128 v15, a[228:231] offset:7168
  s_mul_i32 s21, s20, 10240
  s_add_u32 s21, s21, 4096
  v_add_u32 v9, s21, v255
  v_add_u32 v10, 4096, v9
  v_add_u32 v11, 8192, v9
  v_accvgpr_read_b32 v48, a0
  v_accvgpr_read_b32 v49, a1
  v_accvgpr_read_b32 v50, a2
  v_accvgpr_read_b32 v51, a3
  v_accvgpr_read_b32 v52, a4
  v_accvgpr_read_b32 v53, a5
  v_accvgpr_read_b32 v54, a6
  v_accvgpr_read_b32 v55, a7
  v_accvgpr_read_b32 v56, a8
  v_accvgpr_read_b32 v57, a9
  v_accvgpr_read_b32 v58, a10
  v_accvgpr_read_b32 v59, a11
  v_accvgpr_read_b32 v60, a16
  v_accvgpr_read_b32 v61, a17
  v_accvgpr_read_b32 v62, a18
  v_accvgpr_read_b32 v63, a19
  v_accvgpr_read_b32 v64, a20
  v_accvgpr_read_b32 v65, a21
  v_accvgpr_read_b32 v66, a22
  v_accvgpr_read_b32 v67, a23
  v_accvgpr_read_b32 v68, a24
  v_accvgpr_read_b32 v69, a25
  v_accvgpr_read_b32 v70, a26
  v_accvgpr_read_b32 v71, a27
  s_waitcnt vmcnt(0)
  ds_write_b128 v14, a[136:139] offset:0
  ds_write_b128 v14, a[140:143] offset:1024
  buffer_load_dwordx4 a[0:3], v255, s[12:15], s72 offen
  buffer_load_dwordx4 a[4:7], v255, s[12:15], s73 offen
  ds_write_b128 v14, a[168:171] offset:4096
  ds_write_b128 v14, a[172:175] offset:5120
  s_waitcnt lgkmcnt(2)
  buffer_load_dwordx4 a[8:11], v255, s[12:15], s74 offen
  buffer_load_dwordx4 a[12:15], v255, s[12:15], s75 offen
  ds_write_b128 v14, a[200:203] offset:8192
  ds_write_b128 v14, a[204:207] offset:9216
  s_waitcnt lgkmcnt(2)
  buffer_load_dwordx4 a[16:19], v255, s[12:15], s76 offen
  buffer_load_dwordx4 a[20:23], v9, s[12:15], s72 offen offset:0
  ds_write_b128 v14, a[232:235] offset:12288
  ds_write_b128 v14, a[236:239] offset:13312
  s_waitcnt lgkmcnt(2)
  buffer_load_dwordx4 a[24:27], v9, s[12:15], s73 offen offset:0
  buffer_load_dwordx4 a[28:31], v9, s[12:15], s74 offen offset:0
  ds_write_b128 v14, a[152:155] offset:2048
  ds_write_b128 v14, a[156:159] offset:3072
  s_waitcnt lgkmcnt(2)
  v_accvgpr_read_b32 v16, a144
  v_accvgpr_read_b32 v17, a145
  v_accvgpr_read_b32 v18, a146
  v_accvgpr_read_b32 v19, a147
  v_accvgpr_read_b32 v20, a148
  v_accvgpr_read_b32 v21, a149
  v_accvgpr_read_b32 v22, a150
  v_accvgpr_read_b32 v23, a151
  ds_write_b128 v14, a[184:187] offset:6144
  ds_write_b128 v14, a[188:191] offset:7168
  s_waitcnt lgkmcnt(2)
  v_accvgpr_read_b32 v24, a176
  v_accvgpr_read_b32 v25, a177
  v_accvgpr_read_b32 v26, a178
  v_accvgpr_read_b32 v27, a179
  v_accvgpr_read_b32 v28, a180
  v_accvgpr_read_b32 v29, a181
  v_accvgpr_read_b32 v30, a182
  v_accvgpr_read_b32 v31, a183
  ds_write_b128 v14, a[216:219] offset:10240
  ds_write_b128 v14, a[220:223] offset:11264
  s_waitcnt lgkmcnt(2)
  v_accvgpr_read_b32 v32, a208
  v_accvgpr_read_b32 v33, a209
  v_accvgpr_read_b32 v34, a210
  v_accvgpr_read_b32 v35, a211
  v_accvgpr_read_b32 v36, a212
  v_accvgpr_read_b32 v37, a213
  v_accvgpr_read_b32 v38, a214
  v_accvgpr_read_b32 v39, a215
  v_lshlrev_b32 v248, 16, v248
  v_xor_b32 v5, 0x8000, v14
  v_xor_b32 v6, 0x10000, v14
  v_xor_b32 v7, 0x18000, v14
  v_add_u32 v8, 0xffffe800, v15
  v_pk_add_f32 v[16:17], v[16:17], v[248:249] op_sel_hi:[1,0]
  v_pk_add_f32 v[18:19], v[18:19], v[248:249] op_sel_hi:[1,0]
  v_pk_add_f32 v[20:21], v[20:21], v[248:249] op_sel_hi:[1,0]
  v_pk_add_f32 v[22:23], v[22:23], v[248:249] op_sel_hi:[1,0]
  v_pk_add_f32 v[24:25], v[24:25], v[248:249] op_sel_hi:[1,0]
  v_pk_add_f32 v[26:27], v[26:27], v[248:249] op_sel_hi:[1,0]
  v_pk_add_f32 v[28:29], v[28:29], v[248:249] op_sel_hi:[1,0]
  v_pk_add_f32 v[30:31], v[30:31], v[248:249] op_sel_hi:[1,0]
  v_pk_add_f32 v[32:33], v[32:33], v[248:249] op_sel_hi:[1,0]
  v_pk_add_f32 v[34:35], v[34:35], v[248:249] op_sel_hi:[1,0]
  v_pk_add_f32 v[36:37], v[36:37], v[248:249] op_sel_hi:[1,0]
  v_pk_add_f32 v[38:39], v[38:39], v[248:249] op_sel_hi:[1,0]
  s_waitcnt lgkmcnt(0)
  s_barrier
  ds_read_b128 v[72:75], v8 offset:0
  ds_read_b128 v[80:83], v6 offset:2048
  ds_read_b128 v[88:91], v7 offset:2048
  ds_read_b128 v[76:79], v8 offset:1024
  ds_read_b128 v[84:87], v6 offset:3072
  ds_read_b128 v[92:95], v7 offset:3072
  s_add_u32 s90, s90, s93
  s_add_u32 s91, s91, s93
  s_add_u32 s92, s92, s93
  ds_read_b128 v[96:99], v8 offset:2048
  ds_read_b128 v[104:107], v6 offset:6144
  ds_read_b128 v[112:115], v7 offset:6144
  ds_read_b128 v[100:103], v8 offset:3072
  ds_read_b128 v[108:111], v6 offset:7168
  ds_read_b128 v[116:119], v7 offset:7168
  s_waitcnt lgkmcnt(6)
  ds_write_b128 v14, a[32:35] offset:14336
  ds_write_b128 v14, a[36:39] offset:15360
  ds_write_b128 v14, a[40:43] offset:16384
  ds_write_b128 v14, a[48:51] offset:17408
  ds_write_b128 v14, a[52:55] offset:18432
  ds_write_b128 v14, a[56:59] offset:19456
  v_pk_add_f32 v[72:73], v[72:73], v[80:81]
  v_pk_add_f32 v[16:17], v[16:17], v[88:89]
  v_pk_add_f32 v[74:75], v[74:75], v[82:83]
  v_pk_add_f32 v[18:19], v[18:19], v[90:91]
  v_pk_add_f32 v[76:77], v[76:77], v[84:85]
  v_pk_add_f32 v[20:21], v[20:21], v[92:93]
  v_pk_add_f32 v[78:79], v[78:79], v[86:87]
  v_pk_add_f32 v[22:23], v[22:23], v[94:95]
  v_pk_add_f32 v[16:17], v[16:17], v[72:73]
  v_pk_add_f32 v[18:19], v[18:19], v[74:75]
  v_pk_add_f32 v[20:21], v[20:21], v[76:77]
  v_pk_add_f32 v[22:23], v[22:23], v[78:79]
  v_lshlrev_b32 v72, 16, v232
  v_and_b32 v73, 0xffff0000, v232
  v_lshlrev_b32 v74, 16, v233
  v_and_b32 v75, 0xffff0000, v233
  v_lshlrev_b32 v76, 16, v234
  v_and_b32 v77, 0xffff0000, v234
  v_lshlrev_b32 v78, 16, v235
  v_and_b32 v79, 0xffff0000, v235
  v_pk_mul_f32 v[16:17], v[16:17], v[72:73]
  v_pk_mul_f32 v[18:19], v[18:19], v[74:75]
  v_pk_mul_f32 v[20:21], v[20:21], v[76:77]
  v_pk_mul_f32 v[22:23], v[22:23], v[78:79]
  v_cvt_pk_bf16_f32 v232, v16, v17
  v_cvt_pk_bf16_f32 v233, v18, v19
  v_cvt_pk_bf16_f32 v234, v20, v21
  v_cvt_pk_bf16_f32 v235, v22, v23
  buffer_store_dwordx4 v[232:235], v255, s[12:15], s90 offen offset:0 sc1
  ds_read_b128 v[120:123], v8 offset:4096
  ds_read_b128 v[128:131], v6 offset:10240
  ds_read_b128 v[136:139], v7 offset:10240
  ds_read_b128 v[124:127], v8 offset:5120
  ds_read_b128 v[132:135], v6 offset:11264
  ds_read_b128 v[140:143], v7 offset:11264
  s_waitcnt lgkmcnt(12)
  ds_write_b128 v14, a[64:67] offset:20480
  ds_write_b128 v14, a[68:71] offset:21504
  ds_write_b128 v14, a[72:75] offset:22528
  ds_write_b128 v14, a[80:83] offset:23552
  ds_write_b128 v14, a[84:87] offset:24576
  ds_write_b128 v14, a[88:91] offset:25600
  v_pk_add_f32 v[96:97], v[96:97], v[104:105]
  v_pk_add_f32 v[24:25], v[24:25], v[112:113]
  v_pk_add_f32 v[98:99], v[98:99], v[106:107]
  v_pk_add_f32 v[26:27], v[26:27], v[114:115]
  v_pk_add_f32 v[100:101], v[100:101], v[108:109]
  v_pk_add_f32 v[28:29], v[28:29], v[116:117]
  v_pk_add_f32 v[102:103], v[102:103], v[110:111]
  v_pk_add_f32 v[30:31], v[30:31], v[118:119]
  v_pk_add_f32 v[24:25], v[24:25], v[96:97]
  v_pk_add_f32 v[26:27], v[26:27], v[98:99]
  v_pk_add_f32 v[28:29], v[28:29], v[100:101]
  v_pk_add_f32 v[30:31], v[30:31], v[102:103]
  v_lshlrev_b32 v96, 16, v236
  v_and_b32 v97, 0xffff0000, v236
  v_lshlrev_b32 v98, 16, v237
  v_and_b32 v99, 0xffff0000, v237
  v_lshlrev_b32 v100, 16, v238
  v_and_b32 v101, 0xffff0000, v238
  v_lshlrev_b32 v102, 16, v239
  v_and_b32 v103, 0xffff0000, v239
  v_pk_mul_f32 v[24:25], v[24:25], v[96:97]
  v_pk_mul_f32 v[26:27], v[26:27], v[98:99]
  v_pk_mul_f32 v[28:29], v[28:29], v[100:101]
  v_pk_mul_f32 v[30:31], v[30:31], v[102:103]
  v_cvt_pk_bf16_f32 v236, v24, v25
  v_cvt_pk_bf16_f32 v237, v26, v27
  v_cvt_pk_bf16_f32 v238, v28, v29
  v_cvt_pk_bf16_f32 v239, v30, v31
  buffer_store_dwordx4 v[236:239], v255, s[12:15], s90 offen offset:2048 sc1
  s_waitcnt lgkmcnt(6)
  ds_write_b128 v14, a[96:99] offset:26624
  ds_write_b128 v14, a[100:103] offset:27648
  ds_write_b128 v14, a[104:107] offset:28672
  ds_write_b128 v14, a[112:115] offset:29696
  ds_write_b128 v14, a[116:119] offset:30720
  ds_write_b128 v14, a[120:123] offset:31744
  v_pk_add_f32 v[120:121], v[120:121], v[128:129]
  v_pk_add_f32 v[32:33], v[32:33], v[136:137]
  v_pk_add_f32 v[122:123], v[122:123], v[130:131]
  v_pk_add_f32 v[34:35], v[34:35], v[138:139]
  v_pk_add_f32 v[124:125], v[124:125], v[132:133]
  v_pk_add_f32 v[36:37], v[36:37], v[140:141]
  v_pk_add_f32 v[126:127], v[126:127], v[134:135]
  v_pk_add_f32 v[38:39], v[38:39], v[142:143]
  v_pk_add_f32 v[32:33], v[32:33], v[120:121]
  v_pk_add_f32 v[34:35], v[34:35], v[122:123]
  v_pk_add_f32 v[36:37], v[36:37], v[124:125]
  v_pk_add_f32 v[38:39], v[38:39], v[126:127]
  v_lshlrev_b32 v120, 16, v240
  v_and_b32 v121, 0xffff0000, v240
  v_lshlrev_b32 v122, 16, v241
  v_and_b32 v123, 0xffff0000, v241
  v_lshlrev_b32 v124, 16, v242
  v_and_b32 v125, 0xffff0000, v242
  v_lshlrev_b32 v126, 16, v243
  v_and_b32 v127, 0xffff0000, v243
  v_pk_mul_f32 v[32:33], v[32:33], v[120:121]
  v_pk_mul_f32 v[34:35], v[34:35], v[122:123]
  v_pk_mul_f32 v[36:37], v[36:37], v[124:125]
  v_pk_mul_f32 v[38:39], v[38:39], v[126:127]
  v_cvt_pk_bf16_f32 v240, v32, v33
  v_cvt_pk_bf16_f32 v241, v34, v35
  v_cvt_pk_bf16_f32 v242, v36, v37
  v_cvt_pk_bf16_f32 v243, v38, v39
  buffer_store_dwordx4 v[240:243], v255, s[12:15], s91 offen offset:0 sc1
  s_waitcnt lgkmcnt(0)
K2_T2:
  s_barrier
  ds_read_b128 v[72:75], v5 offset:14336
  ds_read_b128 v[76:79], v6 offset:20480
  ds_read_b128 v[80:83], v7 offset:26624
  ds_read_b128 v[84:87], v5 offset:15360
  ds_read_b128 v[88:91], v6 offset:21504
  ds_read_b128 v[92:95], v7 offset:27648
  ds_read_b128 v[96:99], v5 offset:16384
  ds_read_b128 v[100:103], v6 offset:22528
  ds_read_b128 v[104:107], v7 offset:28672
  ds_read_b128 v[108:111], v5 offset:17408
  ds_read_b128 v[112:115], v6 offset:23552
  ds_read_b128 v[116:119], v7 offset:29696
  ds_read_b128 v[120:123], v5 offset:18432
  ds_read_b128 v[124:127], v6 offset:24576
  ds_read_b128 v[128:131], v7 offset:30720
  s_lshl2_add_u32 s21, s43, s20
  s_mul_i32 s21, s21, 192512
  s_lshl_b32 s30, s42, 10
  s_add_u32 s30, s30, s21
  s_add_u32 s30, s30, 17571840
  s_add_u32 s32, s30, 96256
  s_lshr_b32 s22, s42, 2
  s_xor_b32 s22, s22, s42
  s_bitcmp1_b32 s22, 2
  s_cselect_b32 s28, 96256, 0
  s_add_u32 s28, s28, s21
  s_lshr_b32 s21, s42, 3
  s_and_b32 s22, s42, 3
  s_lshl2_add_u32 s21, s21, s22
  s_lshl_b32 s21, s21, 9
  s_add_u32 s28, s28, s21
  s_add_u32 s28, s28, 17563648
  s_waitcnt lgkmcnt(12)
  ds_read_b128 v[132:135], v5 offset:19456
  ds_read_b128 v[136:139], v6 offset:25600
  ds_read_b128 v[140:143], v7 offset:31744
  v_pk_add_f32 v[72:73], v[72:73], v[76:77]
  v_pk_add_f32 v[48:49], v[48:49], v[80:81]
  v_pk_add_f32 v[74:75], v[74:75], v[78:79]
  v_pk_add_f32 v[50:51], v[50:51], v[82:83]
  v_pk_add_f32 v[48:49], v[48:49], v[72:73]
  v_pk_add_f32 v[50:51], v[50:51], v[74:75]
  s_waitcnt lgkmcnt(12)
  v_pk_add_f32 v[84:85], v[84:85], v[88:89]
  v_pk_add_f32 v[52:53], v[52:53], v[92:93]
  v_pk_add_f32 v[86:87], v[86:87], v[90:91]
  v_pk_add_f32 v[54:55], v[54:55], v[94:95]
  v_pk_add_f32 v[52:53], v[52:53], v[84:85]
  v_pk_add_f32 v[54:55], v[54:55], v[86:87]
  s_waitcnt lgkmcnt(9)
  v_pk_add_f32 v[96:97], v[96:97], v[100:101]
  v_pk_add_f32 v[56:57], v[56:57], v[104:105]
  v_pk_add_f32 v[98:99], v[98:99], v[102:103]
  v_pk_add_f32 v[58:59], v[58:59], v[106:107]
  v_pk_add_f32 v[56:57], v[56:57], v[96:97]
  v_pk_add_f32 v[58:59], v[58:59], v[98:99]
  s_waitcnt lgkmcnt(6)
  v_pk_add_f32 v[108:109], v[108:109], v[112:113]
  v_pk_add_f32 v[60:61], v[60:61], v[116:117]
  v_pk_add_f32 v[110:111], v[110:111], v[114:115]
  v_pk_add_f32 v[62:63], v[62:63], v[118:119]
  v_pk_add_f32 v[60:61], v[60:61], v[108:109]
  v_pk_add_f32 v[62:63], v[62:63], v[110:111]
  s_waitcnt lgkmcnt(3)
  v_pk_add_f32 v[120:121], v[120:121], v[124:125]
  v_pk_add_f32 v[64:65], v[64:65], v[128:129]
  v_pk_add_f32 v[122:123], v[122:123], v[126:127]
  v_pk_add_f32 v[66:67], v[66:67], v[130:131]
  v_pk_add_f32 v[64:65], v[64:65], v[120:121]
  v_pk_add_f32 v[66:67], v[66:67], v[122:123]
  s_waitcnt lgkmcnt(0)
  v_pk_add_f32 v[132:133], v[132:133], v[136:137]
  v_pk_add_f32 v[68:69], v[68:69], v[140:141]
  v_pk_add_f32 v[134:135], v[134:135], v[138:139]
  v_pk_add_f32 v[70:71], v[70:71], v[142:143]
  v_pk_add_f32 v[68:69], v[68:69], v[132:133]
  v_pk_add_f32 v[70:71], v[70:71], v[134:135]
  v_pk_mul_f32 v[72:73], v[48:49], 0 op_sel_hi:[1,0]
  v_pk_fma_f32 v[72:73], v[50:51], 0, v[72:73] op_sel_hi:[1,0,1]
  v_pk_fma_f32 v[72:73], v[52:53], 0, v[72:73] op_sel_hi:[1,0,1]
  v_pk_fma_f32 v[72:73], v[54:55], 0, v[72:73] op_sel_hi:[1,0,1]
  v_pk_fma_f32 v[72:73], v[56:57], 0, v[72:73] op_sel_hi:[1,0,1]
  v_pk_fma_f32 v[72:73], v[58:59], 0, v[72:73] op_sel_hi:[1,0,1]
  v_pk_fma_f32 v[72:73], v[60:61], 0, v[72:73] op_sel_hi:[1,0,1]
  v_pk_fma_f32 v[72:73], v[62:63], 0, v[72:73] op_sel_hi:[1,0,1]
  v_pk_fma_f32 v[72:73], v[64:65], 0, v[72:73] op_sel_hi:[1,0,1]
  v_pk_fma_f32 v[72:73], v[66:67], 0, v[72:73] op_sel_hi:[1,0,1]
  v_pk_fma_f32 v[72:73], v[68:69], 0, v[72:73] op_sel_hi:[1,0,1]
  v_pk_fma_f32 v[72:73], v[70:71], 0, v[72:73] op_sel_hi:[1,0,1]
  v_min_f32 v74, v56, v68
  v_max_f32 v75, v56, v68
  v_cmp_u_f32 s[24:25], v72, v73
  v_cmp_gt_f32 vcc, 0xc800000, v74
  s_or_b32 s25, s25, vcc_hi
  v_cmp_lt_f32 vcc, 0x7e000000, v75
  s_or_b32 s25, s25, vcc_hi
  s_or_b32 s24, s24, s25
  s_cbranch_scc1 K2_FB
K2_NORM:
  v_rcp_f32 v72, v56
  v_rcp_f32 v74, v68
  s_nop 0
  v_mov_b32 v73, v72
  v_mov_b32 v75, v74
  s_nop 1
  v_permlane32_swap_b32 v72, v73
  v_permlane32_swap_b32 v74, v75
  s_nop 1
  v_pk_mul_f32 v[48:49], v[48:49], v[72:73] op_sel:[0,1] op_sel_hi:[1,1]
  v_pk_mul_f32 v[50:51], v[50:51], v[72:73] op_sel:[0,1] op_sel_hi:[1,1]
  v_pk_mul_f32 v[52:53], v[52:53], v[72:73] op_sel:[0,1] op_sel_hi:[1,1]
  v_pk_mul_f32 v[54:55], v[54:55], v[72:73] op_sel:[0,1] op_sel_hi:[1,1]
  v_pk_mul_f32 v[56:57], v[56:57], v[72:73] op_sel:[0,1] op_sel_hi:[1,1]
  v_pk_mul_f32 v[58:59], v[58:59], v[72:73] op_sel:[0,1] op_sel_hi:[1,1]
  v_cvt_pk_bf16_f32 v168, v48, v49
  v_cvt_pk_bf16_f32 v169, v50, v51
  v_cvt_pk_bf16_f32 v170, v52, v53
  v_cvt_pk_bf16_f32 v171, v54, v55
  v_cvt_pk_bf16_f32 v176, v56, v57
  v_cvt_pk_bf16_f32 v177, v58, v59
  buffer_store_dwordx4 v[168:171], v255, s[12:15], s30 offen sc1
  v_pk_mul_f32 v[60:61], v[60:61], v[74:75] op_sel:[0,1] op_sel_hi:[1,1]
  v_pk_mul_f32 v[62:63], v[62:63], v[74:75] op_sel:[0,1] op_sel_hi:[1,1]
  v_pk_mul_f32 v[64:65], v[64:65], v[74:75] op_sel:[0,1] op_sel_hi:[1,1]
  v_pk_mul_f32 v[66:67], v[66:67], v[74:75] op_sel:[0,1] op_sel_hi:[1,1]
  v_pk_mul_f32 v[68:69], v[68:69], v[74:75] op_sel:[0,1] op_sel_hi:[1,1]
  v_pk_mul_f32 v[70:71], v[70:71], v[74:75] op_sel:[0,1] op_sel_hi:[1,1]
  v_cvt_pk_bf16_f32 v172, v60, v61
  v_cvt_pk_bf16_f32 v173, v62, v63
  v_cvt_pk_bf16_f32 v174, v64, v65
  v_cvt_pk_bf16_f32 v175, v66, v67
  v_cvt_pk_bf16_f32 v178, v68, v69
  v_cvt_pk_bf16_f32 v179, v70, v71
  buffer_store_dwordx4 v[172:175], v255, s[12:15], s32 offen sc1
  s_cmp_lt_u32 s42, 16
  s_cbranch_scc1 K2_NOSW
  v_swap_b32 v176, v178
  v_swap_b32 v177, v179
K2_NOSW:
  s_mov_b32 exec_hi, 0
  buffer_store_dwordx4 v[176:179], v255, s[12:15], s28 offen sc1
  s_mov_b32 exec_hi, -1
  buffer_load_dwordx4 a[144:147], v10, s[12:15], s73 offen offset:2048
  buffer_load_dwordx4 a[148:151], v10, s[12:15], s74 offen offset:2048
  buffer_load_dwordx4 a[152:155], v10, s[12:15], s75 offen offset:2048
  buffer_load_dwordx4 a[156:159], v10, s[12:15], s76 offen offset:2048
  buffer_load_dwordx4 a[176:179], v10, s[12:15], s76 offen offset:3072
  buffer_load_dwordx4 a[180:183], v11, s[12:15], s72 offen offset:0
  buffer_load_dwordx4 a[184:187], v11, s[12:15], s73 offen offset:0
  buffer_load_dwordx4 a[188:191], v11, s[12:15], s74 offen offset:0
  buffer_load_dwordx4 a[208:211], v11, s[12:15], s74 offen offset:1024
  buffer_load_dwordx4 a[212:215], v11, s[12:15], s75 offen offset:1024
  buffer_load_dwordx4 a[216:219], v11, s[12:15], s76 offen offset:1024
  buffer_load_dwordx4 a[220:223], v11, s[12:15], s72 offen offset:2048
  s_lshl2_add_u32 s21, s42, s20
  s_mul_i32 s21, s21, 20480
  s_mul_i32 s22, s43, 160
  s_add_u32 s21, s21, s22
  v_and_b32 v12, 15, v0
  v_lshrrev_b32 v1, 4, v0
  v_mul_u32_u24 v12, 1280, v12
  v_lshl_add_u32 v12, v1, 3, v12
  v_add_u32 v12, s21, v12
  s_mul_i32 s21, s20, 15360
  v_add_u32 v1, s21, v255
  s_xor_b32 s21, s20, 1
  s_mul_i32 s21, s21, 15360
  v_add_u32 v3, s21, v255
  s_xor_b32 s21, s20, 2
  s_mul_i32 s21, s21, 15360
  v_add_u32 v4, s21, v255
  s_xor_b32 s21, s20, 3
  s_mul_i32 s21, s21, 15360
  v_add_u32 v5, s21, v255
  s_mul_i32 s23, s20, 20480
  s_add_u32 s23, s23, 8192
  s_mov_b32 s33, 0
  s_cmp_eq_u32 s20, 0
  s_waitcnt vmcnt(12)
  s_barrier
  s_cbranch_scc0 K2_NOFLAG
  s_mov_b64 exec, 1
  buffer_store_dword v253, off, s[12:15], s81 sc1
  s_mov_b64 exec, -1
K2_NOFLAG:
  buffer_load_dwordx4 a[128:131], v10, s[12:15], s74 offen offset:1024
  buffer_load_dwordx4 a[132:135], v10, s[12:15], s75 offen offset:1024
  buffer_load_dwordx4 a[136:139], v10, s[12:15], s76 offen offset:1024
  buffer_load_dwordx4 a[140:143], v10, s[12:15], s72 offen offset:2048
  buffer_load_dwordx4 a[160:163], v10, s[12:15], s72 offen offset:3072
  buffer_load_dwordx4 a[164:167], v10, s[12:15], s73 offen offset:3072
  buffer_load_dwordx4 a[168:171], v10, s[12:15], s74 offen offset:3072
  buffer_load_dwordx4 a[172:175], v10, s[12:15], s75 offen offset:3072
  buffer_load_dwordx4 a[192:195], v11, s[12:15], s75 offen offset:0
  buffer_load_dwordx4 a[196:199], v11, s[12:15], s76 offen offset:0
  buffer_load_dwordx4 a[200:203], v11, s[12:15], s72 offen offset:1024
  buffer_load_dwordx4 a[204:207], v11, s[12:15], s73 offen offset:1024
  buffer_load_dwordx4 a[224:227], v11, s[12:15], s73 offen offset:2048
  buffer_load_dwordx4 a[228:231], v11, s[12:15], s74 offen offset:2048
  buffer_load_dwordx4 a[232:235], v11, s[12:15], s75 offen offset:2048
  buffer_load_dwordx4 a[236:239], v11, s[12:15], s76 offen offset:2048
  buffer_load_dwordx4 a[32:35], v9, s[12:15], s75 offen offset:0
  buffer_load_dwordx4 a[36:39], v9, s[12:15], s76 offen offset:0
  buffer_load_dwordx4 a[40:43], v9, s[12:15], s72 offen offset:1024
  buffer_load_dwordx4 a[44:47], v9, s[12:15], s73 offen offset:1024
  buffer_load_dwordx4 a[48:51], v9, s[12:15], s74 offen offset:1024
  buffer_load_dwordx4 a[52:55], v9, s[12:15], s75 offen offset:1024
  buffer_load_dwordx4 a[56:59], v9, s[12:15], s76 offen offset:1024
  buffer_load_dwordx4 a[60:63], v9, s[12:15], s72 offen offset:2048
  buffer_load_dwordx4 a[64:67], v9, s[12:15], s73 offen offset:2048
  buffer_load_dwordx4 a[68:71], v9, s[12:15], s74 offen offset:2048
  buffer_load_dwordx4 a[72:75], v9, s[12:15], s75 offen offset:2048
  buffer_load_dwordx4 a[76:79], v9, s[12:15], s76 offen offset:2048
  buffer_load_dwordx4 a[80:83], v9, s[12:15], s72 offen offset:3072
  buffer_load_dwordx4 a[84:87], v9, s[12:15], s73 offen offset:3072
  buffer_load_dwordx4 a[88:91], v9, s[12:15], s74 offen offset:3072
  buffer_load_dwordx4 a[92:95], v9, s[12:15], s75 offen offset:3072
  buffer_load_dwordx4 a[96:99], v9, s[12:15], s76 offen offset:3072
  buffer_load_dwordx4 a[100:103], v10, s[12:15], s72 offen offset:0
  buffer_load_dwordx4 a[104:107], v10, s[12:15], s73 offen offset:0
  buffer_load_dwordx4 a[108:111], v10, s[12:15], s74 offen offset:0
  buffer_load_dwordx4 a[112:115], v10, s[12:15], s75 offen offset:0
  buffer_load_dwordx4 a[116:119], v10, s[12:15], s76 offen offset:0
  buffer_load_dwordx4 a[120:123], v10, s[12:15], s72 offen offset:1024
  buffer_load_dwordx4 a[124:127], v10, s[12:15], s73 offen offset:1024
  s_cbranch_scc0 K2_GO
K2_POLL:
  buffer_load_dword v254, v252, s[12:15], s80 offen sc1
  s_waitcnt vmcnt(0)
  v_cmp_ne_u32 vcc, 1, v254
  s_cbranch_vccnz K2_POLL
K2_GO:
  s_barrier
  buffer_load_dwordx4 v[16:19], v250, s[12:15], s78 offen offset:0 sc1
  buffer_load_dwordx4 v[20:23], v251, s[12:15], s78 offen offset:0 sc1
  s_add_u32 s78, s78, s23
  buffer_load_dwordx4 v[24:27], v250, s[12:15], s79 offen offset:0 sc1
  buffer_load_dwordx4 v[28:31], v251, s[12:15], s79 offen offset:0 sc1
  s_add_u32 s79, s79, s23
  buffer_load_dwordx4 v[32:35], v250, s[12:15], s78 offen offset:0 sc1
  buffer_load_dwordx4 v[36:39], v251, s[12:15], s78 offen offset:0 sc1
  buffer_load_dwordx4 v[40:43], v250, s[12:15], s79 offen offset:0 sc1
  buffer_load_dwordx4 v[44:47], v251, s[12:15], s79 offen offset:0 sc1
  buffer_load_dwordx4 v[48:51], v250, s[12:15], s78 offen offset:2048 sc1
  buffer_load_dwordx4 v[52:55], v251, s[12:15], s78 offen offset:2048 sc1
  s_add_u32 s78, s78, s36
  buffer_load_dwordx4 v[56:59], v250, s[12:15], s79 offen offset:2048 sc1
  buffer_load_dwordx4 v[60:63], v251, s[12:15], s79 offen offset:2048 sc1
  s_add_u32 s79, s79, s36
  buffer_load_dwordx4 v[64:67], v250, s[12:15], s78 offen offset:0 sc1
  buffer_load_dwordx4 v[68:71], v251, s[12:15], s78 offen offset:0 sc1
  buffer_load_dwordx4 v[72:75], v250, s[12:15], s79 offen offset:0 sc1
  buffer_load_dwordx4 v[76:79], v251, s[12:15], s79 offen offset:0 sc1
  buffer_load_dwordx4 v[80:83], v250, s[12:15], s78 offen offset:2048 sc1
  buffer_load_dwordx4 v[84:87], v251, s[12:15], s78 offen offset:2048 sc1
  s_add_u32 s78, s78, s36
  buffer_load_dwordx4 v[88:91], v250, s[12:15], s79 offen offset:2048 sc1
  buffer_load_dwordx4 v[92:95], v251, s[12:15], s79 offen offset:2048 sc1
  s_add_u32 s79, s79, s36
  buffer_load_dwordx4 v[96:99], v250, s[12:15], s78 offen offset:0 sc1
  buffer_load_dwordx4 v[100:103], v251, s[12:15], s78 offen offset:0 sc1
  buffer_load_dwordx4 v[104:107], v250, s[12:15], s79 offen offset:0 sc1
  buffer_load_dwordx4 v[108:111], v251, s[12:15], s79 offen offset:0 sc1
  s_waitcnt vmcnt(21)
  v_swap_b32 v18, v24
  v_swap_b32 v19, v25
  s_waitcnt vmcnt(20)
  v_swap_b32 v22, v28
  v_swap_b32 v23, v29
  .p2align 3
  s_waitcnt vmcnt(23)
  s_nop 0
  v_mfma_f32_16x16x32_bf16 v[160:163], a[0:3], v[16:19], 0
  v_mfma_f32_16x16x32_bf16 v[164:167], a[4:7], v[16:19], 0
  buffer_load_dwordx4 v[112:115], v250, s[12:15], s78 offen offset:2048 sc1
  v_mfma_f32_16x16x32_bf16 v[168:171], a[8:11], v[16:19], 0
  v_mfma_f32_16x16x32_bf16 v[172:175], a[12:15], v[16:19], 0
  v_mfma_f32_16x16x32_bf16 v[176:179], a[16:19], v[16:19], 0
  s_waitcnt vmcnt(23)
  s_nop 0
  v_mfma_f32_16x16x32_bf16 v[180:183], a[0:3], v[20:23], 0
  v_mfma_f32_16x16x32_bf16 v[184:187], a[4:7], v[20:23], 0
  buffer_load_dwordx4 v[116:119], v251, s[12:15], s78 offen offset:2048 sc1
  s_add_u32 s78, s78, s36
  s_nop 0
  v_mfma_f32_16x16x32_bf16 v[188:191], a[8:11], v[20:23], 0
  v_mfma_f32_16x16x32_bf16 v[192:195], a[12:15], v[20:23], 0
  v_mfma_f32_16x16x32_bf16 v[196:199], a[16:19], v[20:23], 0
  s_waitcnt vmcnt(23)
  s_nop 0
  v_mfma_f32_16x16x32_bf16 v[200:203], a[0:3], v[24:27], 0
  v_mfma_f32_16x16x32_bf16 v[204:207], a[4:7], v[24:27], 0
  buffer_load_dwordx4 v[120:123], v250, s[12:15], s79 offen offset:2048 sc1
  v_mfma_f32_16x16x32_bf16 v[208:211], a[8:11], v[24:27], 0
  v_mfma_f32_16x16x32_bf16 v[212:215], a[12:15], v[24:27], 0
  v_mfma_f32_16x16x32_bf16 v[216:219], a[16:19], v[24:27], 0
  s_waitcnt vmcnt(23)
  s_nop 0
  v_mfma_f32_16x16x32_bf16 v[220:223], a[0:3], v[28:31], 0
  v_mfma_f32_16x16x32_bf16 v[224:227], a[4:7], v[28:31], 0
  buffer_load_dwordx4 v[124:127], v251, s[12:15], s79 offen offset:2048 sc1
  s_add_u32 s79, s79, s36
  s_nop 0
  v_mfma_f32_16x16x32_bf16 v[228:231], a[8:11], v[28:31], 0
  v_mfma_f32_16x16x32_bf16 v[232:235], a[12:15], v[28:31], 0
  v_mfma_f32_16x16x32_bf16 v[236:239], a[16:19], v[28:31], 0
  s_waitcnt vmcnt(23)
  s_nop 0
  v_mfma_f32_16x16x32_bf16 v[160:163], a[20:23], v[32:35], v[160:163]
  v_mfma_f32_16x16x32_bf16 v[164:167], a[24:27], v[32:35], v[164:167]
  buffer_load_dwordx4 v[128:131], v250, s[12:15], s78 offen offset:0 sc1
  v_mfma_f32_16x16x32_bf16 v[168:171], a[28:31], v[32:35], v[168:171]
  v_mfma_f32_16x16x32_bf16 v[172:175], a[32:35], v[32:35], v[172:175]
  v_mfma_f32_16x16x32_bf16 v[176:179], a[36:39], v[32:35], v[176:179]
  s_waitcnt vmcnt(23)
  s_nop 0
  v_mfma_f32_16x16x32_bf16 v[180:183], a[20:23], v[36:39], v[180:183]
  v_mfma_f32_16x16x32_bf16 v[184:187], a[24:27], v[36:39], v[184:187]
  buffer_load_dwordx4 v[132:135], v251, s[12:15], s78 offen offset:0 sc1
  v_mfma_f32_16x16x32_bf16 v[188:191], a[28:31], v[36:39], v[188:191]
  v_mfma_f32_16x16x32_bf16 v[192:195], a[32:35], v[36:39], v[192:195]
  v_mfma_f32_16x16x32_bf16 v[196:199], a[36:39], v[36:39], v[196:199]
  s_waitcnt vmcnt(23)
  s_nop 0
  v_mfma_f32_16x16x32_bf16 v[200:203], a[20:23], v[40:43], v[200:203]
  v_mfma_f32_16x16x32_bf16 v[204:207], a[24:27], v[40:43], v[204:207]
  buffer_load_dwordx4 v[136:139], v250, s[12:15], s79 offen offset:0 sc1
  v_mfma_f32_16x16x32_bf16 v[208:211], a[28:31], v[40:43], v[208:211]
  v_mfma_f32_16x16x32_bf16 v[212:215], a[32:35], v[40:43], v[212:215]
  v_mfma_f32_16x16x32_bf16 v[216:219], a[36:39], v[40:43], v[216:219]
  s_waitcnt vmcnt(23)
  s_nop 0
  v_mfma_f32_16x16x32_bf16 v[220:223], a[20:23], v[44:47], v[220:223]
  v_mfma_f32_16x16x32_bf16 v[224:227], a[24:27], v[44:47], v[224:227]
  buffer_load_dwordx4 v[140:143], v251, s[12:15], s79 offen offset:0 sc1
  v_mfma_f32_16x16x32_bf16 v[228:231], a[28:31], v[44:47], v[228:231]
  v_mfma_f32_16x16x32_bf16 v[232:235], a[32:35], v[44:47], v[232:235]
  v_mfma_f32_16x16x32_bf16 v[236:239], a[36:39], v[44:47], v[236:239]
  s_waitcnt vmcnt(23)
  s_nop 0
  v_mfma_f32_16x16x32_bf16 v[160:163], a[40:43], v[48:51], v[160:163]
  v_mfma_f32_16x16x32_bf16 v[164:167], a[44:47], v[48:51], v[164:167]
  buffer_load_dwordx4 v[144:147], v250, s[12:15], s78 offen offset:2048 sc1
  v_mfma_f32_16x16x32_bf16 v[168:171], a[48:51], v[48:51], v[168:171]
  v_mfma_f32_16x16x32_bf16 v[172:175], a[52:55], v[48:51], v[172:175]
  v_mfma_f32_16x16x32_bf16 v[176:179], a[56:59], v[48:51], v[176:179]
  s_waitcnt vmcnt(23)
  s_nop 0
  v_mfma_f32_16x16x32_bf16 v[180:183], a[40:43], v[52:55], v[180:183]
  v_mfma_f32_16x16x32_bf16 v[184:187], a[44:47], v[52:55], v[184:187]
  buffer_load_dwordx4 v[148:151], v251, s[12:15], s78 offen offset:2048 sc1
  s_add_u32 s78, s78, s36
  s_nop 0
  v_mfma_f32_16x16x32_bf16 v[188:191], a[48:51], v[52:55], v[188:191]
  v_mfma_f32_16x16x32_bf16 v[192:195], a[52:55], v[52:55], v[192:195]
  v_mfma_f32_16x16x32_bf16 v[196:199], a[56:59], v[52:55], v[196:199]
  s_waitcnt vmcnt(23)
  s_nop 0
  v_mfma_f32_16x16x32_bf16 v[200:203], a[40:43], v[56:59], v[200:203]
  v_mfma_f32_16x16x32_bf16 v[204:207], a[44:47], v[56:59], v[204:207]
  buffer_load_dwordx4 v[152:155], v250, s[12:15], s79 offen offset:2048 sc1
  v_mfma_f32_16x16x32_bf16 v[208:211], a[48:51], v[56:59], v[208:211]
  v_mfma_f32_16x16x32_bf16 v[212:215], a[52:55], v[56:59], v[212:215]
  v_mfma_f32_16x16x32_bf16 v[216:219], a[56:59], v[56:59], v[216:219]
  s_waitcnt vmcnt(23)
  s_nop 0
  v_mfma_f32_16x16x32_bf16 v[220:223], a[40:43], v[60:63], v[220:223]
  v_mfma_f32_16x16x32_bf16 v[224:227], a[44:47], v[60:63], v[224:227]
  buffer_load_dwordx4 v[156:159], v251, s[12:15], s79 offen offset:2048 sc1
  s_add_u32 s79, s79, s36
  s_nop 0
  v_mfma_f32_16x16x32_bf16 v[228:231], a[48:51], v[60:63], v[228:231]
  v_mfma_f32_16x16x32_bf16 v[232:235], a[52:55], v[60:63], v[232:235]
  v_mfma_f32_16x16x32_bf16 v[236:239], a[56:59], v[60:63], v[236:239]
  s_waitcnt vmcnt(23)
  s_nop 0
  v_mfma_f32_16x16x32_bf16 v[160:163], a[60:63], v[64:67], v[160:163]
  v_mfma_f32_16x16x32_bf16 v[164:167], a[64:67], v[64:67], v[164:167]
  buffer_load_dwordx4 v[16:19], v250, s[12:15], s78 offen offset:0 sc1
  v_mfma_f32_16x16x32_bf16 v[168:171], a[68:71], v[64:67], v[168:171]
  v_mfma_f32_16x16x32_bf16 v[172:175], a[72:75], v[64:67], v[172:175]
  v_mfma_f32_16x16x32_bf16 v[176:179], a[76:79], v[64:67], v[176:179]
  s_waitcnt vmcnt(23)
  s_nop 0
  v_mfma_f32_16x16x32_bf16 v[180:183], a[60:63], v[68:71], v[180:183]
  v_mfma_f32_16x16x32_bf16 v[184:187], a[64:67], v[68:71], v[184:187]
  buffer_load_dwordx4 v[20:23], v251, s[12:15], s78 offen offset:0 sc1
  v_mfma_f32_16x16x32_bf16 v[188:191], a[68:71], v[68:71], v[188:191]
  v_mfma_f32_16x16x32_bf16 v[192:195], a[72:75], v[68:71], v[192:195]
  v_mfma_f32_16x16x32_bf16 v[196:199], a[76:79], v[68:71], v[196:199]
  s_waitcnt vmcnt(23)
  s_nop 0
  v_mfma_f32_16x16x32_bf16 v[200:203], a[60:63], v[72:75], v[200:203]
  v_mfma_f32_16x16x32_bf16 v[204:207], a[64:67], v[72:75], v[204:207]
  buffer_load_dwordx4 v[24:27], v250, s[12:15], s79 offen offset:0 sc1
  v_mfma_f32_16x16x32_bf16 v[208:211], a[68:71], v[72:75], v[208:211]
  v_mfma_f32_16x16x32_bf16 v[212:215], a[72:75], v[72:75], v[212:215]
  v_mfma_f32_16x16x32_bf16 v[216:219], a[76:79], v[72:75], v[216:219]
  s_waitcnt vmcnt(23)
  s_nop 0
  v_mfma_f32_16x16x32_bf16 v[220:223], a[60:63], v[76:79], v[220:223]
  v_mfma_f32_16x16x32_bf16 v[224:227], a[64:67], v[76:79], v[224:227]
  buffer_load_dwordx4 v[28:31], v251, s[12:15], s79 offen offset:0 sc1
  v_mfma_f32_16x16x32_bf16 v[228:231], a[68:71], v[76:79], v[228:231]
  v_mfma_f32_16x16x32_bf16 v[232:235], a[72:75], v[76:79], v[232:235]
  v_mfma_f32_16x16x32_bf16 v[236:239], a[76:79], v[76:79], v[236:239]
  s_waitcnt vmcnt(23)
  s_nop 0
  v_mfma_f32_16x16x32_bf16 v[160:163], a[80:83], v[80:83], v[160:163]
  v_mfma_f32_16x16x32_bf16 v[164:167], a[84:87], v[80:83], v[164:167]
  buffer_load_dwordx4 v[32:35], v250, s[12:15], s78 offen offset:2048 sc1
  v_mfma_f32_16x16x32_bf16 v[168:171], a[88:91], v[80:83], v[168:171]
  v_mfma_f32_16x16x32_bf16 v[172:175], a[92:95], v[80:83], v[172:175]
  v_mfma_f32_16x16x32_bf16 v[176:179], a[96:99], v[80:83], v[176:179]
  s_waitcnt vmcnt(23)
  s_nop 0
  v_mfma_f32_16x16x32_bf16 v[180:183], a[80:83], v[84:87], v[180:183]
  v_mfma_f32_16x16x32_bf16 v[184:187], a[84:87], v[84:87], v[184:187]
  buffer_load_dwordx4 v[36:39], v251, s[12:15], s78 offen offset:2048 sc1
  s_add_u32 s78, s78, s36
  s_nop 0
  v_mfma_f32_16x16x32_bf16 v[188:191], a[88:91], v[84:87], v[188:191]
  v_mfma_f32_16x16x32_bf16 v[192:195], a[92:95], v[84:87], v[192:195]
  v_mfma_f32_16x16x32_bf16 v[196:199], a[96:99], v[84:87], v[196:199]
  s_waitcnt vmcnt(23)
  s_nop 0
  v_mfma_f32_16x16x32_bf16 v[200:203], a[80:83], v[88:91], v[200:203]
  v_mfma_f32_16x16x32_bf16 v[204:207], a[84:87], v[88:91], v[204:207]
  buffer_load_dwordx4 v[40:43], v250, s[12:15], s79 offen offset:2048 sc1
  v_mfma_f32_16x16x32_bf16 v[208:211], a[88:91], v[88:91], v[208:211]
  v_mfma_f32_16x16x32_bf16 v[212:215], a[92:95], v[88:91], v[212:215]
  v_mfma_f32_16x16x32_bf16 v[216:219], a[96:99], v[88:91], v[216:219]
  s_waitcnt vmcnt(23)
  s_nop 0
  v_mfma_f32_16x16x32_bf16 v[220:223], a[80:83], v[92:95], v[220:223]
  v_mfma_f32_16x16x32_bf16 v[224:227], a[84:87], v[92:95], v[224:227]
  buffer_load_dwordx4 v[44:47], v251, s[12:15], s79 offen offset:2048 sc1
  s_add_u32 s79, s79, s36
  s_nop 0
  v_mfma_f32_16x16x32_bf16 v[228:231], a[88:91], v[92:95], v[228:231]
  v_mfma_f32_16x16x32_bf16 v[232:235], a[92:95], v[92:95], v[232:235]
  v_mfma_f32_16x16x32_bf16 v[236:239], a[96:99], v[92:95], v[236:239]
  s_waitcnt vmcnt(23)
  s_nop 0
  v_mfma_f32_16x16x32_bf16 v[160:163], a[100:103], v[96:99], v[160:163]
  v_mfma_f32_16x16x32_bf16 v[164:167], a[104:107], v[96:99], v[164:167]
  buffer_load_dwordx4 v[48:51], v250, s[12:15], s78 offen offset:0 sc1
  v_mfma_f32_16x16x32_bf16 v[168:171], a[108:111], v[96:99], v[168:171]
  v_mfma_f32_16x16x32_bf16 v[172:175], a[112:115], v[96:99], v[172:175]
  v_mfma_f32_16x16x32_bf16 v[176:179], a[116:119], v[96:99], v[176:179]
  s_waitcnt vmcnt(23)
  s_nop 0
  v_mfma_f32_16x16x32_bf16 v[180:183], a[100:103], v[100:103], v[180:183]
  v_mfma_f32_16x16x32_bf16 v[184:187], a[104:107], v[100:103], v[184:187]
  buffer_load_dwordx4 v[52:55], v251, s[12:15], s78 offen offset:0 sc1
  v_mfma_f32_16x16x32_bf16 v[188:191], a[108:111], v[100:103], v[188:191]
  v_mfma_f32_16x16x32_bf16 v[192:195], a[112:115], v[100:103], v[192:195]
  v_mfma_f32_16x16x32_bf16 v[196:199], a[116:119], v[100:103], v[196:199]
  s_waitcnt vmcnt(23)
  s_nop 0
  v_mfma_f32_16x16x32_bf16 v[200:203], a[100:103], v[104:107], v[200:203]
  v_mfma_f32_16x16x32_bf16 v[204:207], a[104:107], v[104:107], v[204:207]
  buffer_load_dwordx4 v[56:59], v250, s[12:15], s79 offen offset:0 sc1
  v_mfma_f32_16x16x32_bf16 v[208:211], a[108:111], v[104:107], v[208:211]
  v_mfma_f32_16x16x32_bf16 v[212:215], a[112:115], v[104:107], v[212:215]
  v_mfma_f32_16x16x32_bf16 v[216:219], a[116:119], v[104:107], v[216:219]
  s_waitcnt vmcnt(23)
  s_nop 0
  v_mfma_f32_16x16x32_bf16 v[220:223], a[100:103], v[108:111], v[220:223]
  v_mfma_f32_16x16x32_bf16 v[224:227], a[104:107], v[108:111], v[224:227]
  buffer_load_dwordx4 v[60:63], v251, s[12:15], s79 offen offset:0 sc1
  v_mfma_f32_16x16x32_bf16 v[228:231], a[108:111], v[108:111], v[228:231]
  v_mfma_f32_16x16x32_bf16 v[232:235], a[112:115], v[108:111], v[232:235]
  v_mfma_f32_16x16x32_bf16 v[236:239], a[116:119], v[108:111], v[236:239]
  s_waitcnt vmcnt(23)
  s_nop 0
  v_mfma_f32_16x16x32_bf16 v[160:163], a[120:123], v[112:115], v[160:163]
  v_mfma_f32_16x16x32_bf16 v[164:167], a[124:127], v[112:115], v[164:167]
  buffer_load_dwordx2 v[242:243], v12, s[64:67], 0 offen offset:32
  v_mfma_f32_16x16x32_bf16 v[168:171], a[128:131], v[112:115], v[168:171]
  v_mfma_f32_16x16x32_bf16 v[172:175], a[132:135], v[112:115], v[172:175]
  buffer_load_dwordx2 v[240:241], v12, s[64:67], 0 offen offset:0
  v_mfma_f32_16x16x32_bf16 v[176:179], a[136:139], v[112:115], v[176:179]
  s_waitcnt vmcnt(24)
  s_nop 0
  v_mfma_f32_16x16x32_bf16 v[180:183], a[120:123], v[116:119], v[180:183]
  v_mfma_f32_16x16x32_bf16 v[184:187], a[124:127], v[116:119], v[184:187]
  buffer_load_dwordx2 v[244:245], v12, s[64:67], 0 offen offset:64
  v_mfma_f32_16x16x32_bf16 v[188:191], a[128:131], v[116:119], v[188:191]
  v_mfma_f32_16x16x32_bf16 v[192:195], a[132:135], v[116:119], v[192:195]
  v_mfma_f32_16x16x32_bf16 v[196:199], a[136:139], v[116:119], v[196:199]
  s_waitcnt vmcnt(24)
  s_nop 0
  v_mfma_f32_16x16x32_bf16 v[200:203], a[120:123], v[120:123], v[200:203]
  v_mfma_f32_16x16x32_bf16 v[204:207], a[124:127], v[120:123], v[204:207]
  buffer_load_dwordx2 v[246:247], v12, s[64:67], 0 offen offset:96
  v_mfma_f32_16x16x32_bf16 v[208:211], a[128:131], v[120:123], v[208:211]
  v_mfma_f32_16x16x32_bf16 v[212:215], a[132:135], v[120:123], v[212:215]
  v_mfma_f32_16x16x32_bf16 v[216:219], a[136:139], v[120:123], v[216:219]
  s_waitcnt vmcnt(24)
  s_nop 0
  v_mfma_f32_16x16x32_bf16 v[220:223], a[120:123], v[124:127], v[220:223]
  v_mfma_f32_16x16x32_bf16 v[224:227], a[124:127], v[124:127], v[224:227]
  buffer_load_dwordx2 v[248:249], v12, s[64:67], 0 offen offset:128
  v_mfma_f32_16x16x32_bf16 v[228:231], a[128:131], v[124:127], v[228:231]
  v_mfma_f32_16x16x32_bf16 v[232:235], a[132:135], v[124:127], v[232:235]
  v_mfma_f32_16x16x32_bf16 v[236:239], a[136:139], v[124:127], v[236:239]
  s_waitcnt vmcnt(24)
  s_nop 0
  v_mfma_f32_16x16x32_bf16 v[160:163], a[140:143], v[128:131], v[160:163]
  v_mfma_f32_16x16x32_bf16 v[164:167], a[144:147], v[128:131], v[164:167]
  v_mfma_f32_16x16x32_bf16 v[168:171], a[148:151], v[128:131], v[168:171]
  v_mfma_f32_16x16x32_bf16 v[172:175], a[152:155], v[128:131], v[172:175]
  v_mfma_f32_16x16x32_bf16 v[176:179], a[156:159], v[128:131], v[176:179]
  s_waitcnt vmcnt(23)
  s_nop 0
  v_mfma_f32_16x16x32_bf16 v[180:183], a[140:143], v[132:135], v[180:183]
  v_mfma_f32_16x16x32_bf16 v[184:187], a[144:147], v[132:135], v[184:187]
  v_mfma_f32_16x16x32_bf16 v[188:191], a[148:151], v[132:135], v[188:191]
  v_mfma_f32_16x16x32_bf16 v[192:195], a[152:155], v[132:135], v[192:195]
  v_mfma_f32_16x16x32_bf16 v[196:199], a[156:159], v[132:135], v[196:199]
  s_waitcnt vmcnt(22)
  s_nop 0
  v_mfma_f32_16x16x32_bf16 v[200:203], a[140:143], v[136:139], v[200:203]
  v_mfma_f32_16x16x32_bf16 v[204:207], a[144:147], v[136:139], v[204:207]
  v_mfma_f32_16x16x32_bf16 v[208:211], a[148:151], v[136:139], v[208:211]
  v_mfma_f32_16x16x32_bf16 v[212:215], a[152:155], v[136:139], v[212:215]
  v_mfma_f32_16x16x32_bf16 v[216:219], a[156:159], v[136:139], v[216:219]
  s_waitcnt vmcnt(21)
  s_nop 0
  v_mfma_f32_16x16x32_bf16 v[220:223], a[140:143], v[140:143], v[220:223]
  v_mfma_f32_16x16x32_bf16 v[224:227], a[144:147], v[140:143], v[224:227]
  v_mfma_f32_16x16x32_bf16 v[228:231], a[148:151], v[140:143], v[228:231]
  v_mfma_f32_16x16x32_bf16 v[232:235], a[152:155], v[140:143], v[232:235]
  v_mfma_f32_16x16x32_bf16 v[236:239], a[156:159], v[140:143], v[236:239]
  s_waitcnt vmcnt(20)
  s_nop 0
  v_mfma_f32_16x16x32_bf16 v[160:163], a[160:163], v[144:147], v[160:163]
  v_mfma_f32_16x16x32_bf16 v[164:167], a[164:167], v[144:147], v[164:167]
  v_mfma_f32_16x16x32_bf16 v[168:171], a[168:171], v[144:147], v[168:171]
  v_mfma_f32_16x16x32_bf16 v[172:175], a[172:175], v[144:147], v[172:175]
  v_mfma_f32_16x16x32_bf16 v[176:179], a[176:179], v[144:147], v[176:179]
  s_waitcnt vmcnt(19)
  s_nop 0
  v_mfma_f32_16x16x32_bf16 v[180:183], a[160:163], v[148:151], v[180:183]
  v_mfma_f32_16x16x32_bf16 v[184:187], a[164:167], v[148:151], v[184:187]
  v_mfma_f32_16x16x32_bf16 v[188:191], a[168:171], v[148:151], v[188:191]
  v_mfma_f32_16x16x32_bf16 v[192:195], a[172:175], v[148:151], v[192:195]
  v_mfma_f32_16x16x32_bf16 v[196:199], a[176:179], v[148:151], v[196:199]
  s_waitcnt vmcnt(18)
  s_nop 0
  v_mfma_f32_16x16x32_bf16 v[200:203], a[160:163], v[152:155], v[200:203]
  v_mfma_f32_16x16x32_bf16 v[204:207], a[164:167], v[152:155], v[204:207]
  v_mfma_f32_16x16x32_bf16 v[208:211], a[168:171], v[152:155], v[208:211]
  v_mfma_f32_16x16x32_bf16 v[212:215], a[172:175], v[152:155], v[212:215]
  v_mfma_f32_16x16x32_bf16 v[216:219], a[176:179], v[152:155], v[216:219]
  s_waitcnt vmcnt(17)
  s_nop 0
  v_mfma_f32_16x16x32_bf16 v[220:223], a[160:163], v[156:159], v[220:223]
  v_mfma_f32_16x16x32_bf16 v[224:227], a[164:167], v[156:159], v[224:227]
  v_mfma_f32_16x16x32_bf16 v[228:231], a[168:171], v[156:159], v[228:231]
  v_mfma_f32_16x16x32_bf16 v[232:235], a[172:175], v[156:159], v[232:235]
  v_mfma_f32_16x16x32_bf16 v[236:239], a[176:179], v[156:159], v[236:239]
  s_waitcnt vmcnt(16)
  s_nop 0
  v_mfma_f32_16x16x32_bf16 v[160:163], a[180:183], v[16:19], v[160:163]
  v_mfma_f32_16x16x32_bf16 v[164:167], a[184:187], v[16:19], v[164:167]
  v_mfma_f32_16x16x32_bf16 v[168:171], a[188:191], v[16:19], v[168:171]
  v_mfma_f32_16x16x32_bf16 v[172:175], a[192:195], v[16:19], v[172:175]
  v_mfma_f32_16x16x32_bf16 v[176:179], a[196:199], v[16:19], v[176:179]
  s_waitcnt vmcnt(15)
  s_nop 0
  v_mfma_f32_16x16x32_bf16 v[180:183], a[180:183], v[20:23], v[180:183]
  v_mfma_f32_16x16x32_bf16 v[184:187], a[184:187], v[20:23], v[184:187]
  v_mfma_f32_16x16x32_bf16 v[188:191], a[188:191], v[20:23], v[188:191]
  v_mfma_f32_16x16x32_bf16 v[192:195], a[192:195], v[20:23], v[192:195]
  v_mfma_f32_16x16x32_bf16 v[196:199], a[196:199], v[20:23], v[196:199]
  s_waitcnt vmcnt(14)
  s_nop 0
  v_mfma_f32_16x16x32_bf16 v[200:203], a[180:183], v[24:27], v[200:203]
  v_mfma_f32_16x16x32_bf16 v[204:207], a[184:187], v[24:27], v[204:207]
  v_mfma_f32_16x16x32_bf16 v[208:211], a[188:191], v[24:27], v[208:211]
  v_mfma_f32_16x16x32_bf16 v[212:215], a[192:195], v[24:27], v[212:215]
  v_mfma_f32_16x16x32_bf16 v[216:219], a[196:199], v[24:27], v[216:219]
  s_waitcnt vmcnt(13)
  s_nop 0
  v_mfma_f32_16x16x32_bf16 v[220:223], a[180:183], v[28:31], v[220:223]
  v_mfma_f32_16x16x32_bf16 v[224:227], a[184:187], v[28:31], v[224:227]
  v_mfma_f32_16x16x32_bf16 v[228:231], a[188:191], v[28:31], v[228:231]
  v_mfma_f32_16x16x32_bf16 v[232:235], a[192:195], v[28:31], v[232:235]
  v_mfma_f32_16x16x32_bf16 v[236:239], a[196:199], v[28:31], v[236:239]
  s_waitcnt vmcnt(12)
  s_nop 0
  v_mfma_f32_16x16x32_bf16 v[160:163], a[200:203], v[32:35], v[160:163]
  v_mfma_f32_16x16x32_bf16 v[164:167], a[204:207], v[32:35], v[164:167]
  v_mfma_f32_16x16x32_bf16 v[168:171], a[208:211], v[32:35], v[168:171]
  v_mfma_f32_16x16x32_bf16 v[172:175], a[212:215], v[32:35], v[172:175]
  v_mfma_f32_16x16x32_bf16 v[176:179], a[216:219], v[32:35], v[176:179]
  s_waitcnt vmcnt(11)
  s_nop 0
  v_mfma_f32_16x16x32_bf16 v[180:183], a[200:203], v[36:39], v[180:183]
  v_mfma_f32_16x16x32_bf16 v[184:187], a[204:207], v[36:39], v[184:187]
  v_mfma_f32_16x16x32_bf16 v[188:191], a[208:211], v[36:39], v[188:191]
  v_mfma_f32_16x16x32_bf16 v[192:195], a[212:215], v[36:39], v[192:195]
  v_mfma_f32_16x16x32_bf16 v[196:199], a[216:219], v[36:39], v[196:199]
  s_waitcnt vmcnt(10)
  s_nop 0
  v_mfma_f32_16x16x32_bf16 v[200:203], a[200:203], v[40:43], v[200:203]
  v_mfma_f32_16x16x32_bf16 v[204:207], a[204:207], v[40:43], v[204:207]
  v_mfma_f32_16x16x32_bf16 v[208:211], a[208:211], v[40:43], v[208:211]
  v_mfma_f32_16x16x32_bf16 v[212:215], a[212:215], v[40:43], v[212:215]
  v_mfma_f32_16x16x32_bf16 v[216:219], a[216:219], v[40:43], v[216:219]
  s_waitcnt vmcnt(9)
  s_nop 0
  v_mfma_f32_16x16x32_bf16 v[220:223], a[200:203], v[44:47], v[220:223]
  v_mfma_f32_16x16x32_bf16 v[224:227], a[204:207], v[44:47], v[224:227]
  v_mfma_f32_16x16x32_bf16 v[228:231], a[208:211], v[44:47], v[228:231]
  v_mfma_f32_16x16x32_bf16 v[232:235], a[212:215], v[44:47], v[232:235]
  v_mfma_f32_16x16x32_bf16 v[236:239], a[216:219], v[44:47], v[236:239]
  s_cmp_eq_u32 s20, 3
  s_cbranch_scc1 K3_RED
  s_waitcnt vmcnt(8)
  s_nop 0
  v_mfma_f32_16x16x32_bf16 v[160:163], a[220:223], v[48:51], v[160:163]
  v_mfma_f32_16x16x32_bf16 v[164:167], a[224:227], v[48:51], v[164:167]
  v_mfma_f32_16x16x32_bf16 v[168:171], a[228:231], v[48:51], v[168:171]
  v_mfma_f32_16x16x32_bf16 v[172:175], a[232:235], v[48:51], v[172:175]
  v_mfma_f32_16x16x32_bf16 v[176:179], a[236:239], v[48:51], v[176:179]
  s_waitcnt vmcnt(7)
  s_nop 0
  v_mfma_f32_16x16x32_bf16 v[180:183], a[220:223], v[52:55], v[180:183]
  v_mfma_f32_16x16x32_bf16 v[184:187], a[224:227], v[52:55], v[184:187]
  v_mfma_f32_16x16x32_bf16 v[188:191], a[228:231], v[52:55], v[188:191]
  v_mfma_f32_16x16x32_bf16 v[192:195], a[232:235], v[52:55], v[192:195]
  v_mfma_f32_16x16x32_bf16 v[196:199], a[236:239], v[52:55], v[196:199]
  s_waitcnt vmcnt(6)
  s_nop 0
  v_mfma_f32_16x16x32_bf16 v[200:203], a[220:223], v[56:59], v[200:203]
  v_mfma_f32_16x16x32_bf16 v[204:207], a[224:227], v[56:59], v[204:207]
  v_mfma_f32_16x16x32_bf16 v[208:211], a[228:231], v[56:59], v[208:211]
  v_mfma_f32_16x16x32_bf16 v[212:215], a[232:235], v[56:59], v[212:215]
  v_mfma_f32_16x16x32_bf16 v[216:219], a[236:239], v[56:59], v[216:219]
  s_waitcnt vmcnt(5)
  s_nop 0
  v_mfma_f32_16x16x32_bf16 v[220:223], a[220:223], v[60:63], v[220:223]
  v_mfma_f32_16x16x32_bf16 v[224:227], a[224:227], v[60:63], v[224:227]
  v_mfma_f32_16x16x32_bf16 v[228:231], a[228:231], v[60:63], v[228:231]
  v_mfma_f32_16x16x32_bf16 v[232:235], a[232:235], v[60:63], v[232:235]
  v_mfma_f32_16x16x32_bf16 v[236:239], a[236:239], v[60:63], v[236:239]
K3_RED:
  s_nop 7
  ds_write_b128 v1, v[180:183] offset:0
  ds_write_b128 v1, v[184:187] offset:1024
  ds_write_b128 v1, v[188:191] offset:2048
  ds_write_b128 v1, v[192:195] offset:3072
  ds_write_b128 v1, v[196:199] offset:4096
  ds_write_b128 v1, v[200:203] offset:5120
  ds_write_b128 v1, v[204:207] offset:6144
  ds_write_b128 v1, v[208:211] offset:7168
  ds_write_b128 v1, v[212:215] offset:8192
  ds_write_b128 v1, v[216:219] offset:9216
  ds_write_b128 v1, v[220:223] offset:10240
  ds_write_b128 v1, v[224:227] offset:11264
  ds_write_b128 v1, v[228:231] offset:12288
  ds_write_b128 v1, v[232:235] offset:13312
  ds_write_b128 v1, v[236:239] offset:14336
  s_waitcnt vmcnt(0)
  v_lshlrev_b32 v6, 16, v240
  v_and_b32 v7, 0xffff0000, v240
  v_pk_add_f32 v[160:161], v[160:161], v[6:7]
  v_lshlrev_b32 v6, 16, v241
  v_and_b32 v7, 0xffff0000, v241
  v_pk_add_f32 v[162:163], v[162:163], v[6:7]
  v_lshlrev_b32 v6, 16, v242
  v_and_b32 v7, 0xffff0000, v242
  v_pk_add_f32 v[164:165], v[164:165], v[6:7]
  v_lshlrev_b32 v6, 16, v243
  v_and_b32 v7, 0xffff0000, v243
  v_pk_add_f32 v[166:167], v[166:167], v[6:7]
  v_lshlrev_b32 v6, 16, v244
  v_and_b32 v7, 0xffff0000, v244
  v_pk_add_f32 v[168:169], v[168:169], v[6:7]
  v_lshlrev_b32 v6, 16, v245
  v_and_b32 v7, 0xffff0000, v245
  v_pk_add_f32 v[170:171], v[170:171], v[6:7]
  v_lshlrev_b32 v6, 16, v246
  v_and_b32 v7, 0xffff0000, v246
  v_pk_add_f32 v[172:173], v[172:173], v[6:7]
  v_lshlrev_b32 v6, 16, v247
  v_and_b32 v7, 0xffff0000, v247
  v_pk_add_f32 v[174:175], v[174:175], v[6:7]
  v_lshlrev_b32 v6, 16, v248
  v_and_b32 v7, 0xffff0000, v248
  v_pk_add_f32 v[176:177], v[176:177], v[6:7]
  v_lshlrev_b32 v6, 16, v249
  v_and_b32 v7, 0xffff0000, v249
  v_pk_add_f32 v[178:179], v[178:179], v[6:7]
  s_waitcnt vmcnt(0) lgkmcnt(0)
  s_barrier
  ds_read_b128 v[16:19], v3 offset:0
  ds_read_b128 v[20:23], v4 offset:5120
  ds_read_b128 v[24:27], v5 offset:10240
  ds_read_b128 v[28:31], v3 offset:1024
  ds_read_b128 v[32:35], v4 offset:6144
  ds_read_b128 v[36:39], v5 offset:11264
  ds_read_b128 v[40:43], v3 offset:2048
  ds_read_b128 v[44:47], v4 offset:7168
  ds_read_b128 v[48:51], v5 offset:12288
  ds_read_b128 v[52:55], v3 offset:3072
  ds_read_b128 v[56:59], v4 offset:8192
  ds_read_b128 v[60:63], v5 offset:13312
  ds_read_b128 v[64:67], v3 offset:4096
  ds_read_b128 v[68:71], v4 offset:9216
  ds_read_b128 v[72:75], v5 offset:14336
  s_waitcnt lgkmcnt(12)
  v_pk_add_f32 v[16:17], v[16:17], v[20:21]
  v_pk_add_f32 v[160:161], v[160:161], v[24:25]
  v_pk_add_f32 v[18:19], v[18:19], v[22:23]
  v_pk_add_f32 v[162:163], v[162:163], v[26:27]
  v_pk_add_f32 v[160:161], v[160:161], v[16:17]
  v_pk_add_f32 v[162:163], v[162:163], v[18:19]
  v_cvt_pk_bf16_f32 v240, v160, v161
  v_cvt_pk_bf16_f32 v241, v162, v163
  buffer_store_dwordx2 v[240:241], v12, s[68:71], 0 offen offset:0
  s_waitcnt lgkmcnt(9)
  v_pk_add_f32 v[28:29], v[28:29], v[32:33]
  v_pk_add_f32 v[164:165], v[164:165], v[36:37]
  v_pk_add_f32 v[30:31], v[30:31], v[34:35]
  v_pk_add_f32 v[166:167], v[166:167], v[38:39]
  v_pk_add_f32 v[164:165], v[164:165], v[28:29]
  v_pk_add_f32 v[166:167], v[166:167], v[30:31]
  v_cvt_pk_bf16_f32 v242, v164, v165
  v_cvt_pk_bf16_f32 v243, v166, v167
  buffer_store_dwordx2 v[242:243], v12, s[68:71], 0 offen offset:32
  s_waitcnt lgkmcnt(6)
  v_pk_add_f32 v[40:41], v[40:41], v[44:45]
  v_pk_add_f32 v[168:169], v[168:169], v[48:49]
  v_pk_add_f32 v[42:43], v[42:43], v[46:47]
  v_pk_add_f32 v[170:171], v[170:171], v[50:51]
  v_pk_add_f32 v[168:169], v[168:169], v[40:41]
  v_pk_add_f32 v[170:171], v[170:171], v[42:43]
  v_cvt_pk_bf16_f32 v244, v168, v169
  v_cvt_pk_bf16_f32 v245, v170, v171
  buffer_store_dwordx2 v[244:245], v12, s[68:71], 0 offen offset:64
  s_waitcnt lgkmcnt(3)
  v_pk_add_f32 v[52:53], v[52:53], v[56:57]
  v_pk_add_f32 v[172:173], v[172:173], v[60:61]
  v_pk_add_f32 v[54:55], v[54:55], v[58:59]
  v_pk_add_f32 v[174:175], v[174:175], v[62:63]
  v_pk_add_f32 v[172:173], v[172:173], v[52:53]
  v_pk_add_f32 v[174:175], v[174:175], v[54:55]
  v_cvt_pk_bf16_f32 v246, v172, v173
  v_cvt_pk_bf16_f32 v247, v174, v175
  buffer_store_dwordx2 v[246:247], v12, s[68:71], 0 offen offset:96
  s_waitcnt lgkmcnt(0)
  v_pk_add_f32 v[64:65], v[64:65], v[68:69]
  v_pk_add_f32 v[176:177], v[176:177], v[72:73]
  v_pk_add_f32 v[66:67], v[66:67], v[70:71]
  v_pk_add_f32 v[178:179], v[178:179], v[74:75]
  v_pk_add_f32 v[176:177], v[176:177], v[64:65]
  v_pk_add_f32 v[178:179], v[178:179], v[66:67]
  v_cvt_pk_bf16_f32 v248, v176, v177
  v_cvt_pk_bf16_f32 v249, v178, v179
  buffer_store_dwordx2 v[248:249], v12, s[68:71], 0 offen offset:128
  s_waitcnt vmcnt(0)
K2_END:
  s_endpgm
K2_PF:
  s_mov_b32 s32, 0
  buffer_load_dwordx4 v[232:235], v255, s[12:15], s90 offen offset:0
  buffer_load_dwordx4 v[236:239], v255, s[12:15], s90 offen offset:2048
  buffer_load_dwordx4 v[240:243], v255, s[12:15], s91 offen offset:0
  buffer_load_dwordx4 v[244:247], v255, s[12:15], s92 offen offset:0
  s_branch K2_PFR
K2_FB:
  s_waitcnt vmcnt(0)
  s_lshr_b32 s21, s42, 1
  s_mul_i32 s21, s21, 2560
  s_and_b32 s22, s42, 1
  s_mul_i32 s23, s22, 1536
  s_add_u32 s23, s23, s21
  s_lshl_b32 s22, s22, 3
  s_add_u32 s21, s21, s22
  s_add_u32 s21, s21, 1024
  v_and_b32 v232, 31, v0
  v_lshrrev_b32 v233, 5, v0
  v_lshl_add_u32 v1, v0, 4, s23
  v_lshl_add_u32 v2, v232, 4, s21
  v_lshl_add_u32 v2, v233, 2, v2
  s_mul_i32 s21, s42, 20
  s_add_u32 s21, s21, 640
  v_add_u32 v235, s21, v232
  v_lshrrev_b32 v3, 6, v235
  v_lshl_add_u32 v3, v3, 2, v233
  v_and_b32 v235, 63, v235
  v_lshlrev_b32 v3, 10, v3
  v_lshl_add_u32 v3, v235, 4, v3
  s_mul_i32 s21, s20, 245760
  s_add_u32 s21, s21, s46
  s_add_u32 s22, s21, 122880
  buffer_load_dwordx4 v[48:51], v1, s[12:15], s21 offen
  buffer_load_dword v80, v2, s[12:15], s21 offen
  v_mov_b32 v81, 0
  v_mov_b32 v113, 0x3f803f80
  v_mov_b32 v240, 0xff800000
  buffer_load_dwordx4 v[52:55], v1, s[12:15], s22 offen
  buffer_load_dword v82, v2, s[12:15], s22 offen
  v_mov_b32 v83, 0
  v_mov_b32 v115, 0x3f803f80
  v_mov_b32 v241, 0xff800000
  v_mov_b32 v120, 0x3f803f80
  v_mov_b32 v121, 0x3f803f80
  v_mov_b32 v122, 0x3f803f80
  v_mov_b32 v123, 0x3f803f80
  v_mov_b32 v124, 0x3f803f80
  v_mov_b32 v125, 0x3f803f80
  v_mov_b32 v126, 0x3f803f80
  v_mov_b32 v127, 0x3f803f80
  v_mov_b32 v128, 0x3f803f80
  v_mov_b32 v129, 0x3f803f80
  v_mov_b32 v130, 0x3f803f80
  v_mov_b32 v131, 0x3f803f80
  v_mov_b32 v132, 0x3f803f80
  v_mov_b32 v133, 0x3f803f80
  v_mov_b32 v134, 0x3f803f80
  v_mov_b32 v135, 0x3f803f80
  v_accvgpr_write_b32 a0, 0
  v_accvgpr_write_b32 a1, 0
  v_accvgpr_write_b32 a2, 0
  v_accvgpr_write_b32 a3, 0
  v_accvgpr_write_b32 a4, 0
  v_accvgpr_write_b32 a5, 0
  v_accvgpr_write_b32 a6, 0
  v_accvgpr_write_b32 a7, 0
  v_accvgpr_write_b32 a8, 0
  v_accvgpr_write_b32 a9, 0
  v_accvgpr_write_b32 a10, 0
  v_accvgpr_write_b32 a11, 0
  v_accvgpr_write_b32 a12, 0
  v_accvgpr_write_b32 a13, 0
  v_accvgpr_write_b32 a14, 0
  v_accvgpr_write_b32 a15, 0
  v_accvgpr_write_b32 a16, 0
  v_accvgpr_write_b32 a17, 0
  v_accvgpr_write_b32 a18, 0
  v_accvgpr_write_b32 a19, 0
  v_accvgpr_write_b32 a20, 0
  v_accvgpr_write_b32 a21, 0
  v_accvgpr_write_b32 a22, 0
  v_accvgpr_write_b32 a23, 0
  v_accvgpr_write_b32 a24, 0
  v_accvgpr_write_b32 a25, 0
  v_accvgpr_write_b32 a26, 0
  v_accvgpr_write_b32 a27, 0
  v_accvgpr_write_b32 a28, 0
  v_accvgpr_write_b32 a29, 0
  v_accvgpr_write_b32 a30, 0
  v_accvgpr_write_b32 a31, 0
  s_mov_b32 s21, 40960
  s_mov_b32 s22, 163840
  s_mov_b32 s33, 0
K2_FB0:
  buffer_load_dwordx4 v[96:99], v1, s[12:15], s21 offen
  buffer_load_dword v112, v2, s[12:15], s21 offen
  buffer_load_dwordx4 v[100:103], v1, s[12:15], s22 offen
  buffer_load_dword v114, v2, s[12:15], s22 offen
  s_waitcnt vmcnt(0)
  v_mfma_f32_32x32x16_bf16 v[16:31], v[96:99], v[48:51], 0
  v_mfma_f32_32x32x16_bf16 v[32:47], v[96:99], v[52:55], 0
  v_mfma_f32_32x32x8_bf16 v[16:31], v[112:113], v[80:81], v[16:31]
  v_mfma_f32_32x32x8_bf16 v[32:47], v[112:113], v[82:83], v[32:47]
  s_nop 7
  s_nop 7
  v_max3_f32 v240, v16, v17, v240
  v_max3_f32 v240, v18, v19, v240
  v_max3_f32 v240, v20, v21, v240
  v_max3_f32 v240, v22, v23, v240
  v_max3_f32 v240, v24, v25, v240
  v_max3_f32 v240, v26, v27, v240
  v_max3_f32 v240, v28, v29, v240
  v_max3_f32 v240, v30, v31, v240
  v_max3_f32 v241, v32, v33, v241
  v_max3_f32 v241, v34, v35, v241
  v_max3_f32 v241, v36, v37, v241
  v_max3_f32 v241, v38, v39, v241
  v_max3_f32 v241, v40, v41, v241
  v_max3_f32 v241, v42, v43, v241
  v_max3_f32 v241, v44, v45, v241
  v_max3_f32 v241, v46, v47, v241
  s_nop 7
  v_mfma_f32_32x32x16_bf16 v[16:31], v[100:103], v[48:51], 0
  v_mfma_f32_32x32x16_bf16 v[32:47], v[100:103], v[52:55], 0
  v_mfma_f32_32x32x8_bf16 v[16:31], v[114:115], v[80:81], v[16:31]
  v_mfma_f32_32x32x8_bf16 v[32:47], v[114:115], v[82:83], v[32:47]
  s_nop 7
  s_nop 7
  v_max3_f32 v240, v16, v17, v240
  v_max3_f32 v240, v18, v19, v240
  v_max3_f32 v240, v20, v21, v240
  v_max3_f32 v240, v22, v23, v240
  v_max3_f32 v240, v24, v25, v240
  v_max3_f32 v240, v26, v27, v240
  v_max3_f32 v240, v28, v29, v240
  v_max3_f32 v240, v30, v31, v240
  v_max3_f32 v241, v32, v33, v241
  v_max3_f32 v241, v34, v35, v241
  v_max3_f32 v241, v36, v37, v241
  v_max3_f32 v241, v38, v39, v241
  v_max3_f32 v241, v40, v41, v241
  v_max3_f32 v241, v42, v43, v241
  v_max3_f32 v241, v44, v45, v241
  v_max3_f32 v241, v46, v47, v241
  s_nop 7
  s_add_u32 s21, s21, 245760
  s_add_u32 s22, s22, 245760
  s_add_u32 s33, s33, 1
  s_cmp_lt_u32 s33, 32
  s_cbranch_scc1 K2_FB0
  v_mov_b32 v242, v240
  v_mov_b32 v243, v241
  v_cmp_lt_u32 vcc, 31, v0
  s_nop 1
  v_permlane32_swap_b32 v240, v242
  v_permlane32_swap_b32 v241, v243
  s_nop 1
  v_max_f32 v240, v240, v242
  v_max_f32 v241, v241, v243
  v_cvt_pk_bf16_f32 v242, v240, v240
  v_and_b32 v242, 0xffff0000, v242
  v_sub_f32 v242, v240, v242
  v_cvt_pk_bf16_f32 v81, v240, v242
  v_and_b32 v243, 0xffff0000, v81
  v_sub_f32 v242, v242, v243
  v_cvt_pk_bf16_f32 v242, v242, 0
  v_cndmask_b32 v81, v81, v242, vcc
  v_xor_b32 v81, 0x80008000, v81
  v_cvt_pk_bf16_f32 v242, v241, v241
  v_and_b32 v242, 0xffff0000, v242
  v_sub_f32 v242, v241, v242
  v_cvt_pk_bf16_f32 v83, v241, v242
  v_and_b32 v243, 0xffff0000, v83
  v_sub_f32 v242, v242, v243
  v_cvt_pk_bf16_f32 v242, v242, 0
  v_cndmask_b32 v83, v83, v242, vcc
  v_xor_b32 v83, 0x80008000, v83
  s_mov_b32 s21, 40960
  s_mov_b32 s22, 163840
  s_mov_b32 s33, 0
K2_FB1:
  buffer_load_dwordx4 v[96:99], v1, s[12:15], s21 offen
  buffer_load_dword v112, v2, s[12:15], s21 offen
  buffer_load_dwordx4 v[100:103], v1, s[12:15], s22 offen
  buffer_load_dword v114, v2, s[12:15], s22 offen
  s_mov_b64 exec, s[34:35]
  buffer_load_dwordx4 v[120:123], v3, s[12:15], s21 offen offset:0
  buffer_load_dwordx4 v[124:127], v3, s[12:15], s21 offen offset:2048
  buffer_load_dwordx4 v[128:131], v3, s[12:15], s22 offen offset:0
  buffer_load_dwordx4 v[132:135], v3, s[12:15], s22 offen offset:2048
  s_mov_b64 exec, -1
  s_waitcnt vmcnt(0)
  v_mfma_f32_32x32x16_bf16 v[16:31], v[96:99], v[48:51], 0
  v_mfma_f32_32x32x16_bf16 v[32:47], v[96:99], v[52:55], 0
  v_mfma_f32_32x32x8_bf16 v[16:31], v[112:113], v[80:81], v[16:31]
  v_mfma_f32_32x32x8_bf16 v[32:47], v[112:113], v[82:83], v[32:47]
  s_nop 7
  s_nop 7
  v_exp_f32 v16, v16
  v_exp_f32 v17, v17
  v_exp_f32 v18, v18
  v_exp_f32 v19, v19
  v_exp_f32 v20, v20
  v_exp_f32 v21, v21
  v_exp_f32 v22, v22
  v_exp_f32 v23, v23
  v_exp_f32 v24, v24
  v_exp_f32 v25, v25
  v_exp_f32 v26, v26
  v_exp_f32 v27, v27
  v_exp_f32 v28, v28
  v_exp_f32 v29, v29
  v_exp_f32 v30, v30
  v_exp_f32 v31, v31
  v_exp_f32 v32, v32
  v_exp_f32 v33, v33
  v_exp_f32 v34, v34
  v_exp_f32 v35, v35
  v_exp_f32 v36, v36
  v_exp_f32 v37, v37
  v_exp_f32 v38, v38
  v_exp_f32 v39, v39
  v_exp_f32 v40, v40
  v_exp_f32 v41, v41
  v_exp_f32 v42, v42
  v_exp_f32 v43, v43
  v_exp_f32 v44, v44
  v_exp_f32 v45, v45
  v_exp_f32 v46, v46
  v_exp_f32 v47, v47
  s_nop 1
  v_smfmac_f32_32x32x32_bf16 a[0:15], v[120:123], v[16:23], v13
  v_smfmac_f32_32x32x32_bf16 a[0:15], v[124:127], v[24:31], v13
  v_smfmac_f32_32x32x32_bf16 a[16:31], v[120:123], v[32:39], v13
  v_smfmac_f32_32x32x32_bf16 a[16:31], v[124:127], v[40:47], v13
  s_nop 7
  v_mfma_f32_32x32x16_bf16 v[16:31], v[100:103], v[48:51], 0
  v_mfma_f32_32x32x16_bf16 v[32:47], v[100:103], v[52:55], 0
  v_mfma_f32_32x32x8_bf16 v[16:31], v[114:115], v[80:81], v[16:31]
  v_mfma_f32_32x32x8_bf16 v[32:47], v[114:115], v[82:83], v[32:47]
  s_nop 7
  s_nop 7
  v_exp_f32 v16, v16
  v_exp_f32 v17, v17
  v_exp_f32 v18, v18
  v_exp_f32 v19, v19
  v_exp_f32 v20, v20
  v_exp_f32 v21, v21
  v_exp_f32 v22, v22
  v_exp_f32 v23, v23
  v_exp_f32 v24, v24
  v_exp_f32 v25, v25
  v_exp_f32 v26, v26
  v_exp_f32 v27, v27
  v_exp_f32 v28, v28
  v_exp_f32 v29, v29
  v_exp_f32 v30, v30
  v_exp_f32 v31, v31
  v_exp_f32 v32, v32
  v_exp_f32 v33, v33
  v_exp_f32 v34, v34
  v_exp_f32 v35, v35
  v_exp_f32 v36, v36
  v_exp_f32 v37, v37
  v_exp_f32 v38, v38
  v_exp_f32 v39, v39
  v_exp_f32 v40, v40
  v_exp_f32 v41, v41
  v_exp_f32 v42, v42
  v_exp_f32 v43, v43
  v_exp_f32 v44, v44
  v_exp_f32 v45, v45
  v_exp_f32 v46, v46
  v_exp_f32 v47, v47
  s_nop 1
  v_smfmac_f32_32x32x32_bf16 a[0:15], v[128:131], v[16:23], v13
  v_smfmac_f32_32x32x32_bf16 a[0:15], v[132:135], v[24:31], v13
  v_smfmac_f32_32x32x32_bf16 a[16:31], v[128:131], v[32:39], v13
  v_smfmac_f32_32x32x32_bf16 a[16:31], v[132:135], v[40:47], v13
  s_nop 7
  s_add_u32 s21, s21, 245760
  s_add_u32 s22, s22, 245760
  s_add_u32 s33, s33, 1
  s_cmp_lt_u32 s33, 32
  s_cbranch_scc1 K2_FB1
  s_nop 7
  s_nop 7
  v_accvgpr_read_b32 v48, a0
  v_accvgpr_read_b32 v49, a1
  v_accvgpr_read_b32 v50, a2
  v_accvgpr_read_b32 v51, a3
  v_accvgpr_read_b32 v52, a4
  v_accvgpr_read_b32 v53, a5
  v_accvgpr_read_b32 v54, a6
  v_accvgpr_read_b32 v55, a7
  v_accvgpr_read_b32 v56, a8
  v_accvgpr_read_b32 v57, a9
  v_accvgpr_read_b32 v58, a10
  v_accvgpr_read_b32 v59, a11
  v_accvgpr_read_b32 v60, a16
  v_accvgpr_read_b32 v61, a17
  v_accvgpr_read_b32 v62, a18
  v_accvgpr_read_b32 v63, a19
  v_accvgpr_read_b32 v64, a20
  v_accvgpr_read_b32 v65, a21
  v_accvgpr_read_b32 v66, a22
  v_accvgpr_read_b32 v67, a23
  v_accvgpr_read_b32 v68, a24
  v_accvgpr_read_b32 v69, a25
  v_accvgpr_read_b32 v70, a26
  v_accvgpr_read_b32 v71, a27
  s_nop 1
  buffer_load_dwordx4 a[0:3], v255, s[12:15], s72 offen
  buffer_load_dwordx4 a[4:7], v255, s[12:15], s73 offen
  buffer_load_dwordx4 a[8:11], v255, s[12:15], s74 offen
  buffer_load_dwordx4 a[12:15], v255, s[12:15], s75 offen
  buffer_load_dwordx4 a[16:19], v255, s[12:15], s76 offen
  buffer_load_dwordx4 a[20:23], v9, s[12:15], s72 offen offset:0
  buffer_load_dwordx4 a[24:27], v9, s[12:15], s73 offen offset:0
  buffer_load_dwordx4 a[28:31], v9, s[12:15], s74 offen offset:0
  s_branch K2_NORM
CODE_END:
.section .rodata,"a"
.p2align 6
.amdhsa_kernel parallel_sum__softmax_full_mha__mixer_gmlp__prompt_kernel
  .amdhsa_next_free_vgpr 512
  .amdhsa_next_free_sgpr 102
  .amdhsa_accum_offset 256
  .amdhsa_group_segment_fixed_size 0
  .amdhsa_kernarg_size 88
  .amdhsa_user_sgpr_count 2
  .amdhsa_user_sgpr_kernarg_segment_ptr 1
  .amdhsa_system_sgpr_workgroup_id_x 1
.end_amdhsa_kernel
.p2align 6
.amdhsa_kernel k23_kernel
  .amdhsa_next_free_vgpr 512
  .amdhsa_next_free_sgpr 102
  .amdhsa_accum_offset 256
  .amdhsa_group_segment_fixed_size 0
  .amdhsa_kernarg_size 88
  .amdhsa_user_sgpr_count 2
  .amdhsa_user_sgpr_kernarg_segment_ptr 1
  .amdhsa_system_sgpr_workgroup_id_x 1
.end_amdhsa_kernel
```
